```python
import torch

def _softmax(x, axis=-1):
    return torch.softmax(x, dim=axis)

def _gelu(x):
    return torch.nn.functional.gelu(x, approximate='tanh')

def _silu(x):
    return torch.nn.functional.silu(x)

def _sigmoid(x):
    return torch.sigmoid(x)

def _layernorm(x, axis=-1, eps=1e-05):
    m = x.mean(dim=axis, keepdim=True)
    v = x.var(dim=axis, keepdim=True, unbiased=False)
    return (x - m) / torch.sqrt(v + eps)

def _scatter_add(tgt, idx, src, axis=0):
    return tgt.clone().index_add_(axis, idx, src)

def _segment_sum(src, seg, n):
    out = torch.zeros((n,) + src.shape[1:], dtype=src.dtype)
    return out.index_add_(0, seg, src)

def _pad(x, pw):
    flat = tuple((v for pair in reversed(pw) for v in pair))
    return torch.nn.functional.pad(x, flat)
kernel_name = 'sequential_preLN__softmax_full_mha__mixer_gmlp__prompt'

def setup_inputs():

    _w = lambda a: (lambda t: t.to(torch.bfloat16) if t.is_floating_point() else t)(torch.as_tensor(a))

    def _A_setup():
        B, S, D = (1, 2048, 512)
        return {'x': _w((lambda *s: torch.randn(*s, dtype=torch.bfloat16) * 0.05)(B, S, D)), 'wqkv': _w((lambda *s: torch.randn(*s, dtype=torch.bfloat16) * 0.05)(D, 3 * D)), 'wo': _w((lambda *s: torch.randn(*s, dtype=torch.bfloat16) * 0.05)(D, D))}
    _A_in = _A_setup()

    def _B_setup():
        B, S, D, F = (1, 2048, 512, 1376)
        Fh = F // 2
        return {'x': _w((lambda *s: torch.randn(*s, dtype=torch.bfloat16) * 0.05)(B, S, D)), 'w_in': _w((lambda *s: torch.randn(*s, dtype=torch.bfloat16) * 0.4)(D, 2 * Fh)), 'w_sp': _w(0.01 * (lambda *s: torch.randn(*s, dtype=torch.bfloat16) * 0.4)(S, S)), 'b_sp': _w(1.0 + 0.01 * (lambda *s: torch.randn(*s, dtype=torch.bfloat16) * 0.05)(S)), 'w_out': _w((lambda *s: torch.randn(*s, dtype=torch.bfloat16) * 0.05)(Fh, D))}
    _B_in = _B_setup()
    return {'A_x': _A_in['x'], 'A_wqkv': _A_in['wqkv'], 'A_wo': _A_in['wo'], 'B_x': _B_in['x'], 'B_w_in': _B_in['w_in'], 'B_w_sp': _B_in['w_sp'], 'B_b_sp': _B_in['b_sp'], 'B_w_out': _B_in['w_out']}

def reference(A_x, A_wqkv, A_wo, B_x, B_w_in, B_w_sp, B_b_sp, B_w_out):

    def _A_ref(x, wqkv, wo):
        B, S, D = x.shape
        H = 32
        Dh = D // H
        qkv = (lambda x, *d: x.permute(*d))((x @ wqkv).reshape(B, S, 3, H, Dh), 2, 0, 3, 1, 4)
        q, k, v = (qkv[0], qkv[1], qkv[2])
        scale = Dh ** (-0.5)
        scores = torch.einsum('bhqd,bhkd->bhqk', q, k) * scale
        p = _softmax(scores, axis=-1)
        o = torch.einsum('bhqk,bhkd->bhqd', p, v)
        return (lambda x, *d: x.permute(*d))(o, 0, 2, 1, 3).reshape(B, S, D) @ wo

    def _B_ref(x, w_in, w_sp, b_sp, w_out):
        B, S, D = x.shape
        F = w_in.shape[-1]
        Fh = F // 2
        z = _gelu(torch.einsum('bsd,df->bsf', x, w_in))
        z1 = z[..., :Fh].clone()
        z2 = _layernorm(z[..., Fh:], axis=-1)
        g = torch.einsum('ts,bsf->btf', w_sp, z2) + b_sp[None, :, None]
        return torch.einsum('bsf,fd->bsd', z1 * g, w_out)
    x = A_x
    h = x + _A_ref(_layernorm(x, axis=-1), A_wqkv, A_wo)
    h2 = h + _B_ref(_layernorm(h, axis=-1), B_w_in, B_w_sp, B_b_sp, B_w_out)
    return h2
```

```asm
; @launch grid=(256,1,1) block=(256,1,1) lds=163840
.amdgcn_target "amdgcn-amd-amdhsa--gfx950"
.text
.globl sequential_preLN__softmax_full_mha__mixer_gmlp__prompt_kernel
.p2align 8
.type sequential_preLN__softmax_full_mha__mixer_gmlp__prompt_kernel,@function
sequential_preLN__softmax_full_mha__mixer_gmlp__prompt_kernel:
  s_cmp_ge_u32 s2, 256
  s_cbranch_scc1 L_exit
  s_load_dwordx2 s[4:5], s[0:1], 0
  s_load_dwordx2 s[8:9], s[0:1], 8
  s_getpc_b64 s[60:61]
L_pc:
  s_sub_u32 s60, s60, L_pc-sequential_preLN__softmax_full_mha__mixer_gmlp__prompt_kernel
  s_subb_u32 s61, s61, 0
  s_mov_b32 s62, L_code_end-sequential_preLN__softmax_full_mha__mixer_gmlp__prompt_kernel
  s_mov_b32 s63, 0x00020000
  s_lshr_b32 s56, s2, 3
  s_lshl_b32 s56, s56, 11
  v_lshlrev_b32 v250, 3, v0
  buffer_load_dwordx2 v[250:251], v250, s[60:63], s56 offen
  s_mov_b32 s6, 2097152
  s_mov_b32 s7, 0x00020000
  s_mov_b32 s10, 1572864
  s_mov_b32 s11, 0x00020000
  v_lshrrev_b32 v8, 6, v0
  v_and_b32 v0, 63, v0
  v_readfirstlane_b32 s44, v8
  s_lshr_b32 s56, s2, 3
  s_and_b32 s57, s2, 6
  s_and_b32 s58, s2, 1
  s_lshr_b32 s59, s56, 4
  s_add_u32 s40, s57, s59
  s_bfe_u32 s41, s56, 0x20002
  s_and_b32 s42, s56, 3
  s_lshl_b32 s60, s58, 2
  s_add_u32 s42, s42, s60
  s_lshr_b32 s73, s56, 2
  s_and_b32 s74, s42, 3
  s_lshl_b32 s74, s74, 1
  s_lshl_b32 s45, s40, 8
  s_lshl_b32 s56, s41, 6
  s_add_u32 s45, s45, s56
  v_lshrrev_b32 v8, 3, v0
  v_and_b32 v9, 7, v0
  v_lshrrev_b32 v10, 1, v8
  v_xor_b32 v10, v10, v9
  v_lshlrev_b32 v10, 4, v10
  v_lshl_add_u32 v10, v8, 10, v10
  s_lshl_b32 s56, s44, 4
  s_add_u32 s56, s56, s45
  s_lshl_b32 s56, s56, 10
  v_add_u32 v28, s56, v10
  v_xor_b32 v29, 64, v28
  v_add_u32 v29, 7168, v29
  v_bfe_u32 v10, v0, 4, 1
  v_lshrrev_b32 v11, 1, v9
  v_xor_b32 v11, v11, v10
  v_and_b32 v12, 1, v9
  v_lshl_or_b32 v11, v11, 1, v12
  v_lshlrev_b32 v11, 4, v11
  v_mul_u32_u24 v12, 3072, v8
  v_add_u32 v12, v12, v11
  s_mul_i32 s56, s44, 49152
  s_lshl_b32 s57, s42, 7
  s_add_u32 s56, s56, s57
  v_add_u32 v30, s56, v12
  v_xor_b32 v31, 64, v30
  v_add_u32 v31, 23552, v31
  s_lshl_b32 s72, s44, 11
  s_add_u32 s74, s74, s73
  s_and_b32 s74, s73, 1
  s_lshl_b32 s74, s74, 2
  s_waitcnt lgkmcnt(0)
  s_add_u32 s57, s74, 0
  s_and_b32 s57, s57, 7
  s_lshl_b32 s58, s57, 7
  s_add_u32 m0, s72, 98304
  s_nop 0
  buffer_load_dwordx4 v28, s[4:7], s58 offen lds
  buffer_load_dwordx4 v29, s[4:7], s58 offen offset:1024 lds
  s_mul_i32 s57, s57, 196608
  s_add_u32 s58, s57, 0
  s_add_u32 m0, s72, 0
  s_nop 0
  buffer_load_dwordx4 v30, s[8:11], s58 offen lds
  buffer_load_dwordx4 v31, s[8:11], s58 offen offset:1024 lds
  s_add_u32 s58, s57, 1024
  s_add_u32 m0, s72, 8192
  s_nop 0
  buffer_load_dwordx4 v30, s[8:11], s58 offen lds
  buffer_load_dwordx4 v31, s[8:11], s58 offen offset:1024 lds
  s_add_u32 s58, s57, 2048
  s_add_u32 m0, s72, 16384
  s_nop 0
  buffer_load_dwordx4 v30, s[8:11], s58 offen lds
  buffer_load_dwordx4 v31, s[8:11], s58 offen offset:1024 lds
  s_load_dwordx2 s[36:37], s[0:1], 80
  s_load_dwordx2 s[12:13], s[0:1], 16
  s_load_dwordx2 s[16:17], s[0:1], 32
  s_load_dwordx2 s[20:21], s[0:1], 40
  s_load_dwordx2 s[24:25], s[0:1], 48
  s_load_dwordx2 s[28:29], s[0:1], 56
  s_load_dwordx2 s[32:33], s[0:1], 64
  s_mov_b32 s38, 20971520
  s_mov_b32 s39, 0x00020000
  s_mov_b32 s14, 524288
  s_mov_b32 s15, 0x00020000
  s_mov_b32 s18, 1409024
  s_mov_b32 s19, 0x00020000
  s_mov_b32 s22, 8388608
  s_mov_b32 s23, 0x00020000
  s_mov_b32 s26, 4096
  s_mov_b32 s27, 0x00020000
  s_mov_b32 s30, 704512
  s_mov_b32 s31, 0x00020000
  s_mov_b32 s34, 2097152
  s_mov_b32 s35, 0x00020000
  s_bfe_u32 s43, s2, 0x40003
  s_and_b32 s60, s2, 1
  s_lshl_b32 s60, s60, 4
  s_add_u32 s43, s43, s60
  s_lshr_b32 s46, s44, 1
  s_and_b32 s47, s44, 1
  s_lshl_b32 s54, s40, 2
  s_add_u32 s54, s54, s41
  s_mov_b32 s52, 0x3f803f80
  s_mov_b32 s53, 0xffff0000
  s_mul_i32 s56, s42, 5
  s_min_u32 s57, s42, 3
  s_add_u32 s48, s56, s57
  s_cmp_ge_u32 s42, 3
  s_cselect_b32 s49, 1, 0
  v_lshlrev_b32 v1, 4, v0
  v_mov_b32 v3, 0
  v_and_b32 v8, 15, v0
  v_lshrrev_b32 v9, 5, v0
  v_bfe_u32 v10, v0, 4, 1
  v_lshlrev_b32 v8, 4, v8
  v_lshl_add_u32 v8, v10, 3, v8
  v_lshl_add_u32 v2, v9, 8, v8
  v_lshl_add_u32 v63, v9, 9, v8
  v_and_b32 v6, 31, v0
  v_lshlrev_b32 v6, 7, v6
  v_and_b32 v7, 7, v0
  v_lshlrev_b32 v7, 3, v7
  v_lshrrev_b32 v10, 4, v0
  v_bfe_u32 v11, v0, 2, 2
  v_and_b32 v12, 3, v0
  v_lshl_add_u32 v13, v10, 3, v11
  v_lshlrev_b32 v13, 7, v13
  v_lshl_add_u32 v13, v12, 3, v13
  v_lshrrev_b32 v11, 1, v11
  v_and_b32 v14, 1, v10
  v_lshl_or_b32 v11, v14, 1, v11
  v_xor_b32 v11, s44, v11
  v_lshl_add_u32 v32, v11, 5, v13
  v_add_u32 v33, 49152, v32
  v_and_b32 v11, 15, v0
  v_lshrrev_b32 v12, 1, v11
  v_xor_b32 v12, v12, v10
  v_lshlrev_b32 v12, 4, v12
  v_lshl_add_u32 v12, v11, 7, v12
  s_add_u32 s56, s72, 98304
  v_add_u32 v34, s56, v12
  v_xor_b32 v35, 64, v34
  v_xor_b32 v36, 2048, v34
  v_xor_b32 v37, 2112, v34
  v_xor_b32 v38, 4096, v34
  v_xor_b32 v39, 4160, v34
  v_xor_b32 v40, 6144, v34
  v_xor_b32 v41, 6208, v34
  v_mov_b32 v252, s52
  v_mov_b32 v253, s52
  v_mov_b32 v254, s52
  v_mov_b32 v255, s52
  v_and_b32 v16, 15, v0
  v_lshrrev_b32 v17, 4, v0
  v_and_b32 v20, 3, v0
  v_lshrrev_b32 v21, 2, v16
  s_lshl_b32 s56, s44, 6
  s_add_u32 s56, s56, 65536
  v_cmp_eq_u32 vcc, v17, v21
  s_nop 1
  v_cndmask_b32_e64 v21, 0, -1, vcc
  v_lshlrev_b32 v16, 2, v16
  v_add_u32 v16, s56, v16
  v_lshlrev_b32 v18, 4, v17
  v_add_u32 v18, s56, v18
  v_and_b32 v17, 1, v17
  v_lshl_add_u32 v19, v17, 8, v16
  s_and_b32 s62, s44, 1
  s_lshl_b32 s62, s62, 8
  s_lshr_b32 s63, s44, 1
  s_lshl_b32 s63, s63, 10
  s_or_b32 s62, s62, s63
  v_or_b32 v42, s62, v63
  s_lshl_b32 s62, s44, 9
  v_or_b32 v46, s62, v2
  v_mov_b32 v22, 0x3eb8aa3b
  v_mov_b32 v23, 0x3eb8aa3b
  s_add_u32 s57, s74, 1
  s_and_b32 s57, s57, 7
  s_lshl_b32 s58, s57, 7
  s_add_u32 m0, s72, 106496
  s_nop 0
  buffer_load_dwordx4 v28, s[4:7], s58 offen lds
  buffer_load_dwordx4 v29, s[4:7], s58 offen offset:1024 lds
  s_mul_i32 s57, s57, 196608
  s_add_u32 s58, s57, 0
  s_add_u32 m0, s72, 24576
  s_nop 0
  buffer_load_dwordx4 v30, s[8:11], s58 offen lds
  buffer_load_dwordx4 v31, s[8:11], s58 offen offset:1024 lds
  s_add_u32 s58, s57, 1024
  s_add_u32 m0, s72, 32768
  s_nop 0
  buffer_load_dwordx4 v30, s[8:11], s58 offen lds
  buffer_load_dwordx4 v31, s[8:11], s58 offen offset:1024 lds
  s_add_u32 s58, s57, 2048
  s_add_u32 m0, s72, 40960
  s_nop 0
  buffer_load_dwordx4 v30, s[8:11], s58 offen lds
  buffer_load_dwordx4 v31, s[8:11], s58 offen offset:1024 lds
  v_xor_b32 v43, 256, v42
  v_xor_b32 v47, 512, v46
  v_xor_b32 v44, 1024, v42
  v_xor_b32 v48, 1024, v46
  v_xor_b32 v45, 1280, v42
  v_xor_b32 v49, 1536, v46
  s_lshl_b32 s60, s42, 2
  s_add_u32 s60, s60, s44
  s_lshl_b32 s77, s60, 16
  s_lshl_b32 s59, s45, 5
  s_add_u32 s77, s77, s59
  s_add_u32 s77, s77, 1048576
  s_lshl_b32 s78, s60, 17
  s_lshl_b32 s59, s45, 6
  s_add_u32 s78, s78, s59
  s_add_u32 s78, s78, 3145728
  s_add_u32 s79, s78, 2048
  s_lshl_b32 s56, s41, 5
  s_add_u32 s56, s56, s60
  s_lshl_b32 s56, s56, 7
  s_lshl_b32 s60, s40, 3
  s_add_u32 s56, s56, s60
  s_add_u32 s80, s56, 4096
  s_waitcnt lgkmcnt(0)
  s_mov_b32 s1, s73
  buffer_load_dwordx2 v[4:5], off, s[36:39], 0 sc1
  s_add_u32 s57, s74, 2
  s_and_b32 s57, s57, 7
  s_lshl_b32 s58, s57, 7
  s_add_u32 m0, s72, 114688
  s_nop 0
  buffer_load_dwordx4 v28, s[4:7], s58 offen lds
  buffer_load_dwordx4 v29, s[4:7], s58 offen offset:1024 lds
  s_mul_i32 s57, s57, 196608
  s_add_u32 s58, s57, 0
  s_add_u32 m0, s72, 49152
  s_nop 0
  buffer_load_dwordx4 v30, s[8:11], s58 offen lds
  buffer_load_dwordx4 v31, s[8:11], s58 offen offset:1024 lds
  s_add_u32 s58, s57, 1024
  s_add_u32 m0, s72, 57344
  s_nop 0
  buffer_load_dwordx4 v30, s[8:11], s58 offen lds
  buffer_load_dwordx4 v31, s[8:11], s58 offen offset:1024 lds
  s_add_u32 s58, s57, 2048
  s_add_u32 m0, s72, 65536
  s_nop 0
  buffer_load_dwordx4 v30, s[8:11], s58 offen lds
  buffer_load_dwordx4 v31, s[8:11], s58 offen offset:1024 lds
  s_waitcnt vmcnt(17)
  s_barrier
  ds_read_b64_tr_b16 v[112:113], v32 offset:0
  ds_read_b64_tr_b16 v[114:115], v32 offset:512
  ds_read_b128 v[64:67], v34 offset:0
  ds_read_b128 v[68:71], v36 offset:0
  ds_read_b128 v[72:75], v38 offset:0
  ds_read_b128 v[76:79], v40 offset:0
  ds_read_b64_tr_b16 v[116:117], v32 offset:8192
  ds_read_b64_tr_b16 v[118:119], v32 offset:8704
  ds_read_b64_tr_b16 v[120:121], v32 offset:16384
  ds_read_b64_tr_b16 v[122:123], v32 offset:16896
  ds_read_b64_tr_b16 v[176:177], v32 offset:4096
  ds_read_b64_tr_b16 v[178:179], v32 offset:4608
  ds_read_b128 v[80:83], v35 offset:0
  ds_read_b128 v[84:87], v37 offset:0
  ds_read_b128 v[88:91], v39 offset:0
  ds_read_b128 v[92:95], v41 offset:0
  ds_read_b64_tr_b16 v[180:181], v32 offset:12288
  ds_read_b64_tr_b16 v[182:183], v32 offset:12800
  ds_read_b64_tr_b16 v[184:185], v32 offset:20480
  ds_read_b64_tr_b16 v[186:187], v32 offset:20992
  s_waitcnt lgkmcnt(10)
  s_waitcnt vmcnt(9)
  s_barrier
  v_mfma_f32_16x16x32_bf16 v[128:131], v[112:115], v[64:67], 0
  ds_read_b64_tr_b16 v[188:189], v32 offset:24576
  ds_read_b64_tr_b16 v[190:191], v32 offset:25088
  v_mfma_f32_16x16x32_bf16 v[132:135], v[112:115], v[68:71], 0
  ds_read_b128 v[96:99], v34 offset:8192
  ds_read_b128 v[100:103], v36 offset:8192
  v_mfma_f32_16x16x32_bf16 v[136:139], v[112:115], v[72:75], 0
  ds_read_b128 v[104:107], v38 offset:8192
  ds_read_b128 v[108:111], v40 offset:8192
  v_mfma_f32_16x16x32_bf16 v[140:143], v[112:115], v[76:79], 0
  ds_read_b64_tr_b16 v[192:193], v32 offset:32768
  ds_read_b64_tr_b16 v[194:195], v32 offset:33280
  v_mfma_f32_16x16x32_bf16 v[124:127], v[112:115], v[252:255], 0
  ds_read_b64_tr_b16 v[196:197], v32 offset:40960
  ds_read_b64_tr_b16 v[198:199], v32 offset:41472
  v_mfma_f32_16x16x32_bf16 v[8:11], v[252:255], v[64:67], 0
  v_mfma_f32_16x16x32_bf16 v[144:147], v[116:119], v[64:67], 0
  v_mfma_f32_16x16x32_bf16 v[148:151], v[116:119], v[68:71], 0
  v_mfma_f32_16x16x32_bf16 v[152:155], v[116:119], v[72:75], 0
  v_mfma_f32_16x16x32_bf16 v[156:159], v[116:119], v[76:79], 0
  v_mfma_f32_16x16x32_bf16 v[200:203], v[116:119], v[252:255], 0
  v_mfma_f32_16x16x32_bf16 v[24:27], v[64:67], v[64:67], 0
  v_mfma_f32_16x16x32_bf16 v[160:163], v[64:67], v[120:123], 0
  v_mfma_f32_16x16x32_bf16 v[164:167], v[68:71], v[120:123], 0
  s_add_u32 s57, s74, 3
  s_and_b32 s57, s57, 7
  s_lshl_b32 s58, s57, 7
  s_add_u32 m0, s72, 122880
  s_nop 0
  buffer_load_dwordx4 v28, s[4:7], s58 offen lds
  v_mfma_f32_16x16x32_bf16 v[168:171], v[72:75], v[120:123], 0
  buffer_load_dwordx4 v29, s[4:7], s58 offen offset:1024 lds
  v_mfma_f32_16x16x32_bf16 v[172:175], v[76:79], v[120:123], 0
  s_mul_i32 s57, s57, 196608
  s_add_u32 s58, s57, 0
  s_add_u32 m0, s72, 73728
  s_nop 0
  buffer_load_dwordx4 v30, s[8:11], s58 offen lds
  v_mfma_f32_16x16x32_bf16 v[204:207], v[252:255], v[120:123], 0
  buffer_load_dwordx4 v31, s[8:11], s58 offen offset:1024 lds
  s_waitcnt lgkmcnt(10)
  v_mfma_f32_16x16x32_bf16 v[128:131], v[176:179], v[80:83], v[128:131]
  ds_read_b64_tr_b16 v[112:113], v32 offset:28672
  ds_read_b64_tr_b16 v[114:115], v32 offset:29184
  v_mfma_f32_16x16x32_bf16 v[132:135], v[176:179], v[84:87], v[132:135]
  ds_read_b128 v[64:67], v35 offset:8192
  ds_read_b128 v[68:71], v37 offset:8192
  v_mfma_f32_16x16x32_bf16 v[136:139], v[176:179], v[88:91], v[136:139]
  ds_read_b128 v[72:75], v39 offset:8192
  ds_read_b128 v[76:79], v41 offset:8192
  v_mfma_f32_16x16x32_bf16 v[140:143], v[176:179], v[92:95], v[140:143]
  ds_read_b64_tr_b16 v[116:117], v32 offset:36864
  ds_read_b64_tr_b16 v[118:119], v32 offset:37376
  v_mfma_f32_16x16x32_bf16 v[124:127], v[176:179], v[252:255], v[124:127]
  ds_read_b64_tr_b16 v[120:121], v32 offset:45056
  ds_read_b64_tr_b16 v[122:123], v32 offset:45568
  v_mfma_f32_16x16x32_bf16 v[8:11], v[252:255], v[80:83], v[8:11]
  v_mfma_f32_16x16x32_bf16 v[144:147], v[180:183], v[80:83], v[144:147]
  v_mfma_f32_16x16x32_bf16 v[148:151], v[180:183], v[84:87], v[148:151]
  v_mfma_f32_16x16x32_bf16 v[152:155], v[180:183], v[88:91], v[152:155]
  v_mfma_f32_16x16x32_bf16 v[156:159], v[180:183], v[92:95], v[156:159]
  v_mfma_f32_16x16x32_bf16 v[200:203], v[180:183], v[252:255], v[200:203]
  v_mfma_f32_16x16x32_bf16 v[24:27], v[80:83], v[80:83], v[24:27]
  v_mfma_f32_16x16x32_bf16 v[160:163], v[80:83], v[184:187], v[160:163]
  v_mfma_f32_16x16x32_bf16 v[164:167], v[84:87], v[184:187], v[164:167]
  s_add_u32 s58, s57, 1024
  s_add_u32 m0, s72, 81920
  s_nop 0
  buffer_load_dwordx4 v30, s[8:11], s58 offen lds
  v_mfma_f32_16x16x32_bf16 v[168:171], v[88:91], v[184:187], v[168:171]
  buffer_load_dwordx4 v31, s[8:11], s58 offen offset:1024 lds
  v_mfma_f32_16x16x32_bf16 v[172:175], v[92:95], v[184:187], v[172:175]
  s_add_u32 s58, s57, 2048
  s_add_u32 m0, s72, 90112
  s_nop 0
  buffer_load_dwordx4 v30, s[8:11], s58 offen lds
  v_mfma_f32_16x16x32_bf16 v[204:207], v[252:255], v[184:187], v[204:207]
  buffer_load_dwordx4 v31, s[8:11], s58 offen offset:1024 lds
  s_waitcnt lgkmcnt(10)
  s_waitcnt vmcnt(8)
  s_barrier
  v_mfma_f32_16x16x32_bf16 v[128:131], v[188:191], v[96:99], v[128:131]
  ds_read_b64_tr_b16 v[176:177], v33 offset:0
  ds_read_b64_tr_b16 v[178:179], v33 offset:512
  v_mfma_f32_16x16x32_bf16 v[132:135], v[188:191], v[100:103], v[132:135]
  ds_read_b128 v[80:83], v34 offset:16384
  ds_read_b128 v[84:87], v36 offset:16384
  v_mfma_f32_16x16x32_bf16 v[136:139], v[188:191], v[104:107], v[136:139]
  ds_read_b128 v[88:91], v38 offset:16384
  ds_read_b128 v[92:95], v40 offset:16384
  v_mfma_f32_16x16x32_bf16 v[140:143], v[188:191], v[108:111], v[140:143]
  ds_read_b64_tr_b16 v[180:181], v33 offset:8192
  ds_read_b64_tr_b16 v[182:183], v33 offset:8704
  v_mfma_f32_16x16x32_bf16 v[124:127], v[188:191], v[252:255], v[124:127]
  ds_read_b64_tr_b16 v[184:185], v33 offset:16384
  ds_read_b64_tr_b16 v[186:187], v33 offset:16896
  v_mfma_f32_16x16x32_bf16 v[8:11], v[252:255], v[96:99], v[8:11]
  v_mfma_f32_16x16x32_bf16 v[144:147], v[192:195], v[96:99], v[144:147]
  v_mfma_f32_16x16x32_bf16 v[148:151], v[192:195], v[100:103], v[148:151]
  v_mfma_f32_16x16x32_bf16 v[152:155], v[192:195], v[104:107], v[152:155]
  v_mfma_f32_16x16x32_bf16 v[156:159], v[192:195], v[108:111], v[156:159]
  v_mfma_f32_16x16x32_bf16 v[200:203], v[192:195], v[252:255], v[200:203]
  v_mfma_f32_16x16x32_bf16 v[24:27], v[96:99], v[96:99], v[24:27]
  v_mfma_f32_16x16x32_bf16 v[160:163], v[96:99], v[196:199], v[160:163]
  v_mfma_f32_16x16x32_bf16 v[164:167], v[100:103], v[196:199], v[164:167]
  s_add_u32 s57, s74, 4
  s_and_b32 s57, s57, 7
  s_lshl_b32 s58, s57, 7
  s_add_u32 m0, s72, 131072
  s_nop 0
  buffer_load_dwordx4 v28, s[4:7], s58 offen lds
  v_mfma_f32_16x16x32_bf16 v[168:171], v[104:107], v[196:199], v[168:171]
  buffer_load_dwordx4 v29, s[4:7], s58 offen offset:1024 lds
  v_mfma_f32_16x16x32_bf16 v[172:175], v[108:111], v[196:199], v[172:175]
  s_mul_i32 s57, s57, 196608
  s_add_u32 s58, s57, 0
  s_add_u32 m0, s72, 0
  s_nop 0
  buffer_load_dwordx4 v30, s[8:11], s58 offen lds
  v_mfma_f32_16x16x32_bf16 v[204:207], v[252:255], v[196:199], v[204:207]
  buffer_load_dwordx4 v31, s[8:11], s58 offen offset:1024 lds
  s_waitcnt lgkmcnt(10)
  v_mfma_f32_16x16x32_bf16 v[128:131], v[112:115], v[64:67], v[128:131]
  ds_read_b64_tr_b16 v[188:189], v33 offset:4096
  ds_read_b64_tr_b16 v[190:191], v33 offset:4608
  v_mfma_f32_16x16x32_bf16 v[132:135], v[112:115], v[68:71], v[132:135]
  ds_read_b128 v[96:99], v35 offset:16384
  ds_read_b128 v[100:103], v37 offset:16384
  v_mfma_f32_16x16x32_bf16 v[136:139], v[112:115], v[72:75], v[136:139]
  ds_read_b128 v[104:107], v39 offset:16384
  ds_read_b128 v[108:111], v41 offset:16384
  v_mfma_f32_16x16x32_bf16 v[140:143], v[112:115], v[76:79], v[140:143]
  ds_read_b64_tr_b16 v[192:193], v33 offset:12288
  ds_read_b64_tr_b16 v[194:195], v33 offset:12800
  v_mfma_f32_16x16x32_bf16 v[124:127], v[112:115], v[252:255], v[124:127]
  ds_read_b64_tr_b16 v[196:197], v33 offset:20480
  ds_read_b64_tr_b16 v[198:199], v33 offset:20992
  v_mfma_f32_16x16x32_bf16 v[8:11], v[252:255], v[64:67], v[8:11]
  v_mfma_f32_16x16x32_bf16 v[144:147], v[116:119], v[64:67], v[144:147]
  v_mfma_f32_16x16x32_bf16 v[148:151], v[116:119], v[68:71], v[148:151]
  v_mfma_f32_16x16x32_bf16 v[152:155], v[116:119], v[72:75], v[152:155]
  v_mfma_f32_16x16x32_bf16 v[156:159], v[116:119], v[76:79], v[156:159]
  v_mfma_f32_16x16x32_bf16 v[200:203], v[116:119], v[252:255], v[200:203]
  v_mfma_f32_16x16x32_bf16 v[24:27], v[64:67], v[64:67], v[24:27]
  v_mfma_f32_16x16x32_bf16 v[160:163], v[64:67], v[120:123], v[160:163]
  v_mfma_f32_16x16x32_bf16 v[164:167], v[68:71], v[120:123], v[164:167]
  s_add_u32 s58, s57, 1024
  s_add_u32 m0, s72, 8192
  s_nop 0
  buffer_load_dwordx4 v30, s[8:11], s58 offen lds
  v_mfma_f32_16x16x32_bf16 v[168:171], v[72:75], v[120:123], v[168:171]
  buffer_load_dwordx4 v31, s[8:11], s58 offen offset:1024 lds
  v_mfma_f32_16x16x32_bf16 v[172:175], v[76:79], v[120:123], v[172:175]
  s_add_u32 s58, s57, 2048
  s_add_u32 m0, s72, 16384
  s_nop 0
  buffer_load_dwordx4 v30, s[8:11], s58 offen lds
  v_mfma_f32_16x16x32_bf16 v[204:207], v[252:255], v[120:123], v[204:207]
  buffer_load_dwordx4 v31, s[8:11], s58 offen offset:1024 lds
  s_waitcnt lgkmcnt(10)
  s_waitcnt vmcnt(8)
  s_barrier
  v_mfma_f32_16x16x32_bf16 v[128:131], v[176:179], v[80:83], v[128:131]
  ds_read_b64_tr_b16 v[112:113], v33 offset:24576
  ds_read_b64_tr_b16 v[114:115], v33 offset:25088
  v_mfma_f32_16x16x32_bf16 v[132:135], v[176:179], v[84:87], v[132:135]
  ds_read_b128 v[64:67], v34 offset:24576
  ds_read_b128 v[68:71], v36 offset:24576
  v_mfma_f32_16x16x32_bf16 v[136:139], v[176:179], v[88:91], v[136:139]
  ds_read_b128 v[72:75], v38 offset:24576
  ds_read_b128 v[76:79], v40 offset:24576
  v_mfma_f32_16x16x32_bf16 v[140:143], v[176:179], v[92:95], v[140:143]
  ds_read_b64_tr_b16 v[116:117], v33 offset:32768
  ds_read_b64_tr_b16 v[118:119], v33 offset:33280
  v_mfma_f32_16x16x32_bf16 v[124:127], v[176:179], v[252:255], v[124:127]
  ds_read_b64_tr_b16 v[120:121], v33 offset:40960
  ds_read_b64_tr_b16 v[122:123], v33 offset:41472
  v_mfma_f32_16x16x32_bf16 v[8:11], v[252:255], v[80:83], v[8:11]
  v_mfma_f32_16x16x32_bf16 v[144:147], v[180:183], v[80:83], v[144:147]
  v_mfma_f32_16x16x32_bf16 v[148:151], v[180:183], v[84:87], v[148:151]
  v_mfma_f32_16x16x32_bf16 v[152:155], v[180:183], v[88:91], v[152:155]
  v_mfma_f32_16x16x32_bf16 v[156:159], v[180:183], v[92:95], v[156:159]
  v_mfma_f32_16x16x32_bf16 v[200:203], v[180:183], v[252:255], v[200:203]
  v_mfma_f32_16x16x32_bf16 v[24:27], v[80:83], v[80:83], v[24:27]
  v_mfma_f32_16x16x32_bf16 v[160:163], v[80:83], v[184:187], v[160:163]
  v_mfma_f32_16x16x32_bf16 v[164:167], v[84:87], v[184:187], v[164:167]
  s_add_u32 s57, s74, 5
  s_and_b32 s57, s57, 7
  s_lshl_b32 s58, s57, 7
  s_add_u32 m0, s72, 139264
  s_nop 0
  buffer_load_dwordx4 v28, s[4:7], s58 offen lds
  v_mfma_f32_16x16x32_bf16 v[168:171], v[88:91], v[184:187], v[168:171]
  buffer_load_dwordx4 v29, s[4:7], s58 offen offset:1024 lds
  v_mfma_f32_16x16x32_bf16 v[172:175], v[92:95], v[184:187], v[172:175]
  s_mul_i32 s57, s57, 196608
  s_add_u32 s58, s57, 0
  s_add_u32 m0, s72, 24576
  s_nop 0
  buffer_load_dwordx4 v30, s[8:11], s58 offen lds
  v_mfma_f32_16x16x32_bf16 v[204:207], v[252:255], v[184:187], v[204:207]
  buffer_load_dwordx4 v31, s[8:11], s58 offen offset:1024 lds
  s_waitcnt lgkmcnt(10)
  v_mfma_f32_16x16x32_bf16 v[128:131], v[188:191], v[96:99], v[128:131]
  ds_read_b64_tr_b16 v[176:177], v33 offset:28672
  ds_read_b64_tr_b16 v[178:179], v33 offset:29184
  v_mfma_f32_16x16x32_bf16 v[132:135], v[188:191], v[100:103], v[132:135]
  ds_read_b128 v[80:83], v35 offset:24576
  ds_read_b128 v[84:87], v37 offset:24576
  v_mfma_f32_16x16x32_bf16 v[136:139], v[188:191], v[104:107], v[136:139]
  ds_read_b128 v[88:91], v39 offset:24576
  ds_read_b128 v[92:95], v41 offset:24576
  v_mfma_f32_16x16x32_bf16 v[140:143], v[188:191], v[108:111], v[140:143]
  ds_read_b64_tr_b16 v[180:181], v33 offset:36864
  ds_read_b64_tr_b16 v[182:183], v33 offset:37376
  v_mfma_f32_16x16x32_bf16 v[124:127], v[188:191], v[252:255], v[124:127]
  ds_read_b64_tr_b16 v[184:185], v33 offset:45056
  ds_read_b64_tr_b16 v[186:187], v33 offset:45568
  v_mfma_f32_16x16x32_bf16 v[8:11], v[252:255], v[96:99], v[8:11]
  v_mfma_f32_16x16x32_bf16 v[144:147], v[192:195], v[96:99], v[144:147]
  v_mfma_f32_16x16x32_bf16 v[148:151], v[192:195], v[100:103], v[148:151]
  v_mfma_f32_16x16x32_bf16 v[152:155], v[192:195], v[104:107], v[152:155]
  v_mfma_f32_16x16x32_bf16 v[156:159], v[192:195], v[108:111], v[156:159]
  v_mfma_f32_16x16x32_bf16 v[200:203], v[192:195], v[252:255], v[200:203]
  v_mfma_f32_16x16x32_bf16 v[24:27], v[96:99], v[96:99], v[24:27]
  v_mfma_f32_16x16x32_bf16 v[160:163], v[96:99], v[196:199], v[160:163]
  v_mfma_f32_16x16x32_bf16 v[164:167], v[100:103], v[196:199], v[164:167]
  s_add_u32 s58, s57, 1024
  s_add_u32 m0, s72, 32768
  s_nop 0
  buffer_load_dwordx4 v30, s[8:11], s58 offen lds
  v_mfma_f32_16x16x32_bf16 v[168:171], v[104:107], v[196:199], v[168:171]
  buffer_load_dwordx4 v31, s[8:11], s58 offen offset:1024 lds
  v_mfma_f32_16x16x32_bf16 v[172:175], v[108:111], v[196:199], v[172:175]
  s_add_u32 s58, s57, 2048
  s_add_u32 m0, s72, 40960
  s_nop 0
  buffer_load_dwordx4 v30, s[8:11], s58 offen lds
  v_mfma_f32_16x16x32_bf16 v[204:207], v[252:255], v[196:199], v[204:207]
  buffer_load_dwordx4 v31, s[8:11], s58 offen offset:1024 lds
  s_waitcnt lgkmcnt(10)
  s_waitcnt vmcnt(8)
  s_barrier
  v_mfma_f32_16x16x32_bf16 v[128:131], v[112:115], v[64:67], v[128:131]
  ds_read_b64_tr_b16 v[188:189], v32 offset:0
  ds_read_b64_tr_b16 v[190:191], v32 offset:512
  v_mfma_f32_16x16x32_bf16 v[132:135], v[112:115], v[68:71], v[132:135]
  ds_read_b128 v[96:99], v34 offset:32768
  ds_read_b128 v[100:103], v36 offset:32768
  v_mfma_f32_16x16x32_bf16 v[136:139], v[112:115], v[72:75], v[136:139]
  ds_read_b128 v[104:107], v38 offset:32768
  ds_read_b128 v[108:111], v40 offset:32768
  v_mfma_f32_16x16x32_bf16 v[140:143], v[112:115], v[76:79], v[140:143]
  ds_read_b64_tr_b16 v[192:193], v32 offset:8192
  ds_read_b64_tr_b16 v[194:195], v32 offset:8704
  v_mfma_f32_16x16x32_bf16 v[124:127], v[112:115], v[252:255], v[124:127]
  ds_read_b64_tr_b16 v[196:197], v32 offset:16384
  ds_read_b64_tr_b16 v[198:199], v32 offset:16896
  v_mfma_f32_16x16x32_bf16 v[8:11], v[252:255], v[64:67], v[8:11]
  v_mfma_f32_16x16x32_bf16 v[144:147], v[116:119], v[64:67], v[144:147]
  v_mfma_f32_16x16x32_bf16 v[148:151], v[116:119], v[68:71], v[148:151]
  v_mfma_f32_16x16x32_bf16 v[152:155], v[116:119], v[72:75], v[152:155]
  v_mfma_f32_16x16x32_bf16 v[156:159], v[116:119], v[76:79], v[156:159]
  v_mfma_f32_16x16x32_bf16 v[200:203], v[116:119], v[252:255], v[200:203]
  v_mfma_f32_16x16x32_bf16 v[24:27], v[64:67], v[64:67], v[24:27]
  v_mfma_f32_16x16x32_bf16 v[160:163], v[64:67], v[120:123], v[160:163]
  v_mfma_f32_16x16x32_bf16 v[164:167], v[68:71], v[120:123], v[164:167]
  s_add_u32 s57, s74, 6
  s_and_b32 s57, s57, 7
  s_lshl_b32 s58, s57, 7
  s_add_u32 m0, s72, 147456
  s_nop 0
  buffer_load_dwordx4 v28, s[4:7], s58 offen lds
  v_mfma_f32_16x16x32_bf16 v[168:171], v[72:75], v[120:123], v[168:171]
  buffer_load_dwordx4 v29, s[4:7], s58 offen offset:1024 lds
  v_mfma_f32_16x16x32_bf16 v[172:175], v[76:79], v[120:123], v[172:175]
  s_mul_i32 s57, s57, 196608
  s_add_u32 s58, s57, 0
  s_add_u32 m0, s72, 49152
  s_nop 0
  buffer_load_dwordx4 v30, s[8:11], s58 offen lds
  v_mfma_f32_16x16x32_bf16 v[204:207], v[252:255], v[120:123], v[204:207]
  buffer_load_dwordx4 v31, s[8:11], s58 offen offset:1024 lds
  s_waitcnt lgkmcnt(10)
  v_mfma_f32_16x16x32_bf16 v[128:131], v[176:179], v[80:83], v[128:131]
  ds_read_b64_tr_b16 v[112:113], v32 offset:4096
  ds_read_b64_tr_b16 v[114:115], v32 offset:4608
  v_mfma_f32_16x16x32_bf16 v[132:135], v[176:179], v[84:87], v[132:135]
  ds_read_b128 v[64:67], v35 offset:32768
  ds_read_b128 v[68:71], v37 offset:32768
  v_mfma_f32_16x16x32_bf16 v[136:139], v[176:179], v[88:91], v[136:139]
  ds_read_b128 v[72:75], v39 offset:32768
  ds_read_b128 v[76:79], v41 offset:32768
  v_mfma_f32_16x16x32_bf16 v[140:143], v[176:179], v[92:95], v[140:143]
  ds_read_b64_tr_b16 v[116:117], v32 offset:12288
  ds_read_b64_tr_b16 v[118:119], v32 offset:12800
  v_mfma_f32_16x16x32_bf16 v[124:127], v[176:179], v[252:255], v[124:127]
  ds_read_b64_tr_b16 v[120:121], v32 offset:20480
  ds_read_b64_tr_b16 v[122:123], v32 offset:20992
  v_mfma_f32_16x16x32_bf16 v[8:11], v[252:255], v[80:83], v[8:11]
  v_mfma_f32_16x16x32_bf16 v[144:147], v[180:183], v[80:83], v[144:147]
  v_mfma_f32_16x16x32_bf16 v[148:151], v[180:183], v[84:87], v[148:151]
  v_mfma_f32_16x16x32_bf16 v[152:155], v[180:183], v[88:91], v[152:155]
  v_mfma_f32_16x16x32_bf16 v[156:159], v[180:183], v[92:95], v[156:159]
  v_mfma_f32_16x16x32_bf16 v[200:203], v[180:183], v[252:255], v[200:203]
  v_mfma_f32_16x16x32_bf16 v[24:27], v[80:83], v[80:83], v[24:27]
  v_mfma_f32_16x16x32_bf16 v[160:163], v[80:83], v[184:187], v[160:163]
  v_mfma_f32_16x16x32_bf16 v[164:167], v[84:87], v[184:187], v[164:167]
  s_add_u32 s58, s57, 1024
  s_add_u32 m0, s72, 57344
  s_nop 0
  buffer_load_dwordx4 v30, s[8:11], s58 offen lds
  v_mfma_f32_16x16x32_bf16 v[168:171], v[88:91], v[184:187], v[168:171]
  buffer_load_dwordx4 v31, s[8:11], s58 offen offset:1024 lds
  v_mfma_f32_16x16x32_bf16 v[172:175], v[92:95], v[184:187], v[172:175]
  s_add_u32 s58, s57, 2048
  s_add_u32 m0, s72, 65536
  s_nop 0
  buffer_load_dwordx4 v30, s[8:11], s58 offen lds
  v_mfma_f32_16x16x32_bf16 v[204:207], v[252:255], v[184:187], v[204:207]
  buffer_load_dwordx4 v31, s[8:11], s58 offen offset:1024 lds
  s_waitcnt lgkmcnt(10)
  s_waitcnt vmcnt(8)
  s_barrier
  v_mfma_f32_16x16x32_bf16 v[128:131], v[188:191], v[96:99], v[128:131]
  ds_read_b64_tr_b16 v[176:177], v32 offset:24576
  ds_read_b64_tr_b16 v[178:179], v32 offset:25088
  v_mfma_f32_16x16x32_bf16 v[132:135], v[188:191], v[100:103], v[132:135]
  ds_read_b128 v[80:83], v34 offset:40960
  ds_read_b128 v[84:87], v36 offset:40960
  v_mfma_f32_16x16x32_bf16 v[136:139], v[188:191], v[104:107], v[136:139]
  ds_read_b128 v[88:91], v38 offset:40960
  ds_read_b128 v[92:95], v40 offset:40960
  v_mfma_f32_16x16x32_bf16 v[140:143], v[188:191], v[108:111], v[140:143]
  ds_read_b64_tr_b16 v[180:181], v32 offset:32768
  ds_read_b64_tr_b16 v[182:183], v32 offset:33280
  v_mfma_f32_16x16x32_bf16 v[124:127], v[188:191], v[252:255], v[124:127]
  ds_read_b64_tr_b16 v[184:185], v32 offset:40960
  ds_read_b64_tr_b16 v[186:187], v32 offset:41472
  v_mfma_f32_16x16x32_bf16 v[8:11], v[252:255], v[96:99], v[8:11]
  v_mfma_f32_16x16x32_bf16 v[144:147], v[192:195], v[96:99], v[144:147]
  v_mfma_f32_16x16x32_bf16 v[148:151], v[192:195], v[100:103], v[148:151]
  v_mfma_f32_16x16x32_bf16 v[152:155], v[192:195], v[104:107], v[152:155]
  v_mfma_f32_16x16x32_bf16 v[156:159], v[192:195], v[108:111], v[156:159]
  v_mfma_f32_16x16x32_bf16 v[200:203], v[192:195], v[252:255], v[200:203]
  v_mfma_f32_16x16x32_bf16 v[24:27], v[96:99], v[96:99], v[24:27]
  v_mfma_f32_16x16x32_bf16 v[160:163], v[96:99], v[196:199], v[160:163]
  v_mfma_f32_16x16x32_bf16 v[164:167], v[100:103], v[196:199], v[164:167]
  s_add_u32 s57, s74, 7
  s_and_b32 s57, s57, 7
  s_lshl_b32 s58, s57, 7
  s_add_u32 m0, s72, 155648
  s_nop 0
  buffer_load_dwordx4 v28, s[4:7], s58 offen lds
  v_mfma_f32_16x16x32_bf16 v[168:171], v[104:107], v[196:199], v[168:171]
  buffer_load_dwordx4 v29, s[4:7], s58 offen offset:1024 lds
  v_mfma_f32_16x16x32_bf16 v[172:175], v[108:111], v[196:199], v[172:175]
  s_mul_i32 s57, s57, 196608
  s_add_u32 s58, s57, 0
  s_add_u32 m0, s72, 73728
  s_nop 0
  buffer_load_dwordx4 v30, s[8:11], s58 offen lds
  v_mfma_f32_16x16x32_bf16 v[204:207], v[252:255], v[196:199], v[204:207]
  buffer_load_dwordx4 v31, s[8:11], s58 offen offset:1024 lds
  s_waitcnt lgkmcnt(10)
  v_mfma_f32_16x16x32_bf16 v[128:131], v[112:115], v[64:67], v[128:131]
  ds_read_b64_tr_b16 v[188:189], v32 offset:28672
  ds_read_b64_tr_b16 v[190:191], v32 offset:29184
  v_mfma_f32_16x16x32_bf16 v[132:135], v[112:115], v[68:71], v[132:135]
  ds_read_b128 v[96:99], v35 offset:40960
  ds_read_b128 v[100:103], v37 offset:40960
  v_mfma_f32_16x16x32_bf16 v[136:139], v[112:115], v[72:75], v[136:139]
  ds_read_b128 v[104:107], v39 offset:40960
  ds_read_b128 v[108:111], v41 offset:40960
  v_mfma_f32_16x16x32_bf16 v[140:143], v[112:115], v[76:79], v[140:143]
  ds_read_b64_tr_b16 v[192:193], v32 offset:36864
  ds_read_b64_tr_b16 v[194:195], v32 offset:37376
  v_mfma_f32_16x16x32_bf16 v[124:127], v[112:115], v[252:255], v[124:127]
  ds_read_b64_tr_b16 v[196:197], v32 offset:45056
  ds_read_b64_tr_b16 v[198:199], v32 offset:45568
  v_mfma_f32_16x16x32_bf16 v[8:11], v[252:255], v[64:67], v[8:11]
  v_mfma_f32_16x16x32_bf16 v[144:147], v[116:119], v[64:67], v[144:147]
  v_mfma_f32_16x16x32_bf16 v[148:151], v[116:119], v[68:71], v[148:151]
  v_mfma_f32_16x16x32_bf16 v[152:155], v[116:119], v[72:75], v[152:155]
  v_mfma_f32_16x16x32_bf16 v[156:159], v[116:119], v[76:79], v[156:159]
  v_mfma_f32_16x16x32_bf16 v[200:203], v[116:119], v[252:255], v[200:203]
  v_mfma_f32_16x16x32_bf16 v[24:27], v[64:67], v[64:67], v[24:27]
  v_mfma_f32_16x16x32_bf16 v[160:163], v[64:67], v[120:123], v[160:163]
  v_mfma_f32_16x16x32_bf16 v[164:167], v[68:71], v[120:123], v[164:167]
  s_add_u32 s58, s57, 1024
  s_add_u32 m0, s72, 81920
  s_nop 0
  buffer_load_dwordx4 v30, s[8:11], s58 offen lds
  v_mfma_f32_16x16x32_bf16 v[168:171], v[72:75], v[120:123], v[168:171]
  buffer_load_dwordx4 v31, s[8:11], s58 offen offset:1024 lds
  v_mfma_f32_16x16x32_bf16 v[172:175], v[76:79], v[120:123], v[172:175]
  s_add_u32 s58, s57, 2048
  s_add_u32 m0, s72, 90112
  s_nop 0
  buffer_load_dwordx4 v30, s[8:11], s58 offen lds
  v_mfma_f32_16x16x32_bf16 v[204:207], v[252:255], v[120:123], v[204:207]
  buffer_load_dwordx4 v31, s[8:11], s58 offen offset:1024 lds
  s_waitcnt lgkmcnt(10)
  s_waitcnt vmcnt(8)
  s_barrier
  v_mfma_f32_16x16x32_bf16 v[128:131], v[176:179], v[80:83], v[128:131]
  ds_read_b64_tr_b16 v[112:113], v33 offset:0
  ds_read_b64_tr_b16 v[114:115], v33 offset:512
  v_mfma_f32_16x16x32_bf16 v[132:135], v[176:179], v[84:87], v[132:135]
  ds_read_b128 v[64:67], v34 offset:49152
  ds_read_b128 v[68:71], v36 offset:49152
  v_mfma_f32_16x16x32_bf16 v[136:139], v[176:179], v[88:91], v[136:139]
  ds_read_b128 v[72:75], v38 offset:49152
  ds_read_b128 v[76:79], v40 offset:49152
  v_mfma_f32_16x16x32_bf16 v[140:143], v[176:179], v[92:95], v[140:143]
  ds_read_b64_tr_b16 v[116:117], v33 offset:8192
  ds_read_b64_tr_b16 v[118:119], v33 offset:8704
  v_mfma_f32_16x16x32_bf16 v[124:127], v[176:179], v[252:255], v[124:127]
  ds_read_b64_tr_b16 v[120:121], v33 offset:16384
  ds_read_b64_tr_b16 v[122:123], v33 offset:16896
  v_mfma_f32_16x16x32_bf16 v[8:11], v[252:255], v[80:83], v[8:11]
  v_mfma_f32_16x16x32_bf16 v[144:147], v[180:183], v[80:83], v[144:147]
  v_mfma_f32_16x16x32_bf16 v[148:151], v[180:183], v[84:87], v[148:151]
  v_mfma_f32_16x16x32_bf16 v[152:155], v[180:183], v[88:91], v[152:155]
  v_mfma_f32_16x16x32_bf16 v[156:159], v[180:183], v[92:95], v[156:159]
  v_mfma_f32_16x16x32_bf16 v[200:203], v[180:183], v[252:255], v[200:203]
  v_mfma_f32_16x16x32_bf16 v[24:27], v[80:83], v[80:83], v[24:27]
  v_mfma_f32_16x16x32_bf16 v[160:163], v[80:83], v[184:187], v[160:163]
  v_mfma_f32_16x16x32_bf16 v[164:167], v[84:87], v[184:187], v[164:167]
  v_mfma_f32_16x16x32_bf16 v[168:171], v[88:91], v[184:187], v[168:171]
  v_mfma_f32_16x16x32_bf16 v[172:175], v[92:95], v[184:187], v[172:175]
  v_mfma_f32_16x16x32_bf16 v[204:207], v[252:255], v[184:187], v[204:207]
  s_waitcnt lgkmcnt(10)
  v_mfma_f32_16x16x32_bf16 v[128:131], v[188:191], v[96:99], v[128:131]
  ds_read_b64_tr_b16 v[176:177], v33 offset:4096
  ds_read_b64_tr_b16 v[178:179], v33 offset:4608
  v_mfma_f32_16x16x32_bf16 v[132:135], v[188:191], v[100:103], v[132:135]
  ds_read_b128 v[80:83], v35 offset:49152
  ds_read_b128 v[84:87], v37 offset:49152
  v_mfma_f32_16x16x32_bf16 v[136:139], v[188:191], v[104:107], v[136:139]
  ds_read_b128 v[88:91], v39 offset:49152
  ds_read_b128 v[92:95], v41 offset:49152
  v_mfma_f32_16x16x32_bf16 v[140:143], v[188:191], v[108:111], v[140:143]
  ds_read_b64_tr_b16 v[180:181], v33 offset:12288
  ds_read_b64_tr_b16 v[182:183], v33 offset:12800
  v_mfma_f32_16x16x32_bf16 v[124:127], v[188:191], v[252:255], v[124:127]
  ds_read_b64_tr_b16 v[184:185], v33 offset:20480
  ds_read_b64_tr_b16 v[186:187], v33 offset:20992
  v_mfma_f32_16x16x32_bf16 v[8:11], v[252:255], v[96:99], v[8:11]
  v_mfma_f32_16x16x32_bf16 v[144:147], v[192:195], v[96:99], v[144:147]
  v_mfma_f32_16x16x32_bf16 v[148:151], v[192:195], v[100:103], v[148:151]
  v_mfma_f32_16x16x32_bf16 v[152:155], v[192:195], v[104:107], v[152:155]
  v_mfma_f32_16x16x32_bf16 v[156:159], v[192:195], v[108:111], v[156:159]
  v_mfma_f32_16x16x32_bf16 v[200:203], v[192:195], v[252:255], v[200:203]
  v_mfma_f32_16x16x32_bf16 v[24:27], v[96:99], v[96:99], v[24:27]
  v_mfma_f32_16x16x32_bf16 v[160:163], v[96:99], v[196:199], v[160:163]
  v_mfma_f32_16x16x32_bf16 v[164:167], v[100:103], v[196:199], v[164:167]
  v_mfma_f32_16x16x32_bf16 v[168:171], v[104:107], v[196:199], v[168:171]
  v_mfma_f32_16x16x32_bf16 v[172:175], v[108:111], v[196:199], v[172:175]
  v_mfma_f32_16x16x32_bf16 v[204:207], v[252:255], v[196:199], v[204:207]
  s_waitcnt lgkmcnt(10)
  s_waitcnt vmcnt(0)
  s_barrier
  v_mfma_f32_16x16x32_bf16 v[128:131], v[112:115], v[64:67], v[128:131]
  ds_read_b64_tr_b16 v[188:189], v33 offset:24576
  ds_read_b64_tr_b16 v[190:191], v33 offset:25088
  v_mfma_f32_16x16x32_bf16 v[132:135], v[112:115], v[68:71], v[132:135]
  ds_read_b128 v[96:99], v34 offset:57344
  ds_read_b128 v[100:103], v36 offset:57344
  v_mfma_f32_16x16x32_bf16 v[136:139], v[112:115], v[72:75], v[136:139]
  ds_read_b128 v[104:107], v38 offset:57344
  ds_read_b128 v[108:111], v40 offset:57344
  v_mfma_f32_16x16x32_bf16 v[140:143], v[112:115], v[76:79], v[140:143]
  ds_read_b64_tr_b16 v[192:193], v33 offset:32768
  ds_read_b64_tr_b16 v[194:195], v33 offset:33280
  v_mfma_f32_16x16x32_bf16 v[124:127], v[112:115], v[252:255], v[124:127]
  ds_read_b64_tr_b16 v[196:197], v33 offset:40960
  ds_read_b64_tr_b16 v[198:199], v33 offset:41472
  v_mfma_f32_16x16x32_bf16 v[8:11], v[252:255], v[64:67], v[8:11]
  v_mfma_f32_16x16x32_bf16 v[144:147], v[116:119], v[64:67], v[144:147]
  v_mfma_f32_16x16x32_bf16 v[148:151], v[116:119], v[68:71], v[148:151]
  v_mfma_f32_16x16x32_bf16 v[152:155], v[116:119], v[72:75], v[152:155]
  v_mfma_f32_16x16x32_bf16 v[156:159], v[116:119], v[76:79], v[156:159]
  v_mfma_f32_16x16x32_bf16 v[200:203], v[116:119], v[252:255], v[200:203]
  v_mfma_f32_16x16x32_bf16 v[24:27], v[64:67], v[64:67], v[24:27]
  v_mfma_f32_16x16x32_bf16 v[160:163], v[64:67], v[120:123], v[160:163]
  v_mfma_f32_16x16x32_bf16 v[164:167], v[68:71], v[120:123], v[164:167]
  v_mfma_f32_16x16x32_bf16 v[168:171], v[72:75], v[120:123], v[168:171]
  v_mfma_f32_16x16x32_bf16 v[172:175], v[76:79], v[120:123], v[172:175]
  v_add_u32 v4, 0x9e3779b9, v4
  v_mfma_f32_16x16x32_bf16 v[204:207], v[252:255], v[120:123], v[204:207]
  v_add_u32 v5, 0x7f4a7c15, v5
  s_waitcnt lgkmcnt(10)
  v_mfma_f32_16x16x32_bf16 v[128:131], v[176:179], v[80:83], v[128:131]
  ds_read_b64_tr_b16 v[112:113], v33 offset:28672
  ds_read_b64_tr_b16 v[114:115], v33 offset:29184
  v_mfma_f32_16x16x32_bf16 v[132:135], v[176:179], v[84:87], v[132:135]
  ds_read_b128 v[64:67], v35 offset:57344
  ds_read_b128 v[68:71], v37 offset:57344
  v_mfma_f32_16x16x32_bf16 v[136:139], v[176:179], v[88:91], v[136:139]
  ds_read_b128 v[72:75], v39 offset:57344
  ds_read_b128 v[76:79], v41 offset:57344
  v_mfma_f32_16x16x32_bf16 v[140:143], v[176:179], v[92:95], v[140:143]
  ds_read_b64_tr_b16 v[116:117], v33 offset:36864
  ds_read_b64_tr_b16 v[118:119], v33 offset:37376
  v_mfma_f32_16x16x32_bf16 v[124:127], v[176:179], v[252:255], v[124:127]
  ds_read_b64_tr_b16 v[120:121], v33 offset:45056
  ds_read_b64_tr_b16 v[122:123], v33 offset:45568
  v_mfma_f32_16x16x32_bf16 v[8:11], v[252:255], v[80:83], v[8:11]
  v_mfma_f32_16x16x32_bf16 v[144:147], v[180:183], v[80:83], v[144:147]
  v_mfma_f32_16x16x32_bf16 v[148:151], v[180:183], v[84:87], v[148:151]
  v_mfma_f32_16x16x32_bf16 v[152:155], v[180:183], v[88:91], v[152:155]
  v_mfma_f32_16x16x32_bf16 v[156:159], v[180:183], v[92:95], v[156:159]
  v_mfma_f32_16x16x32_bf16 v[200:203], v[180:183], v[252:255], v[200:203]
  v_mfma_f32_16x16x32_bf16 v[24:27], v[80:83], v[80:83], v[24:27]
  v_mfma_f32_16x16x32_bf16 v[160:163], v[80:83], v[184:187], v[160:163]
  v_mfma_f32_16x16x32_bf16 v[164:167], v[84:87], v[184:187], v[164:167]
  v_mfma_f32_16x16x32_bf16 v[168:171], v[88:91], v[184:187], v[168:171]
  v_mfma_f32_16x16x32_bf16 v[172:175], v[92:95], v[184:187], v[172:175]
  v_readfirstlane_b32 s50, v4
  v_mfma_f32_16x16x32_bf16 v[204:207], v[252:255], v[184:187], v[204:207]
  v_readfirstlane_b32 s51, v5
  s_waitcnt lgkmcnt(10)
  v_mfma_f32_16x16x32_bf16 v[128:131], v[188:191], v[96:99], v[128:131]
  v_mfma_f32_16x16x32_bf16 v[132:135], v[188:191], v[100:103], v[132:135]
  v_mfma_f32_16x16x32_bf16 v[136:139], v[188:191], v[104:107], v[136:139]
  v_mfma_f32_16x16x32_bf16 v[140:143], v[188:191], v[108:111], v[140:143]
  v_mfma_f32_16x16x32_bf16 v[124:127], v[188:191], v[252:255], v[124:127]
  v_mfma_f32_16x16x32_bf16 v[8:11], v[252:255], v[96:99], v[8:11]
  v_mfma_f32_16x16x32_bf16 v[144:147], v[192:195], v[96:99], v[144:147]
  v_mfma_f32_16x16x32_bf16 v[148:151], v[192:195], v[100:103], v[148:151]
  v_mfma_f32_16x16x32_bf16 v[152:155], v[192:195], v[104:107], v[152:155]
  v_mfma_f32_16x16x32_bf16 v[156:159], v[192:195], v[108:111], v[156:159]
  v_mfma_f32_16x16x32_bf16 v[200:203], v[192:195], v[252:255], v[200:203]
  v_mfma_f32_16x16x32_bf16 v[24:27], v[96:99], v[96:99], v[24:27]
  v_mfma_f32_16x16x32_bf16 v[160:163], v[96:99], v[196:199], v[160:163]
  v_mfma_f32_16x16x32_bf16 v[164:167], v[100:103], v[196:199], v[164:167]
  v_mfma_f32_16x16x32_bf16 v[168:171], v[104:107], v[196:199], v[168:171]
  v_and_b32 v52, 27, v0
  v_cmp_eq_u32 vcc, 1, v52
  v_mov_b32 v53, s52
  s_nop 0
  v_cndmask_b32 v56, v3, v53, vcc
  v_mfma_f32_16x16x32_bf16 v[172:175], v[108:111], v[196:199], v[172:175]
  v_mov_b32 v57, v56
  v_mov_b32 v58, v56
  v_mov_b32 v59, v56
  s_lshl_b32 s59, s44, 12
  v_mfma_f32_16x16x32_bf16 v[204:207], v[252:255], v[196:199], v[204:207]
  s_add_u32 s59, s59, 67584
  v_add_u32 v53, s59, v1
  s_waitcnt lgkmcnt(0)
  s_barrier
  v_mfma_f32_16x16x32_bf16 v[24:27], v[64:67], v[64:67], v[24:27]
  s_mov_b32 s61, 0x3b000000
  v_mfma_f32_16x16x32_bf16 v[8:11], v[252:255], v[64:67], v[8:11]
  v_mfma_f32_16x16x32_bf16 v[128:131], v[112:115], v[64:67], v[128:131]
  v_mfma_f32_16x16x32_bf16 v[132:135], v[112:115], v[68:71], v[132:135]
  v_mfma_f32_16x16x32_bf16 v[136:139], v[112:115], v[72:75], v[136:139]
  v_mfma_f32_16x16x32_bf16 v[140:143], v[112:115], v[76:79], v[140:143]
  v_cmp_eq_u32 vcc, 1, v20
  s_nop 2
  v_cndmask_b32 v9, v24, v25, vcc
  v_mfma_f32_16x16x32_bf16 v[124:127], v[112:115], v[252:255], v[124:127]
  v_cmp_eq_u32 vcc, 3, v20
  v_mul_f32 v8, 0x3b000000, v8
  v_mfma_f32_16x16x32_bf16 v[144:147], v[116:119], v[64:67], v[144:147]
  v_cndmask_b32_e64 v10, v26, v27, vcc
  v_cmp_lt_u32 vcc, 1, v20
  v_mfma_f32_16x16x32_bf16 v[148:151], v[116:119], v[68:71], v[148:151]
  v_mul_f32 v12, v8, v8
  v_cndmask_b32 v9, v9, v10, vcc
  v_mfma_f32_16x16x32_bf16 v[152:155], v[116:119], v[72:75], v[152:155]
  v_and_b32 v9, v9, v21
  v_mov_b32 v10, v9
  v_mfma_f32_16x16x32_bf16 v[156:159], v[116:119], v[76:79], v[156:159]
  v_cmp_eq_u32 vcc, 1, v17
  v_permlane32_swap_b32 v9, v10
  v_mfma_f32_16x16x32_bf16 v[200:203], v[116:119], v[252:255], v[200:203]
  v_add_f32 v9, v9, v10
  v_mov_b32 v10, v9
  v_mfma_f32_16x16x32_bf16 v[160:163], v[64:67], v[120:123], v[160:163]
  s_nop 0
  v_permlane16_swap_b32 v9, v10
  v_add_f32 v9, v9, v10
  v_mfma_f32_16x16x32_bf16 v[164:167], v[68:71], v[120:123], v[164:167]
  v_fma_f32 v9, v9, s61, -v12
  v_max_f32 v9, 0, v9
  v_mfma_f32_16x16x32_bf16 v[168:171], v[72:75], v[120:123], v[168:171]
  v_add_f32 v9, 0x3727c5ac, v9
  v_rsq_f32 v10, v9
  v_mfma_f32_16x16x32_bf16 v[172:175], v[76:79], v[120:123], v[172:175]
  v_mul_f32_e64 v11, -v8, v10
  v_cndmask_b32 v10, v10, v11, vcc
  ds_write_b32 v19, v10
  v_mfma_f32_16x16x32_bf16 v[204:207], v[252:255], v[120:123], v[204:207]
  ds_write_b128 v53, v[56:59]
  ds_write_b128 v53, v[56:59] offset:1024
  s_waitcnt lgkmcnt(0)
  s_barrier
  ds_read2_b32 v[64:65], v16 offset1:64
  v_xor_b32 v20, 64, v16
  ds_read2_b32 v[66:67], v20 offset1:64
  v_xor_b32 v20, 128, v16
  ds_read2_b32 v[68:69], v20 offset1:64
  v_xor_b32 v20, 192, v16
  ds_read2_b32 v[70:71], v20 offset1:64
  ds_read_b128 v[80:83], v18
  ds_read_b128 v[84:87], v18 offset:256
  v_xor_b32 v21, 64, v18
  ds_read_b128 v[88:91], v21
  ds_read_b128 v[92:95], v21 offset:256
  v_xor_b32 v21, 128, v18
  ds_read_b128 v[96:99], v21
  ds_read_b128 v[100:103], v21 offset:256
  v_xor_b32 v21, 192, v18
  ds_read_b128 v[104:107], v21
  ds_read_b128 v[108:111], v21 offset:256
  s_waitcnt lgkmcnt(8)
  v_pk_mul_f32 v[52:53], v[200:201], v[64:65] op_sel:[0,1] op_sel_hi:[1,1]
  v_pk_mul_f32 v[54:55], v[202:203], v[64:65] op_sel:[0,1] op_sel_hi:[1,1]
  v_pk_mul_f32 v[56:57], v[200:201], v[66:67] op_sel:[0,1] op_sel_hi:[1,1]
  v_pk_mul_f32 v[58:59], v[202:203], v[66:67] op_sel:[0,1] op_sel_hi:[1,1]
  v_pk_fma_f32 v[144:145], v[144:145], v[64:65], v[52:53] op_sel:[0,0,0] op_sel_hi:[1,0,1]
  v_pk_fma_f32 v[146:147], v[146:147], v[64:65], v[54:55] op_sel:[0,0,0] op_sel_hi:[1,0,1]
  v_pk_fma_f32 v[148:149], v[148:149], v[66:67], v[56:57] op_sel:[0,0,0] op_sel_hi:[1,0,1]
  v_pk_fma_f32 v[150:151], v[150:151], v[66:67], v[58:59] op_sel:[0,0,0] op_sel_hi:[1,0,1]
  v_cvt_pk_bf16_f32 v144, v144, v145
  v_cvt_pk_bf16_f32 v145, v146, v147
  v_cvt_pk_bf16_f32 v148, v148, v149
  v_cvt_pk_bf16_f32 v149, v150, v151
  buffer_store_dwordx2 v[144:145], v42, s[36:39], s78 offen sc1
  buffer_store_dwordx2 v[148:149], v43, s[36:39], s78 offen sc1
  v_pk_mul_f32 v[52:53], v[200:201], v[68:69] op_sel:[0,1] op_sel_hi:[1,1]
  v_pk_mul_f32 v[54:55], v[202:203], v[68:69] op_sel:[0,1] op_sel_hi:[1,1]
  v_pk_mul_f32 v[56:57], v[200:201], v[70:71] op_sel:[0,1] op_sel_hi:[1,1]
  v_pk_mul_f32 v[58:59], v[202:203], v[70:71] op_sel:[0,1] op_sel_hi:[1,1]
  v_pk_fma_f32 v[152:153], v[152:153], v[68:69], v[52:53] op_sel:[0,0,0] op_sel_hi:[1,0,1]
  v_pk_fma_f32 v[154:155], v[154:155], v[68:69], v[54:55] op_sel:[0,0,0] op_sel_hi:[1,0,1]
  v_pk_fma_f32 v[156:157], v[156:157], v[70:71], v[56:57] op_sel:[0,0,0] op_sel_hi:[1,0,1]
  v_pk_fma_f32 v[158:159], v[158:159], v[70:71], v[58:59] op_sel:[0,0,0] op_sel_hi:[1,0,1]
  v_cvt_pk_bf16_f32 v152, v152, v153
  v_cvt_pk_bf16_f32 v153, v154, v155
  v_cvt_pk_bf16_f32 v156, v156, v157
  v_cvt_pk_bf16_f32 v157, v158, v159
  buffer_store_dwordx2 v[152:153], v44, s[36:39], s78 offen sc1
  buffer_store_dwordx2 v[156:157], v45, s[36:39], s78 offen sc1
  s_waitcnt lgkmcnt(0)
  v_pk_mul_f32 v[72:73], v[64:65], v[22:23]
  v_pk_mul_f32 v[74:75], v[66:67], v[22:23]
  v_pk_mul_f32 v[76:77], v[68:69], v[22:23]
  v_pk_mul_f32 v[78:79], v[70:71], v[22:23]
  v_pk_mul_f32 v[52:53], v[204:205], v[84:85]
  v_pk_mul_f32 v[54:55], v[206:207], v[86:87]
  v_pk_mul_f32 v[56:57], v[204:205], v[92:93]
  v_pk_mul_f32 v[58:59], v[206:207], v[94:95]
  v_pk_fma_f32 v[160:161], v[160:161], v[80:81], v[52:53]
  v_pk_fma_f32 v[162:163], v[162:163], v[82:83], v[54:55]
  v_pk_fma_f32 v[164:165], v[164:165], v[88:89], v[56:57]
  v_pk_fma_f32 v[166:167], v[166:167], v[90:91], v[58:59]
  v_cvt_pk_bf16_f32 v160, v160, v161
  v_cvt_pk_bf16_f32 v161, v162, v163
  v_cvt_pk_bf16_f32 v164, v164, v165
  v_cvt_pk_bf16_f32 v165, v166, v167
  buffer_store_dwordx2 v[160:161], v46, s[36:39], s79 offen sc1
  buffer_store_dwordx2 v[164:165], v47, s[36:39], s79 offen sc1
  v_pk_mul_f32 v[52:53], v[204:205], v[100:101]
  v_pk_mul_f32 v[54:55], v[206:207], v[102:103]
  v_pk_mul_f32 v[56:57], v[204:205], v[108:109]
  v_pk_mul_f32 v[58:59], v[206:207], v[110:111]
  v_pk_fma_f32 v[168:169], v[168:169], v[96:97], v[52:53]
  v_pk_fma_f32 v[170:171], v[170:171], v[98:99], v[54:55]
  v_pk_fma_f32 v[172:173], v[172:173], v[104:105], v[56:57]
  v_pk_fma_f32 v[174:175], v[174:175], v[106:107], v[58:59]
  v_cvt_pk_bf16_f32 v168, v168, v169
  v_cvt_pk_bf16_f32 v169, v170, v171
  v_cvt_pk_bf16_f32 v172, v172, v173
  v_cvt_pk_bf16_f32 v173, v174, v175
  buffer_store_dwordx2 v[168:169], v48, s[36:39], s79 offen sc1
  buffer_store_dwordx2 v[172:173], v49, s[36:39], s79 offen sc1
  v_pk_mul_f32 v[52:53], v[124:125], v[72:73] op_sel:[0,1] op_sel_hi:[1,1]
  v_pk_mul_f32 v[54:55], v[126:127], v[72:73] op_sel:[0,1] op_sel_hi:[1,1]
  v_pk_mul_f32 v[56:57], v[124:125], v[74:75] op_sel:[0,1] op_sel_hi:[1,1]
  v_pk_mul_f32 v[58:59], v[126:127], v[74:75] op_sel:[0,1] op_sel_hi:[1,1]
  v_pk_fma_f32 v[128:129], v[128:129], v[72:73], v[52:53] op_sel:[0,0,0] op_sel_hi:[1,0,1]
  v_pk_fma_f32 v[130:131], v[130:131], v[72:73], v[54:55] op_sel:[0,0,0] op_sel_hi:[1,0,1]
  v_pk_fma_f32 v[132:133], v[132:133], v[74:75], v[56:57] op_sel:[0,0,0] op_sel_hi:[1,0,1]
  v_pk_fma_f32 v[134:135], v[134:135], v[74:75], v[58:59] op_sel:[0,0,0] op_sel_hi:[1,0,1]
  v_cvt_pk_bf16_f32 v128, v128, v129
  v_cvt_pk_bf16_f32 v129, v130, v131
  v_cvt_pk_bf16_f32 v132, v132, v133
  v_cvt_pk_bf16_f32 v133, v134, v135
  buffer_store_dwordx2 v[128:129], v42, s[36:39], s77 offen sc1
  buffer_store_dwordx2 v[132:133], v43, s[36:39], s77 offen sc1
  v_pk_mul_f32 v[52:53], v[124:125], v[76:77] op_sel:[0,1] op_sel_hi:[1,1]
  v_pk_mul_f32 v[54:55], v[126:127], v[76:77] op_sel:[0,1] op_sel_hi:[1,1]
  v_pk_mul_f32 v[56:57], v[124:125], v[78:79] op_sel:[0,1] op_sel_hi:[1,1]
  v_pk_mul_f32 v[58:59], v[126:127], v[78:79] op_sel:[0,1] op_sel_hi:[1,1]
  v_pk_fma_f32 v[136:137], v[136:137], v[76:77], v[52:53] op_sel:[0,0,0] op_sel_hi:[1,0,1]
  v_pk_fma_f32 v[138:139], v[138:139], v[76:77], v[54:55] op_sel:[0,0,0] op_sel_hi:[1,0,1]
  v_pk_fma_f32 v[140:141], v[140:141], v[78:79], v[56:57] op_sel:[0,0,0] op_sel_hi:[1,0,1]
  v_pk_fma_f32 v[142:143], v[142:143], v[78:79], v[58:59] op_sel:[0,0,0] op_sel_hi:[1,0,1]
  v_cvt_pk_bf16_f32 v136, v136, v137
  v_cvt_pk_bf16_f32 v137, v138, v139
  v_cvt_pk_bf16_f32 v140, v140, v141
  v_cvt_pk_bf16_f32 v141, v142, v143
  buffer_store_dwordx2 v[136:137], v44, s[36:39], s77 offen sc1
  buffer_store_dwordx2 v[140:141], v45, s[36:39], s77 offen sc1
  s_waitcnt vmcnt(0)
  s_mov_b64 exec, 1
  buffer_store_dwordx2 v[4:5], off, s[36:39], s80 sc1
  s_mov_b64 exec, -1
  v_and_b32 v8, 15, v0
  v_lshrrev_b32 v9, 4, v0
  v_lshlrev_b32 v10, 12, v8
  v_lshl_add_u32 v10, v9, 4, v10
  s_lshl_b32 s62, s45, 12
  s_lshl_b32 s63, s44, 7
  s_add_u32 s62, s62, s63
  v_add_u32 v209, s62, v10
  v_add_u32 v210, 65536, v209
  v_add_u32 v211, 131072, v209
  v_add_u32 v212, 196608, v209
  v_mov_b32 v208, 0xdddddddd
  v_mov_b32 v213, v1
  v_add_u32 v214, 98304, v1
  v_lshrrev_b32 v10, 5, v0
  v_lshl_add_u32 v10, v10, 4, v8
  v_lshlrev_b32 v10, 4, v10
  v_and_b32 v11, 31, v0
  v_bfe_u32 v12, v0, 2, 2
  v_add_u32 v12, -1, v12
  v_cmp_gt_u32 vcc, 2, v12
  s_nop 1
  v_cndmask_b32_e64 v12, 0, 4, vcc
  v_and_b32 v13, 27, v11
  v_cmp_eq_u32 vcc, 16, v13
  s_nop 1
  v_cndmask_b32_e64 v13, 0, 1, vcc
  v_add_u32 v12, v12, v13
  v_lshlrev_b32 v12, 4, v12
  v_add_u32 v12, 65536, v12
  v_cmp_gt_u32 vcc, 16, v11
  s_nop 1
  v_cndmask_b32 v215, v12, v10, vcc
  v_mov_b32 v13, 0x4000
  v_cndmask_b32 v216, v3, v13, vcc
  v_lshrrev_b32 v16, 3, v0
  v_and_b32 v17, 7, v0
  v_bfe_u32 v18, v0, 4, 1
  v_lshrrev_b32 v19, 1, v17
  v_xor_b32 v19, v19, v18
  v_and_b32 v20, 1, v17
  v_lshl_or_b32 v19, v19, 1, v20
  v_lshlrev_b32 v19, 4, v19
  v_lshl_add_u32 v19, v16, 10, v19
  s_lshl_b32 s62, s42, 7
  v_add_u32 v217, s62, v19
  v_xor_b32 v218, 64, v217
  v_add_u32 v218, 7168, v218
  v_add_u32 v219, 14336, v217
  v_add_u32 v220, 14336, v218
  v_add_u32 v16, 0, v0
  v_mul_u32_u24 v17, 171, v16
  v_lshrrev_b32 v17, 11, v17
  v_mul_u32_u24 v18, 12, v17
  v_sub_u32 v18, v16, v18
  v_bfe_u32 v19, v17, 3, 1
  v_lshlrev_b32 v19, 1, v19
  v_xor_b32 v18, v18, v19
  v_mul_u32_u24 v17, 2752, v17
  v_lshl_add_u32 v17, v18, 4, v17
  v_add_u32 v56, 0, v17
  v_add_u32 v16, 64, v0
  v_mul_u32_u24 v17, 171, v16
  v_lshrrev_b32 v17, 11, v17
  v_mul_u32_u24 v18, 12, v17
  v_sub_u32 v18, v16, v18
  v_bfe_u32 v19, v17, 3, 1
  v_lshlrev_b32 v19, 1, v19
  v_xor_b32 v18, v18, v19
  v_mul_u32_u24 v17, 2752, v17
  v_lshl_add_u32 v17, v18, 4, v17
  v_add_u32 v57, -1024, v17
  v_add_u32 v16, 128, v0
  v_mul_u32_u24 v17, 171, v16
  v_lshrrev_b32 v17, 11, v17
  v_mul_u32_u24 v18, 12, v17
  v_sub_u32 v18, v16, v18
  v_bfe_u32 v19, v17, 3, 1
  v_lshlrev_b32 v19, 1, v19
  v_xor_b32 v18, v18, v19
  v_mul_u32_u24 v17, 2752, v17
  v_lshl_add_u32 v17, v18, 4, v17
  v_add_u32 v58, -2048, v17
  v_lshrrev_b32 v16, 4, v0
  v_bfe_u32 v17, v0, 2, 2
  v_and_b32 v18, 3, v0
  v_lshl_add_u32 v19, v16, 3, v17
  v_mul_u32_u24 v19, 192, v19
  v_lshl_add_u32 v19, v18, 3, v19
  v_and_b32 v17, 1, v16
  v_xor_b32 v17, s47, v17
  v_lshl_add_u32 v59, v17, 5, v19
  v_add_u32 v60, 49152, v59
  v_and_b32 v17, 15, v0
  v_lshlrev_b32 v17, 2, v17
  v_and_b32 v18, 1, v16
  v_lshl_add_u32 v17, v18, 6, v17
  v_lshrrev_b32 v16, 1, v16
  v_lshl_add_u32 v61, v16, 8, v17
  s_lshl_b32 s61, s43, 17
  s_lshl_b32 s73, s44, 12
  s_add_u32 s61, s61, s73
  s_add_u32 s61, s61, 3145728
  s_add_u32 s62, s40, 0
  s_and_b32 s62, s62, 7
  s_lshl_b32 s62, s62, 14
  s_add_u32 s64, s62, s61
  s_add_u32 s62, s40, 1
  s_and_b32 s62, s62, 7
  s_lshl_b32 s62, s62, 14
  s_add_u32 s65, s62, s61
  s_add_u32 s62, s40, 2
  s_and_b32 s62, s62, 7
  s_lshl_b32 s62, s62, 14
  s_add_u32 s66, s62, s61
  s_add_u32 s62, s40, 3
  s_and_b32 s62, s62, 7
  s_lshl_b32 s62, s62, 14
  s_add_u32 s67, s62, s61
  s_add_u32 s62, s40, 4
  s_and_b32 s62, s62, 7
  s_lshl_b32 s62, s62, 14
  s_add_u32 s68, s62, s61
  s_add_u32 s62, s40, 5
  s_and_b32 s62, s62, 7
  s_lshl_b32 s62, s62, 14
  s_add_u32 s69, s62, s61
  s_add_u32 s62, s40, 6
  s_and_b32 s62, s62, 7
  s_lshl_b32 s62, s62, 14
  s_add_u32 s70, s62, s61
  s_add_u32 s62, s40, 7
  s_and_b32 s62, s62, 7
  s_lshl_b32 s62, s62, 14
  s_add_u32 s71, s62, s61
  s_add_u32 s3, s1, s40
  s_lshr_b32 s3, s42, 2
  s_lshl_b32 s3, s3, 2
  s_add_u32 s62, s3, 0
  s_and_b32 s62, s62, 7
  s_lshl_b32 s76, s62, 9
  s_add_u32 s62, s3, 1
  s_and_b32 s62, s62, 7
  s_lshl_b32 s77, s62, 9
  s_add_u32 s62, s3, 2
  s_and_b32 s62, s62, 7
  s_lshl_b32 s78, s62, 9
  s_add_u32 s62, s3, 3
  s_and_b32 s62, s62, 7
  s_lshl_b32 s79, s62, 9
  s_add_u32 s62, s3, 4
  s_and_b32 s62, s62, 7
  s_lshl_b32 s80, s62, 9
  s_add_u32 s62, s3, 5
  s_and_b32 s62, s62, 7
  s_lshl_b32 s81, s62, 9
  s_add_u32 s62, s3, 6
  s_and_b32 s62, s62, 7
  s_lshl_b32 s82, s62, 9
  s_add_u32 s62, s3, 7
  s_and_b32 s62, s62, 7
  s_lshl_b32 s83, s62, 9
  v_lshrrev_b32 v226, 3, v0
  s_lshl_b32 s62, s42, 3
  s_add_u32 s62, s62, s45
  v_add_u32 v226, s62, v226
  v_lshlrev_b32 v226, 12, v226
  v_and_b32 v8, 7, v0
  v_lshl_add_u32 v226, v8, 4, v226
  s_lshl_b32 s62, s44, 7
  v_add_u32 v226, s62, v226
  v_and_b32 v8, 15, v0
  v_lshrrev_b32 v9, 4, v0
  v_lshlrev_b32 v8, 10, v8
  v_lshl_add_u32 v62, v9, 3, v8
  v_and_b32 v10, 15, v0
  v_bfe_u32 v11, v0, 4, 1
  v_lshrrev_b32 v12, 5, v0
  v_lshlrev_b32 v10, 4, v10
  v_lshl_add_u32 v10, v11, 14, v10
  v_lshl_add_u32 v227, v12, 3, v10
  s_lshl_b32 s56, s44, 5
  s_add_u32 s56, s56, s43
  s_lshl_b32 s56, s56, 7
  s_add_u32 s56, s56, 4096
  s_lshl_b32 s57, s43, 16
  s_lshl_b32 s58, s40, 13
  s_add_u32 s57, s57, s58
  s_lshl_b32 s58, s44, 11
  s_add_u32 s57, s57, s58
  s_add_u32 s57, s57, 1048576
  v_mov_b32 v112, 0
  v_mov_b32 v113, 0
  v_mov_b32 v114, 0
  v_mov_b32 v115, 0
  v_mov_b32 v116, 0
  v_mov_b32 v117, 0
  v_mov_b32 v118, 0
  v_mov_b32 v119, 0
  v_mov_b32 v120, 0
  v_mov_b32 v121, 0
  v_mov_b32 v122, 0
  v_mov_b32 v123, 0
  v_mov_b32 v124, 0
  v_mov_b32 v125, 0
  v_mov_b32 v126, 0
  v_mov_b32 v127, 0
  v_mov_b32 v128, 0
  v_mov_b32 v129, 0
  v_mov_b32 v130, 0
  v_mov_b32 v131, 0
  v_mov_b32 v132, 0
  v_mov_b32 v133, 0
  v_mov_b32 v134, 0
  v_mov_b32 v135, 0
  v_mov_b32 v136, 0
  v_mov_b32 v137, 0
  v_mov_b32 v138, 0
  v_mov_b32 v139, 0
  v_mov_b32 v140, 0
  v_mov_b32 v141, 0
  v_mov_b32 v142, 0
  v_mov_b32 v143, 0
  s_lshr_b32 s84, s43, 1
  s_lshl_b32 s84, s84, 10
  s_and_b32 s85, s43, 1
  s_lshl_b32 s85, s85, 9
  s_add_u32 s84, s84, s85
  s_lshl_b32 s85, s40, 18
  s_add_u32 s84, s84, s85
  s_lshl_b32 s85, s44, 16
  s_add_u32 s84, s84, s85
  s_add_u32 s84, s84, 7340032
  s_add_u32 s85, s84, 0x8000
  s_lshl_b32 s86, s40, 2
  s_add_u32 s86, s86, s44
  s_lshl_b32 s86, s86, 12
  s_lshl_b32 s87, s43, 7
  s_add_u32 s86, s86, s87
  s_add_u32 s86, s86, 589824
  s_lshl_b32 s87, s46, 15
  s_lshl_b32 s88, s45, 10
  s_add_u32 s87, s87, s88
  s_lshl_b32 s88, s42, 7
  s_add_u32 s87, s87, s88
  s_lshl_b32 s88, s47, 6
  s_add_u32 s87, s87, s88
  s_add_u32 s88, s87, 0x4000
  v_lshrrev_b32 v64, 4, v0
  v_bfe_u32 v65, v0, 2, 2
  v_and_b32 v66, 3, v0
  v_lshl_add_u32 v67, v64, 3, v65
  v_lshlrev_b32 v67, 7, v67
  v_lshl_add_u32 v67, v66, 3, v67
  v_lshrrev_b32 v65, 1, v65
  v_and_b32 v64, 1, v64
  v_lshl_or_b32 v65, v64, 1, v65
  s_lshl_b32 s59, s47, 1
  v_xor_b32 v65, s59, v65
  v_lshl_add_u32 v28, v65, 5, v67
  v_xor_b32 v29, 32, v28
  v_add_u32 v28, 98304, v28
  v_add_u32 v29, 98304, v29
  s_mov_b32 s55, 0x40000
  s_lshl_b32 s58, 1, s40
L_s1_1:
  buffer_load_dwordx2 v[8:9], v7, s[36:39], s56 offen sc1
  s_waitcnt vmcnt(0)
  v_cmp_ne_u64 vcc, s[50:51], v[8:9]
  s_sub_u32 s55, s55, 1
  s_cbranch_scc1 L_s1own_2
  s_and_b32 s59, vcc_lo, s58
  s_cbranch_scc1 L_s1_1
L_s1own_2:
  s_mov_b64 s[60:61], vcc
  buffer_load_dwordx4 v[176:179], v1, s[36:39], s57 offen offset:0 sc1
  buffer_load_dwordx4 v[180:183], v1, s[36:39], s57 offen offset:1024 sc1
  s_add_u32 m0, s73, 0
  s_nop 0
  buffer_load_dwordx4 v1, s[36:39], s64 offen offset:0 sc1 lds
  buffer_load_dwordx4 v1, s[36:39], s64 offen offset:1024 sc1 lds
  buffer_load_dwordx4 v1, s[36:39], s64 offen offset:2048 sc1 lds
  buffer_load_dwordx4 v1, s[36:39], s64 offen offset:3072 sc1 lds
  s_and_b32 s75, s60, 0xff
  s_mov_b32 s74, s56
  s_waitcnt vmcnt(0)
  s_barrier
  ds_read_b128 v[184:187], v213 offset:0
  ds_read_b128 v[188:191], v213 offset:1024
  ds_read_b128 v[192:195], v215 offset:2048
  ds_read_b128 v[196:199], v215 offset:2560
  s_waitcnt lgkmcnt(0)
  v_mfma_f32_32x32x16_bf16 v[64:79], v[184:187], v[176:179], 0
  v_mfma_f32_32x32x16_bf16 v[80:95], v[184:187], v[180:183], 0
  s_nop 10
  v_max3_f32 v8, v64, v65, v66
  v_max3_f32 v8, v8, v67, v68
  v_max3_f32 v8, v8, v69, v70
  v_max3_f32 v8, v8, v71, v72
  v_max3_f32 v8, v8, v73, v74
  v_max3_f32 v8, v8, v75, v76
  v_max3_f32 v8, v8, v77, v78
  v_max_f32 v8, v8, v79
  v_mov_b32 v9, v8
  v_max3_f32 v10, v80, v81, v82
  v_max3_f32 v10, v10, v83, v84
  v_max3_f32 v10, v10, v85, v86
  v_max3_f32 v10, v10, v87, v88
  v_max3_f32 v10, v10, v89, v90
  v_max3_f32 v10, v10, v91, v92
  v_max3_f32 v10, v10, v93, v94
  v_max_f32 v10, v10, v95
  v_mov_b32 v11, v10
  v_permlane32_swap_b32 v8, v9
  s_nop 0
  v_permlane32_swap_b32 v10, v11
  v_max_f32 v8, v8, v9
  v_sub_f32 v8, 0, v8
  v_pk_mov_b32 v[144:145], v[8:9], v[8:9] op_sel:[0,0]
  v_pk_mov_b32 v[146:147], v[8:9], v[8:9] op_sel:[0,0]
  v_pk_mov_b32 v[148:149], v[8:9], v[8:9] op_sel:[0,0]
  v_pk_mov_b32 v[150:151], v[8:9], v[8:9] op_sel:[0,0]
  v_pk_mov_b32 v[152:153], v[8:9], v[8:9] op_sel:[0,0]
  v_pk_mov_b32 v[154:155], v[8:9], v[8:9] op_sel:[0,0]
  v_pk_mov_b32 v[156:157], v[8:9], v[8:9] op_sel:[0,0]
  v_pk_mov_b32 v[158:159], v[8:9], v[8:9] op_sel:[0,0]
  s_nop 1
  v_mfma_f32_32x32x16_bf16 v[64:79], v[184:187], v[176:179], v[144:159]
  v_max_f32 v10, v10, v11
  v_sub_f32 v10, 0, v10
  v_pk_mov_b32 v[160:161], v[10:11], v[10:11] op_sel:[0,0]
  v_pk_mov_b32 v[162:163], v[10:11], v[10:11] op_sel:[0,0]
  v_pk_mov_b32 v[164:165], v[10:11], v[10:11] op_sel:[0,0]
  v_pk_mov_b32 v[166:167], v[10:11], v[10:11] op_sel:[0,0]
  v_pk_mov_b32 v[168:169], v[10:11], v[10:11] op_sel:[0,0]
  v_pk_mov_b32 v[170:171], v[10:11], v[10:11] op_sel:[0,0]
  v_pk_mov_b32 v[172:173], v[10:11], v[10:11] op_sel:[0,0]
  v_pk_mov_b32 v[174:175], v[10:11], v[10:11] op_sel:[0,0]
  s_nop 1
  v_mfma_f32_32x32x16_bf16 v[80:95], v[184:187], v[180:183], v[160:175]
  s_lshl_b32 s60, s44, 1
  s_add_u32 s60, s60, 0
  s_add_u32 s60, s60, s42
  s_and_b32 s60, s60, 7
  s_lshl_b32 s60, s60, 16
  s_add_u32 s56, s60, 0
  s_lshl_b32 s60, s44, 1
  s_add_u32 s60, s60, 0
  s_add_u32 s60, s60, s42
  s_and_b32 s60, s60, 7
  s_lshl_b32 s60, s60, 16
  s_add_u32 s57, s60, 32768
  s_lshl_b32 s60, s44, 1
  s_add_u32 s60, s60, 1
  s_add_u32 s60, s60, s42
  s_and_b32 s60, s60, 7
  s_lshl_b32 s60, s60, 16
  s_add_u32 s58, s60, 0
  s_lshl_b32 s60, s44, 1
  s_add_u32 s60, s60, 1
  s_add_u32 s60, s60, s42
  s_and_b32 s60, s60, 7
  s_lshl_b32 s60, s60, 16
  s_add_u32 s59, s60, 32768
  s_lshl_b32 s62, s43, 2
  s_add_u32 s62, s62, s44
  s_mul_i32 s62, s62, 11008
  s_mov_b32 s63, s76
  s_mov_b32 s76, s42
  s_lshl_b32 s60, s48, 5
  s_mul_i32 s61, s44, 1
  s_lshl_b32 s62, s76, 2
  s_add_u32 s62, s62, s61
  s_mul_i32 s61, s61, 3072
  s_add_u32 s72, s62, 28
  s_and_b32 s72, s72, 31
  s_mul_i32 s72, s72, 44032
  s_add_u32 s72, s72, s60
  s_add_u32 s72, s72, 1376
  s_add_u32 m0, s61, 86016
  s_mov_b32 s60, m0
  s_mov_b32 s76, s63
  s_lshl_b32 s61, s2, 2
  s_add_u32 s61, s61, s44
  s_mul_i32 s62, s61, 1376
  s_mul_i32 s63, s61, 688
  s_lshl_b32 s61, s61, 9
  v_min_u32 v50, 42, v0
  v_lshlrev_b32 v50, 4, v50
  v_min_u32 v51, 21, v0
  v_lshlrev_b32 v51, 4, v51
  v_min_u32 v49, 31, v0
  v_lshlrev_b32 v49, 4, v49
  v_lshlrev_b32 v234, 6, v0
  v_exp_f32 v64, v64
  v_exp_f32 v65, v65
  ds_read_b128 v[184:187], v213 offset:4096
  v_exp_f32 v66, v66
  v_exp_f32 v67, v67
  v_exp_f32 v68, v68
  v_exp_f32 v69, v69
  v_exp_f32 v70, v70
  v_mfma_f32_32x32x16_bf16 v[96:111], v[188:191], v[176:179], v[144:159]
  ds_read_b128 v[200:203], v215 offset:3072
  v_exp_f32 v71, v71
  v_exp_f32 v72, v72
  v_exp_f32 v73, v73
  v_exp_f32 v74, v74
  v_exp_f32 v75, v75
  v_smfmac_f32_32x32x32_bf16 v[112:127], v[192:195], v[64:71], v208
  ds_read_b128 v[204:207], v215 offset:3584
  v_exp_f32 v76, v76
  v_exp_f32 v77, v77
  v_exp_f32 v78, v78
  v_exp_f32 v79, v79
  v_exp_f32 v80, v80
  v_exp_f32 v81, v81
  v_smfmac_f32_32x32x32_bf16 v[112:127], v[196:199], v[72:79], v208
  v_exp_f32 v82, v82
  v_exp_f32 v83, v83
  v_exp_f32 v84, v84
  v_exp_f32 v85, v85
  v_exp_f32 v86, v86
  v_mfma_f32_32x32x16_bf16 v[64:79], v[188:191], v[180:183], v[160:175]
  s_waitcnt lgkmcnt(0)
  v_exp_f32 v87, v87
  v_exp_f32 v88, v88
  v_exp_f32 v89, v89
  v_exp_f32 v90, v90
  v_exp_f32 v91, v91
  v_smfmac_f32_32x32x32_bf16 v[128:143], v[192:195], v[80:87], v208
  v_exp_f32 v92, v92
  v_exp_f32 v93, v93
  v_exp_f32 v94, v94
  v_exp_f32 v95, v95
  v_exp_f32 v96, v96
  v_exp_f32 v97, v97
  v_smfmac_f32_32x32x32_bf16 v[128:143], v[196:199], v[88:95], v208
  ds_read_b128 v[188:191], v213 offset:5120
  v_exp_f32 v98, v98
  v_exp_f32 v99, v99
  v_exp_f32 v100, v100
  v_exp_f32 v101, v101
  v_exp_f32 v102, v102
  v_mfma_f32_32x32x16_bf16 v[80:95], v[184:187], v[176:179], v[144:159]
  ds_read_b128 v[192:195], v215 offset:6144
  v_exp_f32 v103, v103
  v_exp_f32 v104, v104
  v_exp_f32 v105, v105
  v_exp_f32 v106, v106
  v_exp_f32 v107, v107
  v_smfmac_f32_32x32x32_bf16 v[112:127], v[200:203], v[96:103], v208
  ds_read_b128 v[196:199], v215 offset:6656
  s_lshl_b32 s55, 1542, s40
  s_lshr_b32 s55, s55, 8
  s_and_b32 s55, s55, 0xff
  s_and_b32 vcc_lo, s75, s55
  s_cbranch_scc0 L_rcok_5
  s_mov_b32 s0, s55
  s_mov_b32 s55, 0x40000
L_rc_4:
  buffer_load_dwordx2 v[8:9], v7, s[36:39], s74 offen sc1
  s_waitcnt vmcnt(0)
  v_cmp_ne_u64 vcc, s[50:51], v[8:9]
  s_sub_u32 s55, s55, 1
  s_cbranch_scc1 L_rcok_5
  s_and_b32 s75, vcc_lo, 0xff
  s_and_b32 vcc_lo, s75, s0
  s_cbranch_scc1 L_rc_4
L_rcok_5:
  s_add_u32 m0, s73, 16384
  v_exp_f32 v108, v108
  v_exp_f32 v109, v109
  v_exp_f32 v110, v110
  v_exp_f32 v111, v111
  v_exp_f32 v64, v64
  v_exp_f32 v65, v65
  v_smfmac_f32_32x32x32_bf16 v[112:127], v[204:207], v[104:111], v208
  buffer_load_dwordx4 v1, s[36:39], s65 offen offset:0 sc1 lds
  v_exp_f32 v66, v66
  v_exp_f32 v67, v67
  v_exp_f32 v68, v68
  v_exp_f32 v69, v69
  v_exp_f32 v70, v70
  v_mfma_f32_32x32x16_bf16 v[96:111], v[184:187], v[180:183], v[160:175]
  s_waitcnt lgkmcnt(0)
  v_exp_f32 v71, v71
  v_exp_f32 v72, v72
  v_exp_f32 v73, v73
  v_exp_f32 v74, v74
  v_exp_f32 v75, v75
  v_smfmac_f32_32x32x32_bf16 v[128:143], v[200:203], v[64:71], v208
  buffer_load_dwordx4 v1, s[36:39], s65 offen offset:1024 sc1 lds
  v_exp_f32 v76, v76
  v_exp_f32 v77, v77
  v_exp_f32 v78, v78
  v_exp_f32 v79, v79
  v_exp_f32 v80, v80
  v_exp_f32 v81, v81
  v_smfmac_f32_32x32x32_bf16 v[128:143], v[204:207], v[72:79], v208
  ds_read_b128 v[184:187], v213 offset:8192
  v_exp_f32 v82, v82
  v_exp_f32 v83, v83
  v_exp_f32 v84, v84
  v_exp_f32 v85, v85
  v_exp_f32 v86, v86
  v_mfma_f32_32x32x16_bf16 v[64:79], v[188:191], v[176:179], v[144:159]
  ds_read_b128 v[200:203], v215 offset:7168
  v_exp_f32 v87, v87
  v_exp_f32 v88, v88
  v_exp_f32 v89, v89
  v_exp_f32 v90, v90
  v_exp_f32 v91, v91
  v_smfmac_f32_32x32x32_bf16 v[112:127], v[192:195], v[80:87], v208
  ds_read_b128 v[204:207], v215 offset:7680
  v_exp_f32 v92, v92
  v_exp_f32 v93, v93
  v_exp_f32 v94, v94
  v_exp_f32 v95, v95
  v_exp_f32 v96, v96
  v_exp_f32 v97, v97
  v_smfmac_f32_32x32x32_bf16 v[112:127], v[196:199], v[88:95], v208
  buffer_load_dwordx4 v1, s[36:39], s65 offen offset:2048 sc1 lds
  v_exp_f32 v98, v98
  v_exp_f32 v99, v99
  v_exp_f32 v100, v100
  v_exp_f32 v101, v101
  v_exp_f32 v102, v102
  v_mfma_f32_32x32x16_bf16 v[80:95], v[188:191], v[180:183], v[160:175]
  s_waitcnt lgkmcnt(0)
  v_exp_f32 v103, v103
  v_exp_f32 v104, v104
  v_exp_f32 v105, v105
  v_exp_f32 v106, v106
  v_exp_f32 v107, v107
  v_smfmac_f32_32x32x32_bf16 v[128:143], v[192:195], v[96:103], v208
  buffer_load_dwordx4 v1, s[36:39], s65 offen offset:3072 sc1 lds
  v_exp_f32 v108, v108
  v_exp_f32 v109, v109
  v_exp_f32 v110, v110
  v_exp_f32 v111, v111
  v_exp_f32 v64, v64
  v_exp_f32 v65, v65
  v_smfmac_f32_32x32x32_bf16 v[128:143], v[196:199], v[104:111], v208
  ds_read_b128 v[188:191], v213 offset:9216
  v_exp_f32 v66, v66
  v_exp_f32 v67, v67
  v_exp_f32 v68, v68
  v_exp_f32 v69, v69
  v_exp_f32 v70, v70
  v_mfma_f32_32x32x16_bf16 v[96:111], v[184:187], v[176:179], v[144:159]
  ds_read_b128 v[192:195], v215 offset:10240
  v_exp_f32 v71, v71
  v_exp_f32 v72, v72
  v_exp_f32 v73, v73
  v_exp_f32 v74, v74
  v_exp_f32 v75, v75
  v_smfmac_f32_32x32x32_bf16 v[112:127], v[200:203], v[64:71], v208
  ds_read_b128 v[196:199], v215 offset:10752
  s_add_u32 m0, s73, 32768
  v_exp_f32 v76, v76
  v_exp_f32 v77, v77
  v_exp_f32 v78, v78
  v_exp_f32 v79, v79
  v_exp_f32 v80, v80
  v_exp_f32 v81, v81
  v_smfmac_f32_32x32x32_bf16 v[112:127], v[204:207], v[72:79], v208
  buffer_load_dwordx4 v1, s[36:39], s66 offen offset:0 sc1 lds
  v_exp_f32 v82, v82
  v_exp_f32 v83, v83
  v_exp_f32 v84, v84
  v_exp_f32 v85, v85
  v_exp_f32 v86, v86
  v_mfma_f32_32x32x16_bf16 v[64:79], v[184:187], v[180:183], v[160:175]
  s_waitcnt lgkmcnt(0)
  v_exp_f32 v87, v87
  v_exp_f32 v88, v88
  v_exp_f32 v89, v89
  v_exp_f32 v90, v90
  v_exp_f32 v91, v91
  v_smfmac_f32_32x32x32_bf16 v[128:143], v[200:203], v[80:87], v208
  buffer_load_dwordx4 v1, s[36:39], s66 offen offset:1024 sc1 lds
  v_exp_f32 v92, v92
  v_exp_f32 v93, v93
  v_exp_f32 v94, v94
  v_exp_f32 v95, v95
  v_exp_f32 v96, v96
  v_exp_f32 v97, v97
  v_smfmac_f32_32x32x32_bf16 v[128:143], v[204:207], v[88:95], v208
  ds_read_b128 v[184:187], v213 offset:12288
  v_exp_f32 v98, v98
  v_exp_f32 v99, v99
  v_exp_f32 v100, v100
  v_exp_f32 v101, v101
  v_exp_f32 v102, v102
  v_mfma_f32_32x32x16_bf16 v[80:95], v[188:191], v[176:179], v[144:159]
  ds_read_b128 v[200:203], v215 offset:11264
  v_exp_f32 v103, v103
  v_exp_f32 v104, v104
  v_exp_f32 v105, v105
  v_exp_f32 v106, v106
  v_exp_f32 v107, v107
  v_smfmac_f32_32x32x32_bf16 v[112:127], v[192:195], v[96:103], v208
  ds_read_b128 v[204:207], v215 offset:11776
  v_exp_f32 v108, v108
  v_exp_f32 v109, v109
  v_exp_f32 v110, v110
  v_exp_f32 v111, v111
  v_exp_f32 v64, v64
  v_exp_f32 v65, v65
  v_smfmac_f32_32x32x32_bf16 v[112:127], v[196:199], v[104:111], v208
  buffer_load_dwordx4 v1, s[36:39], s66 offen offset:2048 sc1 lds
  v_exp_f32 v66, v66
  v_exp_f32 v67, v67
  v_exp_f32 v68, v68
  v_exp_f32 v69, v69
  v_exp_f32 v70, v70
  v_mfma_f32_32x32x16_bf16 v[96:111], v[188:191], v[180:183], v[160:175]
  s_waitcnt lgkmcnt(0)
  v_exp_f32 v71, v71
  v_exp_f32 v72, v72
  v_exp_f32 v73, v73
  v_exp_f32 v74, v74
  v_exp_f32 v75, v75
  v_smfmac_f32_32x32x32_bf16 v[128:143], v[192:195], v[64:71], v208
  buffer_load_dwordx4 v1, s[36:39], s66 offen offset:3072 sc1 lds
  v_exp_f32 v76, v76
  v_exp_f32 v77, v77
  v_exp_f32 v78, v78
  v_exp_f32 v79, v79
  v_exp_f32 v80, v80
  v_exp_f32 v81, v81
  v_smfmac_f32_32x32x32_bf16 v[128:143], v[196:199], v[72:79], v208
  ds_read_b128 v[188:191], v213 offset:13312
  v_exp_f32 v82, v82
  v_exp_f32 v83, v83
  v_exp_f32 v84, v84
  v_exp_f32 v85, v85
  v_exp_f32 v86, v86
  v_mfma_f32_32x32x16_bf16 v[64:79], v[184:187], v[176:179], v[144:159]
  ds_read_b128 v[192:195], v215 offset:14336
  v_exp_f32 v87, v87
  v_exp_f32 v88, v88
  v_exp_f32 v89, v89
  v_exp_f32 v90, v90
  v_exp_f32 v91, v91
  v_smfmac_f32_32x32x32_bf16 v[112:127], v[200:203], v[80:87], v208
  ds_read_b128 v[196:199], v215 offset:14848
  s_mov_b32 m0, s60
  v_exp_f32 v92, v92
  v_exp_f32 v93, v93
  v_exp_f32 v94, v94
  v_exp_f32 v95, v95
  v_exp_f32 v96, v96
  v_exp_f32 v97, v97
  v_smfmac_f32_32x32x32_bf16 v[112:127], v[204:207], v[88:95], v208
  buffer_load_dwordx4 v56, s[16:19], s72 offen offset:0 lds
  v_exp_f32 v98, v98
  v_exp_f32 v99, v99
  v_exp_f32 v100, v100
  v_exp_f32 v101, v101
  v_exp_f32 v102, v102
  v_mfma_f32_32x32x16_bf16 v[80:95], v[184:187], v[180:183], v[160:175]
  s_waitcnt vmcnt(5) lgkmcnt(0)
  s_barrier
  v_exp_f32 v103, v103
  v_exp_f32 v104, v104
  v_exp_f32 v105, v105
  v_exp_f32 v106, v106
  v_exp_f32 v107, v107
  v_smfmac_f32_32x32x32_bf16 v[128:143], v[200:203], v[96:103], v208
  buffer_load_dwordx4 v57, s[16:19], s72 offen offset:1024 lds
  v_exp_f32 v108, v108
  v_exp_f32 v109, v109
  v_exp_f32 v110, v110
  v_exp_f32 v111, v111
  v_exp_f32 v64, v64
  v_exp_f32 v65, v65
  v_smfmac_f32_32x32x32_bf16 v[128:143], v[204:207], v[104:111], v208
  ds_read_b128 v[184:187], v213 offset:16384
  v_exp_f32 v66, v66
  v_exp_f32 v67, v67
  v_exp_f32 v68, v68
  v_exp_f32 v69, v69
  v_exp_f32 v70, v70
  v_mfma_f32_32x32x16_bf16 v[96:111], v[188:191], v[176:179], v[144:159]
  ds_read_b128 v[200:203], v215 offset:15360
  v_exp_f32 v71, v71
  v_exp_f32 v72, v72
  v_exp_f32 v73, v73
  v_exp_f32 v74, v74
  v_exp_f32 v75, v75
  v_smfmac_f32_32x32x32_bf16 v[112:127], v[192:195], v[64:71], v208
  ds_read_b128 v[204:207], v215 offset:15872
  v_exp_f32 v76, v76
  v_exp_f32 v77, v77
  v_exp_f32 v78, v78
  v_exp_f32 v79, v79
  v_exp_f32 v80, v80
  v_exp_f32 v81, v81
  v_smfmac_f32_32x32x32_bf16 v[112:127], v[196:199], v[72:79], v208
  buffer_load_dwordx4 v58, s[16:19], s72 offen offset:2048 lds
  v_exp_f32 v82, v82
  v_exp_f32 v83, v83
  v_exp_f32 v84, v84
  v_exp_f32 v85, v85
  v_exp_f32 v86, v86
  v_mfma_f32_32x32x16_bf16 v[64:79], v[188:191], v[180:183], v[160:175]
  s_waitcnt lgkmcnt(0)
  v_exp_f32 v87, v87
  v_exp_f32 v88, v88
  v_exp_f32 v89, v89
  v_exp_f32 v90, v90
  v_exp_f32 v91, v91
  v_smfmac_f32_32x32x32_bf16 v[128:143], v[192:195], v[80:87], v208
  buffer_load_dwordx4 a[0:3], v209, s[20:23], s76 offen offset:0
  v_exp_f32 v92, v92
  v_exp_f32 v93, v93
  v_exp_f32 v94, v94
  v_exp_f32 v95, v95
  v_exp_f32 v96, v96
  v_exp_f32 v97, v97
  v_smfmac_f32_32x32x32_bf16 v[128:143], v[196:199], v[88:95], v208
  ds_read_b128 v[188:191], v213 offset:17408
  v_add_u32 v215, v215, v216
  v_exp_f32 v98, v98
  v_exp_f32 v99, v99
  v_exp_f32 v100, v100
  v_exp_f32 v101, v101
  v_exp_f32 v102, v102
  v_mfma_f32_32x32x16_bf16 v[80:95], v[184:187], v[176:179], v[144:159]
  ds_read_b128 v[192:195], v215 offset:2048
  v_exp_f32 v103, v103
  v_exp_f32 v104, v104
  v_exp_f32 v105, v105
  v_exp_f32 v106, v106
  v_exp_f32 v107, v107
  v_smfmac_f32_32x32x32_bf16 v[112:127], v[200:203], v[96:103], v208
  ds_read_b128 v[196:199], v215 offset:2560
  v_exp_f32 v108, v108
  v_exp_f32 v109, v109
  v_exp_f32 v110, v110
  v_exp_f32 v111, v111
  v_exp_f32 v64, v64
  v_exp_f32 v65, v65
  v_smfmac_f32_32x32x32_bf16 v[112:127], v[204:207], v[104:111], v208
  buffer_load_dwordx4 a[4:7], v210, s[20:23], s76 offen offset:0
  v_exp_f32 v66, v66
  v_exp_f32 v67, v67
  v_exp_f32 v68, v68
  v_exp_f32 v69, v69
  v_exp_f32 v70, v70
  v_mfma_f32_32x32x16_bf16 v[96:111], v[184:187], v[180:183], v[160:175]
  s_waitcnt lgkmcnt(0)
  v_exp_f32 v71, v71
  v_exp_f32 v72, v72
  v_exp_f32 v73, v73
  v_exp_f32 v74, v74
  v_exp_f32 v75, v75
  v_smfmac_f32_32x32x32_bf16 v[128:143], v[200:203], v[64:71], v208
  buffer_load_dwordx4 a[8:11], v211, s[20:23], s76 offen offset:0
  v_exp_f32 v76, v76
  v_exp_f32 v77, v77
  v_exp_f32 v78, v78
  v_exp_f32 v79, v79
  v_exp_f32 v80, v80
  v_exp_f32 v81, v81
  v_smfmac_f32_32x32x32_bf16 v[128:143], v[204:207], v[72:79], v208
  ds_read_b128 v[184:187], v213 offset:20480
  v_exp_f32 v82, v82
  v_exp_f32 v83, v83
  v_exp_f32 v84, v84
  v_exp_f32 v85, v85
  v_exp_f32 v86, v86
  v_mfma_f32_32x32x16_bf16 v[64:79], v[188:191], v[176:179], v[144:159]
  ds_read_b128 v[200:203], v215 offset:3072
  v_exp_f32 v87, v87
  v_exp_f32 v88, v88
  v_exp_f32 v89, v89
  v_exp_f32 v90, v90
  v_exp_f32 v91, v91
  v_smfmac_f32_32x32x32_bf16 v[112:127], v[192:195], v[80:87], v208
  ds_read_b128 v[204:207], v215 offset:3584
  s_lshl_b32 s55, 63736, s40
  s_lshr_b32 s55, s55, 8
  s_and_b32 s55, s55, 0xff
  s_and_b32 vcc_lo, s75, s55
  s_cbranch_scc0 L_rcok_7
  s_mov_b32 s0, s55
  s_mov_b32 s55, 0x40000
L_rc_6:
  buffer_load_dwordx2 v[8:9], v7, s[36:39], s74 offen sc1
  s_waitcnt vmcnt(0)
  v_cmp_ne_u64 vcc, s[50:51], v[8:9]
  s_sub_u32 s55, s55, 1
  s_cbranch_scc1 L_rcok_7
  s_and_b32 s75, vcc_lo, 0xff
  s_and_b32 vcc_lo, s75, s0
  s_cbranch_scc1 L_rc_6
L_rcok_7:
  s_add_u32 m0, s73, 49152
  v_exp_f32 v92, v92
  v_exp_f32 v93, v93
  v_exp_f32 v94, v94
  v_exp_f32 v95, v95
  v_exp_f32 v96, v96
  v_exp_f32 v97, v97
  v_smfmac_f32_32x32x32_bf16 v[112:127], v[196:199], v[88:95], v208
  buffer_load_dwordx4 v1, s[36:39], s67 offen offset:0 sc1 lds
  v_exp_f32 v98, v98
  v_exp_f32 v99, v99
  v_exp_f32 v100, v100
  v_exp_f32 v101, v101
  v_exp_f32 v102, v102
  v_mfma_f32_32x32x16_bf16 v[80:95], v[188:191], v[180:183], v[160:175]
  s_waitcnt lgkmcnt(0)
  v_exp_f32 v103, v103
  v_exp_f32 v104, v104
  v_exp_f32 v105, v105
  v_exp_f32 v106, v106
  v_exp_f32 v107, v107
  v_smfmac_f32_32x32x32_bf16 v[128:143], v[192:195], v[96:103], v208
  v_exp_f32 v108, v108
  v_exp_f32 v109, v109
  v_exp_f32 v110, v110
  v_exp_f32 v111, v111
  v_exp_f32 v64, v64
  v_exp_f32 v65, v65
  v_smfmac_f32_32x32x32_bf16 v[128:143], v[196:199], v[104:111], v208
  ds_read_b128 v[188:191], v213 offset:21504
  v_exp_f32 v66, v66
  v_exp_f32 v67, v67
  v_exp_f32 v68, v68
  v_exp_f32 v69, v69
  v_exp_f32 v70, v70
  v_mfma_f32_32x32x16_bf16 v[96:111], v[184:187], v[176:179], v[144:159]
  ds_read_b128 v[192:195], v215 offset:6144
  v_exp_f32 v71, v71
  v_exp_f32 v72, v72
  v_exp_f32 v73, v73
  v_exp_f32 v74, v74
  v_exp_f32 v75, v75
  v_smfmac_f32_32x32x32_bf16 v[112:127], v[200:203], v[64:71], v208
  ds_read_b128 v[196:199], v215 offset:6656
  v_exp_f32 v76, v76
  v_exp_f32 v77, v77
  v_exp_f32 v78, v78
  v_exp_f32 v79, v79
  v_exp_f32 v80, v80
  v_exp_f32 v81, v81
  v_smfmac_f32_32x32x32_bf16 v[112:127], v[204:207], v[72:79], v208
  buffer_load_dwordx4 a[12:15], v212, s[20:23], s76 offen offset:0
  v_exp_f32 v82, v82
  v_exp_f32 v83, v83
  v_exp_f32 v84, v84
  v_exp_f32 v85, v85
  v_exp_f32 v86, v86
  v_mfma_f32_32x32x16_bf16 v[64:79], v[184:187], v[180:183], v[160:175]
  s_waitcnt lgkmcnt(0)
  v_exp_f32 v87, v87
  v_exp_f32 v88, v88
  v_exp_f32 v89, v89
  v_exp_f32 v90, v90
  v_exp_f32 v91, v91
  v_smfmac_f32_32x32x32_bf16 v[128:143], v[200:203], v[80:87], v208
  buffer_load_dwordx4 a[16:19], v209, s[20:23], s76 offen offset:64
  v_exp_f32 v92, v92
  v_exp_f32 v93, v93
  v_exp_f32 v94, v94
  v_exp_f32 v95, v95
  v_exp_f32 v96, v96
  v_exp_f32 v97, v97
  v_smfmac_f32_32x32x32_bf16 v[128:143], v[204:207], v[88:95], v208
  ds_read_b128 v[184:187], v213 offset:24576
  v_exp_f32 v98, v98
  v_exp_f32 v99, v99
  v_exp_f32 v100, v100
  v_exp_f32 v101, v101
  v_exp_f32 v102, v102
  v_mfma_f32_32x32x16_bf16 v[80:95], v[188:191], v[176:179], v[144:159]
  ds_read_b128 v[200:203], v215 offset:7168
  v_exp_f32 v103, v103
  v_exp_f32 v104, v104
  v_exp_f32 v105, v105
  v_exp_f32 v106, v106
  v_exp_f32 v107, v107
  v_smfmac_f32_32x32x32_bf16 v[112:127], v[192:195], v[96:103], v208
  ds_read_b128 v[204:207], v215 offset:7680
  v_exp_f32 v108, v108
  v_exp_f32 v109, v109
  v_exp_f32 v110, v110
  v_exp_f32 v111, v111
  v_exp_f32 v64, v64
  v_exp_f32 v65, v65
  v_smfmac_f32_32x32x32_bf16 v[112:127], v[196:199], v[104:111], v208
  buffer_load_dwordx4 v1, s[36:39], s67 offen offset:1024 sc1 lds
  v_exp_f32 v66, v66
  v_exp_f32 v67, v67
  v_exp_f32 v68, v68
  v_exp_f32 v69, v69
  v_exp_f32 v70, v70
  v_mfma_f32_32x32x16_bf16 v[96:111], v[188:191], v[180:183], v[160:175]
  s_waitcnt lgkmcnt(0)
  v_exp_f32 v71, v71
  v_exp_f32 v72, v72
  v_exp_f32 v73, v73
  v_exp_f32 v74, v74
  v_exp_f32 v75, v75
  v_smfmac_f32_32x32x32_bf16 v[128:143], v[192:195], v[64:71], v208
  v_exp_f32 v76, v76
  v_exp_f32 v77, v77
  v_exp_f32 v78, v78
  v_exp_f32 v79, v79
  v_exp_f32 v80, v80
  v_exp_f32 v81, v81
  v_smfmac_f32_32x32x32_bf16 v[128:143], v[196:199], v[72:79], v208
  ds_read_b128 v[188:191], v213 offset:25600
  v_exp_f32 v82, v82
  v_exp_f32 v83, v83
  v_exp_f32 v84, v84
  v_exp_f32 v85, v85
  v_exp_f32 v86, v86
  v_mfma_f32_32x32x16_bf16 v[64:79], v[184:187], v[176:179], v[144:159]
  ds_read_b128 v[192:195], v215 offset:10240
  v_exp_f32 v87, v87
  v_exp_f32 v88, v88
  v_exp_f32 v89, v89
  v_exp_f32 v90, v90
  v_exp_f32 v91, v91
  v_smfmac_f32_32x32x32_bf16 v[112:127], v[200:203], v[80:87], v208
  ds_read_b128 v[196:199], v215 offset:10752
  v_exp_f32 v92, v92
  v_exp_f32 v93, v93
  v_exp_f32 v94, v94
  v_exp_f32 v95, v95
  v_exp_f32 v96, v96
  v_exp_f32 v97, v97
  v_smfmac_f32_32x32x32_bf16 v[112:127], v[204:207], v[88:95], v208
  buffer_load_dwordx4 a[20:23], v210, s[20:23], s76 offen offset:64
  v_exp_f32 v98, v98
  v_exp_f32 v99, v99
  v_exp_f32 v100, v100
  v_exp_f32 v101, v101
  v_exp_f32 v102, v102
  v_mfma_f32_32x32x16_bf16 v[80:95], v[184:187], v[180:183], v[160:175]
  s_waitcnt lgkmcnt(0)
  v_exp_f32 v103, v103
  v_exp_f32 v104, v104
  v_exp_f32 v105, v105
  v_exp_f32 v106, v106
  v_exp_f32 v107, v107
  v_smfmac_f32_32x32x32_bf16 v[128:143], v[200:203], v[96:103], v208
  buffer_load_dwordx4 a[24:27], v211, s[20:23], s76 offen offset:64
  v_exp_f32 v108, v108
  v_exp_f32 v109, v109
  v_exp_f32 v110, v110
  v_exp_f32 v111, v111
  v_exp_f32 v64, v64
  v_exp_f32 v65, v65
  v_smfmac_f32_32x32x32_bf16 v[128:143], v[204:207], v[104:111], v208
  ds_read_b128 v[184:187], v213 offset:28672
  v_exp_f32 v66, v66
  v_exp_f32 v67, v67
  v_exp_f32 v68, v68
  v_exp_f32 v69, v69
  v_exp_f32 v70, v70
  v_mfma_f32_32x32x16_bf16 v[96:111], v[188:191], v[176:179], v[144:159]
  ds_read_b128 v[200:203], v215 offset:11264
  v_exp_f32 v71, v71
  v_exp_f32 v72, v72
  v_exp_f32 v73, v73
  v_exp_f32 v74, v74
  v_exp_f32 v75, v75
  v_smfmac_f32_32x32x32_bf16 v[112:127], v[192:195], v[64:71], v208
  ds_read_b128 v[204:207], v215 offset:11776
  v_exp_f32 v76, v76
  v_exp_f32 v77, v77
  v_exp_f32 v78, v78
  v_exp_f32 v79, v79
  v_exp_f32 v80, v80
  v_exp_f32 v81, v81
  v_smfmac_f32_32x32x32_bf16 v[112:127], v[196:199], v[72:79], v208
  buffer_load_dwordx4 v1, s[36:39], s67 offen offset:2048 sc1 lds
  v_exp_f32 v82, v82
  v_exp_f32 v83, v83
  v_exp_f32 v84, v84
  v_exp_f32 v85, v85
  v_exp_f32 v86, v86
  v_mfma_f32_32x32x16_bf16 v[64:79], v[188:191], v[180:183], v[160:175]
  s_waitcnt lgkmcnt(0)
  v_exp_f32 v87, v87
  v_exp_f32 v88, v88
  v_exp_f32 v89, v89
  v_exp_f32 v90, v90
  v_exp_f32 v91, v91
  v_smfmac_f32_32x32x32_bf16 v[128:143], v[192:195], v[80:87], v208
  buffer_load_dwordx4 a[28:31], v212, s[20:23], s76 offen offset:64
  v_exp_f32 v92, v92
  v_exp_f32 v93, v93
  v_exp_f32 v94, v94
  v_exp_f32 v95, v95
  v_exp_f32 v96, v96
  v_exp_f32 v97, v97
  v_smfmac_f32_32x32x32_bf16 v[128:143], v[196:199], v[88:95], v208
  ds_read_b128 v[188:191], v213 offset:29696
  v_exp_f32 v98, v98
  v_exp_f32 v99, v99
  v_exp_f32 v100, v100
  v_exp_f32 v101, v101
  v_exp_f32 v102, v102
  v_mfma_f32_32x32x16_bf16 v[80:95], v[184:187], v[176:179], v[144:159]
  ds_read_b128 v[192:195], v215 offset:14336
  v_exp_f32 v103, v103
  v_exp_f32 v104, v104
  v_exp_f32 v105, v105
  v_exp_f32 v106, v106
  v_exp_f32 v107, v107
  v_smfmac_f32_32x32x32_bf16 v[112:127], v[200:203], v[96:103], v208
  ds_read_b128 v[196:199], v215 offset:14848
  v_exp_f32 v108, v108
  v_exp_f32 v109, v109
  v_exp_f32 v110, v110
  v_exp_f32 v111, v111
  v_exp_f32 v64, v64
  v_exp_f32 v65, v65
  v_smfmac_f32_32x32x32_bf16 v[112:127], v[204:207], v[104:111], v208
  v_exp_f32 v66, v66
  v_exp_f32 v67, v67
  v_exp_f32 v68, v68
  v_exp_f32 v69, v69
  v_exp_f32 v70, v70
  v_mfma_f32_32x32x16_bf16 v[96:111], v[184:187], v[180:183], v[160:175]
  s_waitcnt vmcnt(14) lgkmcnt(0)
  s_barrier
  v_exp_f32 v71, v71
  v_exp_f32 v72, v72
  v_exp_f32 v73, v73
  v_exp_f32 v74, v74
  v_exp_f32 v75, v75
  v_smfmac_f32_32x32x32_bf16 v[128:143], v[200:203], v[64:71], v208
  buffer_load_dwordx4 a[32:35], v209, s[20:23], s77 offen offset:0
  v_exp_f32 v76, v76
  v_exp_f32 v77, v77
  v_exp_f32 v78, v78
  v_exp_f32 v79, v79
  v_exp_f32 v80, v80
  v_exp_f32 v81, v81
  v_smfmac_f32_32x32x32_bf16 v[128:143], v[204:207], v[72:79], v208
  ds_read_b128 v[184:187], v213 offset:32768
  v_exp_f32 v82, v82
  v_exp_f32 v83, v83
  v_exp_f32 v84, v84
  v_exp_f32 v85, v85
  v_exp_f32 v86, v86
  v_mfma_f32_32x32x16_bf16 v[64:79], v[188:191], v[176:179], v[144:159]
  ds_read_b128 v[200:203], v215 offset:15360
  v_exp_f32 v87, v87
  v_exp_f32 v88, v88
  v_exp_f32 v89, v89
  v_exp_f32 v90, v90
  v_exp_f32 v91, v91
  v_smfmac_f32_32x32x32_bf16 v[112:127], v[192:195], v[80:87], v208
  ds_read_b128 v[204:207], v215 offset:15872
  v_exp_f32 v92, v92
  v_exp_f32 v93, v93
  v_exp_f32 v94, v94
  v_exp_f32 v95, v95
  v_exp_f32 v96, v96
  v_exp_f32 v97, v97
  v_smfmac_f32_32x32x32_bf16 v[112:127], v[196:199], v[88:95], v208
  buffer_load_dwordx4 v1, s[36:39], s67 offen offset:3072 sc1 lds
  v_exp_f32 v98, v98
  v_exp_f32 v99, v99
  v_exp_f32 v100, v100
  v_exp_f32 v101, v101
  v_exp_f32 v102, v102
  v_mfma_f32_32x32x16_bf16 v[80:95], v[188:191], v[180:183], v[160:175]
  s_waitcnt lgkmcnt(0)
  v_exp_f32 v103, v103
  v_exp_f32 v104, v104
  v_exp_f32 v105, v105
  v_exp_f32 v106, v106
  v_exp_f32 v107, v107
  v_smfmac_f32_32x32x32_bf16 v[128:143], v[192:195], v[96:103], v208
  buffer_load_dwordx4 a[36:39], v210, s[20:23], s77 offen offset:0
  v_exp_f32 v108, v108
  v_exp_f32 v109, v109
  v_exp_f32 v110, v110
  v_exp_f32 v111, v111
  v_exp_f32 v64, v64
  v_exp_f32 v65, v65
  v_smfmac_f32_32x32x32_bf16 v[128:143], v[196:199], v[104:111], v208
  ds_read_b128 v[188:191], v213 offset:33792
  v_add_u32 v215, v215, v216
  v_exp_f32 v66, v66
  v_exp_f32 v67, v67
  v_exp_f32 v68, v68
  v_exp_f32 v69, v69
  v_exp_f32 v70, v70
  v_mfma_f32_32x32x16_bf16 v[96:111], v[184:187], v[176:179], v[144:159]
  ds_read_b128 v[192:195], v215 offset:2048
  v_exp_f32 v71, v71
  v_exp_f32 v72, v72
  v_exp_f32 v73, v73
  v_exp_f32 v74, v74
  v_exp_f32 v75, v75
  v_smfmac_f32_32x32x32_bf16 v[112:127], v[200:203], v[64:71], v208
  ds_read_b128 v[196:199], v215 offset:2560
  v_exp_f32 v76, v76
  v_exp_f32 v77, v77
  v_exp_f32 v78, v78
  v_exp_f32 v79, v79
  v_exp_f32 v80, v80
  v_exp_f32 v81, v81
  v_smfmac_f32_32x32x32_bf16 v[112:127], v[204:207], v[72:79], v208
  v_exp_f32 v82, v82
  v_exp_f32 v83, v83
  v_exp_f32 v84, v84
  v_exp_f32 v85, v85
  v_exp_f32 v86, v86
  v_mfma_f32_32x32x16_bf16 v[64:79], v[184:187], v[180:183], v[160:175]
  s_waitcnt lgkmcnt(0)
  v_exp_f32 v87, v87
  v_exp_f32 v88, v88
  v_exp_f32 v89, v89
  v_exp_f32 v90, v90
  v_exp_f32 v91, v91
  v_smfmac_f32_32x32x32_bf16 v[128:143], v[200:203], v[80:87], v208
  buffer_load_dwordx4 a[40:43], v211, s[20:23], s77 offen offset:0
  v_exp_f32 v92, v92
  v_exp_f32 v93, v93
  v_exp_f32 v94, v94
  v_exp_f32 v95, v95
  v_exp_f32 v96, v96
  v_exp_f32 v97, v97
  v_smfmac_f32_32x32x32_bf16 v[128:143], v[204:207], v[88:95], v208
  ds_read_b128 v[184:187], v213 offset:36864
  v_exp_f32 v98, v98
  v_exp_f32 v99, v99
  v_exp_f32 v100, v100
  v_exp_f32 v101, v101
  v_exp_f32 v102, v102
  v_mfma_f32_32x32x16_bf16 v[80:95], v[188:191], v[176:179], v[144:159]
  ds_read_b128 v[200:203], v215 offset:3072
  v_exp_f32 v103, v103
  v_exp_f32 v104, v104
  v_exp_f32 v105, v105
  v_exp_f32 v106, v106
  v_exp_f32 v107, v107
  v_smfmac_f32_32x32x32_bf16 v[112:127], v[192:195], v[96:103], v208
  ds_read_b128 v[204:207], v215 offset:3584
  s_add_u32 m0, s73, 98304
  v_exp_f32 v108, v108
  v_exp_f32 v109, v109
  v_exp_f32 v110, v110
  v_exp_f32 v111, v111
  v_exp_f32 v64, v64
  v_exp_f32 v65, v65
  v_smfmac_f32_32x32x32_bf16 v[112:127], v[196:199], v[104:111], v208
  buffer_load_dwordx4 v1, s[36:39], s68 offen offset:0 sc1 lds
  v_exp_f32 v66, v66
  v_exp_f32 v67, v67
  v_exp_f32 v68, v68
  v_exp_f32 v69, v69
  v_exp_f32 v70, v70
  v_mfma_f32_32x32x16_bf16 v[96:111], v[188:191], v[180:183], v[160:175]
  s_waitcnt lgkmcnt(0)
  v_exp_f32 v71, v71
  v_exp_f32 v72, v72
  v_exp_f32 v73, v73
  v_exp_f32 v74, v74
  v_exp_f32 v75, v75
  v_smfmac_f32_32x32x32_bf16 v[128:143], v[192:195], v[64:71], v208
  buffer_load_dwordx4 a[44:47], v212, s[20:23], s77 offen offset:0
  v_exp_f32 v76, v76
  v_exp_f32 v77, v77
  v_exp_f32 v78, v78
  v_exp_f32 v79, v79
  v_exp_f32 v80, v80
  v_exp_f32 v81, v81
  v_smfmac_f32_32x32x32_bf16 v[128:143], v[196:199], v[72:79], v208
  ds_read_b128 v[188:191], v213 offset:37888
  v_exp_f32 v82, v82
  v_exp_f32 v83, v83
  v_exp_f32 v84, v84
  v_exp_f32 v85, v85
  v_exp_f32 v86, v86
  v_mfma_f32_32x32x16_bf16 v[64:79], v[184:187], v[176:179], v[144:159]
  ds_read_b128 v[192:195], v215 offset:6144
  v_exp_f32 v87, v87
  v_exp_f32 v88, v88
  v_exp_f32 v89, v89
  v_exp_f32 v90, v90
  v_exp_f32 v91, v91
  v_smfmac_f32_32x32x32_bf16 v[112:127], v[200:203], v[80:87], v208
  ds_read_b128 v[196:199], v215 offset:6656
  v_exp_f32 v92, v92
  v_exp_f32 v93, v93
  v_exp_f32 v94, v94
  v_exp_f32 v95, v95
  v_exp_f32 v96, v96
  v_exp_f32 v97, v97
  v_smfmac_f32_32x32x32_bf16 v[112:127], v[204:207], v[88:95], v208
  buffer_load_dwordx4 v[228:231], v49, s[12:15], s61 offen
  v_exp_f32 v98, v98
  v_exp_f32 v99, v99
  v_exp_f32 v100, v100
  v_exp_f32 v101, v101
  v_exp_f32 v102, v102
  v_mfma_f32_32x32x16_bf16 v[80:95], v[184:187], v[180:183], v[160:175]
  s_waitcnt lgkmcnt(0)
  v_exp_f32 v103, v103
  v_exp_f32 v104, v104
  v_exp_f32 v105, v105
  v_exp_f32 v106, v106
  v_exp_f32 v107, v107
  v_smfmac_f32_32x32x32_bf16 v[128:143], v[200:203], v[96:103], v208
  buffer_load_dwordx4 a[48:51], v209, s[20:23], s77 offen offset:64
  v_exp_f32 v108, v108
  v_exp_f32 v109, v109
  v_exp_f32 v110, v110
  v_exp_f32 v111, v111
  v_exp_f32 v64, v64
  v_exp_f32 v65, v65
  v_smfmac_f32_32x32x32_bf16 v[128:143], v[204:207], v[104:111], v208
  ds_read_b128 v[184:187], v213 offset:40960
  v_exp_f32 v66, v66
  v_exp_f32 v67, v67
  v_exp_f32 v68, v68
  v_exp_f32 v69, v69
  v_exp_f32 v70, v70
  v_mfma_f32_32x32x16_bf16 v[96:111], v[188:191], v[176:179], v[144:159]
  ds_read_b128 v[200:203], v215 offset:7168
  v_exp_f32 v71, v71
  v_exp_f32 v72, v72
  v_exp_f32 v73, v73
  v_exp_f32 v74, v74
  v_exp_f32 v75, v75
  v_smfmac_f32_32x32x32_bf16 v[112:127], v[192:195], v[64:71], v208
  ds_read_b128 v[204:207], v215 offset:7680
  v_exp_f32 v76, v76
  v_exp_f32 v77, v77
  v_exp_f32 v78, v78
  v_exp_f32 v79, v79
  v_exp_f32 v80, v80
  v_exp_f32 v81, v81
  v_smfmac_f32_32x32x32_bf16 v[112:127], v[196:199], v[72:79], v208
  buffer_load_dwordx4 v1, s[36:39], s68 offen offset:1024 sc1 lds
  v_exp_f32 v82, v82
  v_exp_f32 v83, v83
  v_exp_f32 v84, v84
  v_exp_f32 v85, v85
  v_exp_f32 v86, v86
  v_mfma_f32_32x32x16_bf16 v[64:79], v[188:191], v[180:183], v[160:175]
  s_waitcnt lgkmcnt(0)
  v_exp_f32 v87, v87
  v_exp_f32 v88, v88
  v_exp_f32 v89, v89
  v_exp_f32 v90, v90
  v_exp_f32 v91, v91
  v_smfmac_f32_32x32x32_bf16 v[128:143], v[192:195], v[80:87], v208
  v_exp_f32 v92, v92
  v_exp_f32 v93, v93
  v_exp_f32 v94, v94
  v_exp_f32 v95, v95
  v_exp_f32 v96, v96
  v_exp_f32 v97, v97
  v_smfmac_f32_32x32x32_bf16 v[128:143], v[196:199], v[88:95], v208
  ds_read_b128 v[188:191], v213 offset:41984
  v_exp_f32 v98, v98
  v_exp_f32 v99, v99
  v_exp_f32 v100, v100
  v_exp_f32 v101, v101
  v_exp_f32 v102, v102
  v_mfma_f32_32x32x16_bf16 v[80:95], v[184:187], v[176:179], v[144:159]
  ds_read_b128 v[192:195], v215 offset:10240
  v_exp_f32 v103, v103
  v_exp_f32 v104, v104
  v_exp_f32 v105, v105
  v_exp_f32 v106, v106
  v_exp_f32 v107, v107
  v_smfmac_f32_32x32x32_bf16 v[112:127], v[200:203], v[96:103], v208
  ds_read_b128 v[196:199], v215 offset:10752
  v_exp_f32 v108, v108
  v_exp_f32 v109, v109
  v_exp_f32 v110, v110
  v_exp_f32 v111, v111
  v_exp_f32 v64, v64
  v_exp_f32 v65, v65
  v_smfmac_f32_32x32x32_bf16 v[112:127], v[204:207], v[104:111], v208
  buffer_load_dwordx4 v[228:231], v1, s[16:19], s62 offen
  v_exp_f32 v66, v66
  v_exp_f32 v67, v67
  v_exp_f32 v68, v68
  v_exp_f32 v69, v69
  v_exp_f32 v70, v70
  v_mfma_f32_32x32x16_bf16 v[96:111], v[184:187], v[180:183], v[160:175]
  s_waitcnt lgkmcnt(0)
  v_exp_f32 v71, v71
  v_exp_f32 v72, v72
  v_exp_f32 v73, v73
  v_exp_f32 v74, v74
  v_exp_f32 v75, v75
  v_smfmac_f32_32x32x32_bf16 v[128:143], v[200:203], v[64:71], v208
  buffer_load_dwordx4 a[52:55], v210, s[20:23], s77 offen offset:64
  v_exp_f32 v76, v76
  v_exp_f32 v77, v77
  v_exp_f32 v78, v78
  v_exp_f32 v79, v79
  v_exp_f32 v80, v80
  v_exp_f32 v81, v81
  v_smfmac_f32_32x32x32_bf16 v[128:143], v[204:207], v[72:79], v208
  ds_read_b128 v[184:187], v213 offset:45056
  v_exp_f32 v82, v82
  v_exp_f32 v83, v83
  v_exp_f32 v84, v84
  v_exp_f32 v85, v85
  v_exp_f32 v86, v86
  v_mfma_f32_32x32x16_bf16 v[64:79], v[188:191], v[176:179], v[144:159]
  ds_read_b128 v[200:203], v215 offset:11264
  v_exp_f32 v87, v87
  v_exp_f32 v88, v88
  v_exp_f32 v89, v89
  v_exp_f32 v90, v90
  v_exp_f32 v91, v91
  v_smfmac_f32_32x32x32_bf16 v[112:127], v[192:195], v[80:87], v208
  ds_read_b128 v[204:207], v215 offset:11776
  v_exp_f32 v92, v92
  v_exp_f32 v93, v93
  v_exp_f32 v94, v94
  v_exp_f32 v95, v95
  v_exp_f32 v96, v96
  v_exp_f32 v97, v97
  v_smfmac_f32_32x32x32_bf16 v[112:127], v[196:199], v[88:95], v208
  buffer_load_dwordx4 v1, s[36:39], s68 offen offset:2048 sc1 lds
  v_exp_f32 v98, v98
  v_exp_f32 v99, v99
  v_exp_f32 v100, v100
  v_exp_f32 v101, v101
  v_exp_f32 v102, v102
  v_mfma_f32_32x32x16_bf16 v[80:95], v[188:191], v[180:183], v[160:175]
  s_waitcnt lgkmcnt(0)
  v_exp_f32 v103, v103
  v_exp_f32 v104, v104
  v_exp_f32 v105, v105
  v_exp_f32 v106, v106
  v_exp_f32 v107, v107
  v_smfmac_f32_32x32x32_bf16 v[128:143], v[192:195], v[96:103], v208
  buffer_load_dwordx4 a[56:59], v211, s[20:23], s77 offen offset:64
  v_exp_f32 v108, v108
  v_exp_f32 v109, v109
  v_exp_f32 v110, v110
  v_exp_f32 v111, v111
  v_exp_f32 v64, v64
  v_exp_f32 v65, v65
  v_smfmac_f32_32x32x32_bf16 v[128:143], v[196:199], v[104:111], v208
  ds_read_b128 v[188:191], v213 offset:46080
  v_exp_f32 v66, v66
  v_exp_f32 v67, v67
  v_exp_f32 v68, v68
  v_exp_f32 v69, v69
  v_exp_f32 v70, v70
  v_mfma_f32_32x32x16_bf16 v[96:111], v[184:187], v[176:179], v[144:159]
  ds_read_b128 v[192:195], v215 offset:14336
  v_exp_f32 v71, v71
  v_exp_f32 v72, v72
  v_exp_f32 v73, v73
  v_exp_f32 v74, v74
  v_exp_f32 v75, v75
  v_smfmac_f32_32x32x32_bf16 v[112:127], v[200:203], v[64:71], v208
  ds_read_b128 v[196:199], v215 offset:14848
  v_exp_f32 v76, v76
  v_exp_f32 v77, v77
  v_exp_f32 v78, v78
  v_exp_f32 v79, v79
  v_exp_f32 v80, v80
  v_exp_f32 v81, v81
  v_smfmac_f32_32x32x32_bf16 v[112:127], v[204:207], v[72:79], v208
  buffer_load_dwordx4 v[228:231], v51, s[16:19], s62 offen offset:1024
  v_exp_f32 v82, v82
  v_exp_f32 v83, v83
  v_exp_f32 v84, v84
  v_exp_f32 v85, v85
  v_exp_f32 v86, v86
  v_mfma_f32_32x32x16_bf16 v[64:79], v[184:187], v[180:183], v[160:175]
  s_waitcnt vmcnt(12) lgkmcnt(0)
  s_barrier
  v_exp_f32 v87, v87
  v_exp_f32 v88, v88
  v_exp_f32 v89, v89
  v_exp_f32 v90, v90
  v_exp_f32 v91, v91
  v_smfmac_f32_32x32x32_bf16 v[128:143], v[200:203], v[80:87], v208
  v_exp_f32 v92, v92
  v_exp_f32 v93, v93
  v_exp_f32 v94, v94
  v_exp_f32 v95, v95
  v_exp_f32 v96, v96
  v_exp_f32 v97, v97
  v_smfmac_f32_32x32x32_bf16 v[128:143], v[204:207], v[88:95], v208
  ds_read_b128 v[184:187], v213 offset:49152
  v_exp_f32 v98, v98
  v_exp_f32 v99, v99
  v_exp_f32 v100, v100
  v_exp_f32 v101, v101
  v_exp_f32 v102, v102
  v_mfma_f32_32x32x16_bf16 v[80:95], v[188:191], v[176:179], v[144:159]
  ds_read_b128 v[200:203], v215 offset:15360
  v_exp_f32 v103, v103
  v_exp_f32 v104, v104
  v_exp_f32 v105, v105
  v_exp_f32 v106, v106
  v_exp_f32 v107, v107
  v_smfmac_f32_32x32x32_bf16 v[112:127], v[192:195], v[96:103], v208
  ds_read_b128 v[204:207], v215 offset:15872
  v_exp_f32 v108, v108
  v_exp_f32 v109, v109
  v_exp_f32 v110, v110
  v_exp_f32 v111, v111
  v_exp_f32 v64, v64
  v_exp_f32 v65, v65
  v_smfmac_f32_32x32x32_bf16 v[112:127], v[196:199], v[104:111], v208
  buffer_load_dwordx4 v1, s[36:39], s68 offen offset:3072 sc1 lds
  v_exp_f32 v66, v66
  v_exp_f32 v67, v67
  v_exp_f32 v68, v68
  v_exp_f32 v69, v69
  v_exp_f32 v70, v70
  v_mfma_f32_32x32x16_bf16 v[96:111], v[188:191], v[180:183], v[160:175]
  s_waitcnt lgkmcnt(0)
  v_exp_f32 v71, v71
  v_exp_f32 v72, v72
  v_exp_f32 v73, v73
  v_exp_f32 v74, v74
  v_exp_f32 v75, v75
  v_smfmac_f32_32x32x32_bf16 v[128:143], v[192:195], v[64:71], v208
  buffer_load_dwordx4 a[60:63], v212, s[20:23], s77 offen offset:64
  v_exp_f32 v76, v76
  v_exp_f32 v77, v77
  v_exp_f32 v78, v78
  v_exp_f32 v79, v79
  v_exp_f32 v80, v80
  v_exp_f32 v81, v81
  v_smfmac_f32_32x32x32_bf16 v[128:143], v[196:199], v[72:79], v208
  ds_read_b128 v[188:191], v213 offset:50176
  v_add_u32 v215, v215, v216
  v_exp_f32 v82, v82
  v_exp_f32 v83, v83
  v_exp_f32 v84, v84
  v_exp_f32 v85, v85
  v_exp_f32 v86, v86
  v_mfma_f32_32x32x16_bf16 v[64:79], v[184:187], v[176:179], v[144:159]
  ds_read_b128 v[192:195], v215 offset:2048
  v_exp_f32 v87, v87
  v_exp_f32 v88, v88
  v_exp_f32 v89, v89
  v_exp_f32 v90, v90
  v_exp_f32 v91, v91
  v_smfmac_f32_32x32x32_bf16 v[112:127], v[200:203], v[80:87], v208
  ds_read_b128 v[196:199], v215 offset:2560
  v_exp_f32 v92, v92
  v_exp_f32 v93, v93
  v_exp_f32 v94, v94
  v_exp_f32 v95, v95
  v_exp_f32 v96, v96
  v_exp_f32 v97, v97
  v_smfmac_f32_32x32x32_bf16 v[112:127], v[204:207], v[88:95], v208
  buffer_load_dwordx4 v[228:231], v50, s[28:31], s63 offen
  v_exp_f32 v98, v98
  v_exp_f32 v99, v99
  v_exp_f32 v100, v100
  v_exp_f32 v101, v101
  v_exp_f32 v102, v102
  v_mfma_f32_32x32x16_bf16 v[80:95], v[184:187], v[180:183], v[160:175]
  s_waitcnt lgkmcnt(0)
  v_exp_f32 v103, v103
  v_exp_f32 v104, v104
  v_exp_f32 v105, v105
  v_exp_f32 v106, v106
  v_exp_f32 v107, v107
  v_smfmac_f32_32x32x32_bf16 v[128:143], v[200:203], v[96:103], v208
  buffer_load_dwordx4 a[64:67], v209, s[20:23], s78 offen offset:0
  v_exp_f32 v108, v108
  v_exp_f32 v109, v109
  v_exp_f32 v110, v110
  v_exp_f32 v111, v111
  v_exp_f32 v64, v64
  v_exp_f32 v65, v65
  v_smfmac_f32_32x32x32_bf16 v[128:143], v[204:207], v[104:111], v208
  ds_read_b128 v[184:187], v213 offset:53248
  v_exp_f32 v66, v66
  v_exp_f32 v67, v67
  v_exp_f32 v68, v68
  v_exp_f32 v69, v69
  v_exp_f32 v70, v70
  v_mfma_f32_32x32x16_bf16 v[96:111], v[188:191], v[176:179], v[144:159]
  ds_read_b128 v[200:203], v215 offset:3072
  v_exp_f32 v71, v71
  v_exp_f32 v72, v72
  v_exp_f32 v73, v73
  v_exp_f32 v74, v74
  v_exp_f32 v75, v75
  v_smfmac_f32_32x32x32_bf16 v[112:127], v[192:195], v[64:71], v208
  ds_read_b128 v[204:207], v215 offset:3584
  s_add_u32 m0, s73, 114688
  v_exp_f32 v76, v76
  v_exp_f32 v77, v77
  v_exp_f32 v78, v78
  v_exp_f32 v79, v79
  v_exp_f32 v80, v80
  v_exp_f32 v81, v81
  v_smfmac_f32_32x32x32_bf16 v[112:127], v[196:199], v[72:79], v208
  buffer_load_dwordx4 v1, s[36:39], s69 offen offset:0 sc1 lds
  v_exp_f32 v82, v82
  v_exp_f32 v83, v83
  v_exp_f32 v84, v84
  v_exp_f32 v85, v85
  v_exp_f32 v86, v86
  v_mfma_f32_32x32x16_bf16 v[64:79], v[188:191], v[180:183], v[160:175]
  s_waitcnt lgkmcnt(0)
  v_exp_f32 v87, v87
  v_exp_f32 v88, v88
  v_exp_f32 v89, v89
  v_exp_f32 v90, v90
  v_exp_f32 v91, v91
  v_smfmac_f32_32x32x32_bf16 v[128:143], v[192:195], v[80:87], v208
  buffer_load_dwordx4 a[68:71], v210, s[20:23], s78 offen offset:0
  v_exp_f32 v92, v92
  v_exp_f32 v93, v93
  v_exp_f32 v94, v94
  v_exp_f32 v95, v95
  v_exp_f32 v96, v96
  v_exp_f32 v97, v97
  v_smfmac_f32_32x32x32_bf16 v[128:143], v[196:199], v[88:95], v208
  ds_read_b128 v[188:191], v213 offset:54272
  v_exp_f32 v98, v98
  v_exp_f32 v99, v99
  v_exp_f32 v100, v100
  v_exp_f32 v101, v101
  v_exp_f32 v102, v102
  v_mfma_f32_32x32x16_bf16 v[80:95], v[184:187], v[176:179], v[144:159]
  ds_read_b128 v[192:195], v215 offset:6144
  v_exp_f32 v103, v103
  v_exp_f32 v104, v104
  v_exp_f32 v105, v105
  v_exp_f32 v106, v106
  v_exp_f32 v107, v107
  v_smfmac_f32_32x32x32_bf16 v[112:127], v[200:203], v[96:103], v208
  ds_read_b128 v[196:199], v215 offset:6656
  v_exp_f32 v108, v108
  v_exp_f32 v109, v109
  v_exp_f32 v110, v110
  v_exp_f32 v111, v111
  v_exp_f32 v64, v64
  v_exp_f32 v65, v65
  v_smfmac_f32_32x32x32_bf16 v[112:127], v[204:207], v[104:111], v208
  buffer_load_dword v228, v234, s[24:27], 0 offen
  v_exp_f32 v66, v66
  v_exp_f32 v67, v67
  v_exp_f32 v68, v68
  v_exp_f32 v69, v69
  v_exp_f32 v70, v70
  v_mfma_f32_32x32x16_bf16 v[96:111], v[184:187], v[180:183], v[160:175]
  s_waitcnt lgkmcnt(0)
  v_exp_f32 v71, v71
  v_exp_f32 v72, v72
  v_exp_f32 v73, v73
  v_exp_f32 v74, v74
  v_exp_f32 v75, v75
  v_smfmac_f32_32x32x32_bf16 v[128:143], v[200:203], v[64:71], v208
  v_exp_f32 v76, v76
  v_exp_f32 v77, v77
  v_exp_f32 v78, v78
  v_exp_f32 v79, v79
  v_exp_f32 v80, v80
  v_exp_f32 v81, v81
  v_smfmac_f32_32x32x32_bf16 v[128:143], v[204:207], v[72:79], v208
  ds_read_b128 v[184:187], v213 offset:57344
  v_exp_f32 v82, v82
  v_exp_f32 v83, v83
  v_exp_f32 v84, v84
  v_exp_f32 v85, v85
  v_exp_f32 v86, v86
  v_mfma_f32_32x32x16_bf16 v[64:79], v[188:191], v[176:179], v[144:159]
  ds_read_b128 v[200:203], v215 offset:7168
  v_exp_f32 v87, v87
  v_exp_f32 v88, v88
  v_exp_f32 v89, v89
  v_exp_f32 v90, v90
  v_exp_f32 v91, v91
  v_smfmac_f32_32x32x32_bf16 v[112:127], v[192:195], v[80:87], v208
  ds_read_b128 v[204:207], v215 offset:7680
  v_exp_f32 v92, v92
  v_exp_f32 v93, v93
  v_exp_f32 v94, v94
  v_exp_f32 v95, v95
  v_exp_f32 v96, v96
  v_exp_f32 v97, v97
  v_smfmac_f32_32x32x32_bf16 v[112:127], v[196:199], v[88:95], v208
  buffer_load_dwordx4 v1, s[36:39], s69 offen offset:1024 sc1 lds
  v_exp_f32 v98, v98
  v_exp_f32 v99, v99
  v_exp_f32 v100, v100
  v_exp_f32 v101, v101
  v_exp_f32 v102, v102
  v_mfma_f32_32x32x16_bf16 v[80:95], v[188:191], v[180:183], v[160:175]
  s_waitcnt lgkmcnt(0)
  v_exp_f32 v103, v103
  v_exp_f32 v104, v104
  v_exp_f32 v105, v105
  v_exp_f32 v106, v106
  v_exp_f32 v107, v107
  v_smfmac_f32_32x32x32_bf16 v[128:143], v[192:195], v[96:103], v208
  buffer_load_dwordx4 a[72:75], v211, s[20:23], s78 offen offset:0
  v_exp_f32 v108, v108
  v_exp_f32 v109, v109
  v_exp_f32 v110, v110
  v_exp_f32 v111, v111
  v_exp_f32 v64, v64
  v_exp_f32 v65, v65
  v_smfmac_f32_32x32x32_bf16 v[128:143], v[196:199], v[104:111], v208
  ds_read_b128 v[188:191], v213 offset:58368
  v_exp_f32 v66, v66
  v_exp_f32 v67, v67
  v_exp_f32 v68, v68
  v_exp_f32 v69, v69
  v_exp_f32 v70, v70
  v_mfma_f32_32x32x16_bf16 v[96:111], v[184:187], v[176:179], v[144:159]
  ds_read_b128 v[192:195], v215 offset:10240
  v_exp_f32 v71, v71
  v_exp_f32 v72, v72
  v_exp_f32 v73, v73
  v_exp_f32 v74, v74
  v_exp_f32 v75, v75
  v_smfmac_f32_32x32x32_bf16 v[112:127], v[200:203], v[64:71], v208
  ds_read_b128 v[196:199], v215 offset:10752
  v_exp_f32 v76, v76
  v_exp_f32 v77, v77
  v_exp_f32 v78, v78
  v_exp_f32 v79, v79
  v_exp_f32 v80, v80
  v_exp_f32 v81, v81
  v_smfmac_f32_32x32x32_bf16 v[112:127], v[204:207], v[72:79], v208
  buffer_load_dwordx4 a[76:79], v212, s[20:23], s78 offen offset:0
  v_exp_f32 v82, v82
  v_exp_f32 v83, v83
  v_exp_f32 v84, v84
  v_exp_f32 v85, v85
  v_exp_f32 v86, v86
  v_mfma_f32_32x32x16_bf16 v[64:79], v[184:187], v[180:183], v[160:175]
  s_waitcnt lgkmcnt(0)
  v_exp_f32 v87, v87
  v_exp_f32 v88, v88
  v_exp_f32 v89, v89
  v_exp_f32 v90, v90
  v_exp_f32 v91, v91
  v_smfmac_f32_32x32x32_bf16 v[128:143], v[200:203], v[80:87], v208
  v_exp_f32 v92, v92
  v_exp_f32 v93, v93
  v_exp_f32 v94, v94
  v_exp_f32 v95, v95
  v_exp_f32 v96, v96
  v_exp_f32 v97, v97
  v_smfmac_f32_32x32x32_bf16 v[128:143], v[204:207], v[88:95], v208
  ds_read_b128 v[184:187], v213 offset:61440
  v_exp_f32 v98, v98
  v_exp_f32 v99, v99
  v_exp_f32 v100, v100
  v_exp_f32 v101, v101
  v_exp_f32 v102, v102
  v_mfma_f32_32x32x16_bf16 v[80:95], v[188:191], v[176:179], v[144:159]
  ds_read_b128 v[200:203], v215 offset:11264
  v_exp_f32 v103, v103
  v_exp_f32 v104, v104
  v_exp_f32 v105, v105
  v_exp_f32 v106, v106
  v_exp_f32 v107, v107
  v_smfmac_f32_32x32x32_bf16 v[112:127], v[192:195], v[96:103], v208
  ds_read_b128 v[204:207], v215 offset:11776
  v_exp_f32 v108, v108
  v_exp_f32 v109, v109
  v_exp_f32 v110, v110
  v_exp_f32 v111, v111
  v_exp_f32 v64, v64
  v_exp_f32 v65, v65
  v_smfmac_f32_32x32x32_bf16 v[112:127], v[196:199], v[104:111], v208
  buffer_load_dwordx4 v1, s[36:39], s69 offen offset:2048 sc1 lds
  v_exp_f32 v66, v66
  v_exp_f32 v67, v67
  v_exp_f32 v68, v68
  v_exp_f32 v69, v69
  v_exp_f32 v70, v70
  v_mfma_f32_32x32x16_bf16 v[96:111], v[188:191], v[180:183], v[160:175]
  s_waitcnt lgkmcnt(0)
  v_exp_f32 v71, v71
  v_exp_f32 v72, v72
  v_exp_f32 v73, v73
  v_exp_f32 v74, v74
  v_exp_f32 v75, v75
  v_smfmac_f32_32x32x32_bf16 v[128:143], v[192:195], v[64:71], v208
  buffer_load_dwordx4 a[80:83], v209, s[20:23], s78 offen offset:64
  v_exp_f32 v76, v76
  v_exp_f32 v77, v77
  v_exp_f32 v78, v78
  v_exp_f32 v79, v79
  v_exp_f32 v80, v80
  v_exp_f32 v81, v81
  v_smfmac_f32_32x32x32_bf16 v[128:143], v[196:199], v[72:79], v208
  ds_read_b128 v[188:191], v213 offset:62464
  v_exp_f32 v82, v82
  v_exp_f32 v83, v83
  v_exp_f32 v84, v84
  v_exp_f32 v85, v85
  v_exp_f32 v86, v86
  v_mfma_f32_32x32x16_bf16 v[64:79], v[184:187], v[176:179], v[144:159]
  ds_read_b128 v[192:195], v215 offset:14336
  v_exp_f32 v87, v87
  v_exp_f32 v88, v88
  v_exp_f32 v89, v89
  v_exp_f32 v90, v90
  v_exp_f32 v91, v91
  v_smfmac_f32_32x32x32_bf16 v[112:127], v[200:203], v[80:87], v208
  ds_read_b128 v[196:199], v215 offset:14848
  v_exp_f32 v92, v92
  v_exp_f32 v93, v93
  v_exp_f32 v94, v94
  v_exp_f32 v95, v95
  v_exp_f32 v96, v96
  v_exp_f32 v97, v97
  v_smfmac_f32_32x32x32_bf16 v[112:127], v[204:207], v[88:95], v208
  buffer_load_dwordx4 a[84:87], v210, s[20:23], s78 offen offset:64
  v_exp_f32 v98, v98
  v_exp_f32 v99, v99
  v_exp_f32 v100, v100
  v_exp_f32 v101, v101
  v_exp_f32 v102, v102
  v_mfma_f32_32x32x16_bf16 v[80:95], v[184:187], v[180:183], v[160:175]
  s_waitcnt vmcnt(12) lgkmcnt(0)
  s_barrier
  v_exp_f32 v103, v103
  v_exp_f32 v104, v104
  v_exp_f32 v105, v105
  v_exp_f32 v106, v106
  v_exp_f32 v107, v107
  v_smfmac_f32_32x32x32_bf16 v[128:143], v[200:203], v[96:103], v208
  buffer_load_dwordx4 a[88:91], v211, s[20:23], s78 offen offset:64
  v_exp_f32 v108, v108
  v_exp_f32 v109, v109
  v_exp_f32 v110, v110
  v_exp_f32 v111, v111
  v_exp_f32 v64, v64
  v_exp_f32 v65, v65
  v_smfmac_f32_32x32x32_bf16 v[128:143], v[204:207], v[104:111], v208
  ds_read_b128 v[184:187], v214 offset:0
  v_exp_f32 v66, v66
  v_exp_f32 v67, v67
  v_exp_f32 v68, v68
  v_exp_f32 v69, v69
  v_exp_f32 v70, v70
  v_mfma_f32_32x32x16_bf16 v[96:111], v[188:191], v[176:179], v[144:159]
  ds_read_b128 v[200:203], v215 offset:15360
  v_exp_f32 v71, v71
  v_exp_f32 v72, v72
  v_exp_f32 v73, v73
  v_exp_f32 v74, v74
  v_exp_f32 v75, v75
  v_smfmac_f32_32x32x32_bf16 v[112:127], v[192:195], v[64:71], v208
  ds_read_b128 v[204:207], v215 offset:15872
  v_exp_f32 v76, v76
  v_exp_f32 v77, v77
  v_exp_f32 v78, v78
  v_exp_f32 v79, v79
  v_exp_f32 v80, v80
  v_exp_f32 v81, v81
  v_smfmac_f32_32x32x32_bf16 v[112:127], v[196:199], v[72:79], v208
  buffer_load_dwordx4 v1, s[36:39], s69 offen offset:3072 sc1 lds
  v_exp_f32 v82, v82
  v_exp_f32 v83, v83
  v_exp_f32 v84, v84
  v_exp_f32 v85, v85
  v_exp_f32 v86, v86
  v_mfma_f32_32x32x16_bf16 v[64:79], v[188:191], v[180:183], v[160:175]
  s_waitcnt lgkmcnt(0)
  v_exp_f32 v87, v87
  v_exp_f32 v88, v88
  v_exp_f32 v89, v89
  v_exp_f32 v90, v90
  v_exp_f32 v91, v91
  v_smfmac_f32_32x32x32_bf16 v[128:143], v[192:195], v[80:87], v208
  v_exp_f32 v92, v92
  v_exp_f32 v93, v93
  v_exp_f32 v94, v94
  v_exp_f32 v95, v95
  v_exp_f32 v96, v96
  v_exp_f32 v97, v97
  v_smfmac_f32_32x32x32_bf16 v[128:143], v[196:199], v[88:95], v208
  ds_read_b128 v[188:191], v214 offset:1024
  v_add_u32 v215, v215, v216
  v_add_u32 v215, v215, v216
  v_add_u32 v215, v215, v216
  v_exp_f32 v98, v98
  v_exp_f32 v99, v99
  v_exp_f32 v100, v100
  v_exp_f32 v101, v101
  v_exp_f32 v102, v102
  v_mfma_f32_32x32x16_bf16 v[80:95], v[184:187], v[176:179], v[144:159]
  ds_read_b128 v[192:195], v215 offset:2048
  v_exp_f32 v103, v103
  v_exp_f32 v104, v104
  v_exp_f32 v105, v105
  v_exp_f32 v106, v106
  v_exp_f32 v107, v107
  v_smfmac_f32_32x32x32_bf16 v[112:127], v[200:203], v[96:103], v208
  ds_read_b128 v[196:199], v215 offset:2560
  v_exp_f32 v108, v108
  v_exp_f32 v109, v109
  v_exp_f32 v110, v110
  v_exp_f32 v111, v111
  v_exp_f32 v64, v64
  v_exp_f32 v65, v65
  v_smfmac_f32_32x32x32_bf16 v[112:127], v[204:207], v[104:111], v208
  buffer_load_dwordx4 a[92:95], v212, s[20:23], s78 offen offset:64
  v_exp_f32 v66, v66
  v_exp_f32 v67, v67
  v_exp_f32 v68, v68
  v_exp_f32 v69, v69
  v_exp_f32 v70, v70
  v_mfma_f32_32x32x16_bf16 v[96:111], v[184:187], v[180:183], v[160:175]
  s_waitcnt lgkmcnt(0)
  v_exp_f32 v71, v71
  v_exp_f32 v72, v72
  v_exp_f32 v73, v73
  v_exp_f32 v74, v74
  v_exp_f32 v75, v75
  v_smfmac_f32_32x32x32_bf16 v[128:143], v[200:203], v[64:71], v208
  buffer_load_dwordx4 a[96:99], v209, s[20:23], s79 offen offset:0
  v_exp_f32 v76, v76
  v_exp_f32 v77, v77
  v_exp_f32 v78, v78
  v_exp_f32 v79, v79
  v_exp_f32 v80, v80
  v_exp_f32 v81, v81
  v_smfmac_f32_32x32x32_bf16 v[128:143], v[204:207], v[72:79], v208
  ds_read_b128 v[184:187], v214 offset:4096
  v_exp_f32 v82, v82
  v_exp_f32 v83, v83
  v_exp_f32 v84, v84
  v_exp_f32 v85, v85
  v_exp_f32 v86, v86
  v_mfma_f32_32x32x16_bf16 v[64:79], v[188:191], v[176:179], v[144:159]
  ds_read_b128 v[200:203], v215 offset:3072
  v_exp_f32 v87, v87
  v_exp_f32 v88, v88
  v_exp_f32 v89, v89
  v_exp_f32 v90, v90
  v_exp_f32 v91, v91
  v_smfmac_f32_32x32x32_bf16 v[112:127], v[192:195], v[80:87], v208
  ds_read_b128 v[204:207], v215 offset:3584
  s_add_u32 m0, s73, 131072
  v_exp_f32 v92, v92
  v_exp_f32 v93, v93
  v_exp_f32 v94, v94
  v_exp_f32 v95, v95
  v_exp_f32 v96, v96
  v_exp_f32 v97, v97
  v_smfmac_f32_32x32x32_bf16 v[112:127], v[196:199], v[88:95], v208
  buffer_load_dwordx4 v1, s[36:39], s70 offen offset:0 sc1 lds
  v_exp_f32 v98, v98
  v_exp_f32 v99, v99
  v_exp_f32 v100, v100
  v_exp_f32 v101, v101
  v_exp_f32 v102, v102
  v_mfma_f32_32x32x16_bf16 v[80:95], v[188:191], v[180:183], v[160:175]
  s_waitcnt lgkmcnt(0)
  v_exp_f32 v103, v103
  v_exp_f32 v104, v104
  v_exp_f32 v105, v105
  v_exp_f32 v106, v106
  v_exp_f32 v107, v107
  v_smfmac_f32_32x32x32_bf16 v[128:143], v[192:195], v[96:103], v208
  v_exp_f32 v108, v108
  v_exp_f32 v109, v109
  v_exp_f32 v110, v110
  v_exp_f32 v111, v111
  v_exp_f32 v64, v64
  v_exp_f32 v65, v65
  v_smfmac_f32_32x32x32_bf16 v[128:143], v[196:199], v[104:111], v208
  ds_read_b128 v[188:191], v214 offset:5120
  v_exp_f32 v66, v66
  v_exp_f32 v67, v67
  v_exp_f32 v68, v68
  v_exp_f32 v69, v69
  v_exp_f32 v70, v70
  v_mfma_f32_32x32x16_bf16 v[96:111], v[184:187], v[176:179], v[144:159]
  ds_read_b128 v[192:195], v215 offset:6144
  v_exp_f32 v71, v71
  v_exp_f32 v72, v72
  v_exp_f32 v73, v73
  v_exp_f32 v74, v74
  v_exp_f32 v75, v75
  v_smfmac_f32_32x32x32_bf16 v[112:127], v[200:203], v[64:71], v208
  ds_read_b128 v[196:199], v215 offset:6656
  v_exp_f32 v76, v76
  v_exp_f32 v77, v77
  v_exp_f32 v78, v78
  v_exp_f32 v79, v79
  v_exp_f32 v80, v80
  v_exp_f32 v81, v81
  v_smfmac_f32_32x32x32_bf16 v[112:127], v[204:207], v[72:79], v208
  buffer_load_dwordx4 a[100:103], v210, s[20:23], s79 offen offset:0
  v_exp_f32 v82, v82
  v_exp_f32 v83, v83
  v_exp_f32 v84, v84
  v_exp_f32 v85, v85
  v_exp_f32 v86, v86
  v_mfma_f32_32x32x16_bf16 v[64:79], v[184:187], v[180:183], v[160:175]
  s_waitcnt lgkmcnt(0)
  v_exp_f32 v87, v87
  v_exp_f32 v88, v88
  v_exp_f32 v89, v89
  v_exp_f32 v90, v90
  v_exp_f32 v91, v91
  v_smfmac_f32_32x32x32_bf16 v[128:143], v[200:203], v[80:87], v208
  buffer_load_dwordx4 a[104:107], v211, s[20:23], s79 offen offset:0
  v_exp_f32 v92, v92
  v_exp_f32 v93, v93
  v_exp_f32 v94, v94
  v_exp_f32 v95, v95
  v_exp_f32 v96, v96
  v_exp_f32 v97, v97
  v_smfmac_f32_32x32x32_bf16 v[128:143], v[204:207], v[88:95], v208
  ds_read_b128 v[184:187], v214 offset:8192
  v_exp_f32 v98, v98
  v_exp_f32 v99, v99
  v_exp_f32 v100, v100
  v_exp_f32 v101, v101
  v_exp_f32 v102, v102
  v_mfma_f32_32x32x16_bf16 v[80:95], v[188:191], v[176:179], v[144:159]
  ds_read_b128 v[200:203], v215 offset:7168
  v_exp_f32 v103, v103
  v_exp_f32 v104, v104
  v_exp_f32 v105, v105
  v_exp_f32 v106, v106
  v_exp_f32 v107, v107
  v_smfmac_f32_32x32x32_bf16 v[112:127], v[192:195], v[96:103], v208
  ds_read_b128 v[204:207], v215 offset:7680
  v_exp_f32 v108, v108
  v_exp_f32 v109, v109
  v_exp_f32 v110, v110
  v_exp_f32 v111, v111
  v_exp_f32 v64, v64
  v_exp_f32 v65, v65
  v_smfmac_f32_32x32x32_bf16 v[112:127], v[196:199], v[104:111], v208
  buffer_load_dwordx4 v1, s[36:39], s70 offen offset:1024 sc1 lds
  v_exp_f32 v66, v66
  v_exp_f32 v67, v67
  v_exp_f32 v68, v68
  v_exp_f32 v69, v69
  v_exp_f32 v70, v70
  v_mfma_f32_32x32x16_bf16 v[96:111], v[188:191], v[180:183], v[160:175]
  s_waitcnt lgkmcnt(0)
  v_exp_f32 v71, v71
  v_exp_f32 v72, v72
  v_exp_f32 v73, v73
  v_exp_f32 v74, v74
  v_exp_f32 v75, v75
  v_smfmac_f32_32x32x32_bf16 v[128:143], v[192:195], v[64:71], v208
  buffer_load_dwordx4 a[108:111], v212, s[20:23], s79 offen offset:0
  v_exp_f32 v76, v76
  v_exp_f32 v77, v77
  v_exp_f32 v78, v78
  v_exp_f32 v79, v79
  v_exp_f32 v80, v80
  v_exp_f32 v81, v81
  v_smfmac_f32_32x32x32_bf16 v[128:143], v[196:199], v[72:79], v208
  ds_read_b128 v[188:191], v214 offset:9216
  v_exp_f32 v82, v82
  v_exp_f32 v83, v83
  v_exp_f32 v84, v84
  v_exp_f32 v85, v85
  v_exp_f32 v86, v86
  v_mfma_f32_32x32x16_bf16 v[64:79], v[184:187], v[176:179], v[144:159]
  ds_read_b128 v[192:195], v215 offset:10240
  v_exp_f32 v87, v87
  v_exp_f32 v88, v88
  v_exp_f32 v89, v89
  v_exp_f32 v90, v90
  v_exp_f32 v91, v91
  v_smfmac_f32_32x32x32_bf16 v[112:127], v[200:203], v[80:87], v208
  ds_read_b128 v[196:199], v215 offset:10752
  v_exp_f32 v92, v92
  v_exp_f32 v93, v93
  v_exp_f32 v94, v94
  v_exp_f32 v95, v95
  v_exp_f32 v96, v96
  v_exp_f32 v97, v97
  v_smfmac_f32_32x32x32_bf16 v[112:127], v[204:207], v[88:95], v208
  v_exp_f32 v98, v98
  v_exp_f32 v99, v99
  v_exp_f32 v100, v100
  v_exp_f32 v101, v101
  v_exp_f32 v102, v102
  v_mfma_f32_32x32x16_bf16 v[80:95], v[184:187], v[180:183], v[160:175]
  s_waitcnt lgkmcnt(0)
  v_exp_f32 v103, v103
  v_exp_f32 v104, v104
  v_exp_f32 v105, v105
  v_exp_f32 v106, v106
  v_exp_f32 v107, v107
  v_smfmac_f32_32x32x32_bf16 v[128:143], v[200:203], v[96:103], v208
  buffer_load_dwordx4 a[112:115], v209, s[20:23], s79 offen offset:64
  v_exp_f32 v108, v108
  v_exp_f32 v109, v109
  v_exp_f32 v110, v110
  v_exp_f32 v111, v111
  v_exp_f32 v64, v64
  v_exp_f32 v65, v65
  v_smfmac_f32_32x32x32_bf16 v[128:143], v[204:207], v[104:111], v208
  ds_read_b128 v[184:187], v214 offset:12288
  v_exp_f32 v66, v66
  v_exp_f32 v67, v67
  v_exp_f32 v68, v68
  v_exp_f32 v69, v69
  v_exp_f32 v70, v70
  v_mfma_f32_32x32x16_bf16 v[96:111], v[188:191], v[176:179], v[144:159]
  ds_read_b128 v[200:203], v215 offset:11264
  v_exp_f32 v71, v71
  v_exp_f32 v72, v72
  v_exp_f32 v73, v73
  v_exp_f32 v74, v74
  v_exp_f32 v75, v75
  v_smfmac_f32_32x32x32_bf16 v[112:127], v[192:195], v[64:71], v208
  ds_read_b128 v[204:207], v215 offset:11776
  v_exp_f32 v76, v76
  v_exp_f32 v77, v77
  v_exp_f32 v78, v78
  v_exp_f32 v79, v79
  v_exp_f32 v80, v80
  v_exp_f32 v81, v81
  v_smfmac_f32_32x32x32_bf16 v[112:127], v[196:199], v[72:79], v208
  buffer_load_dwordx4 v1, s[36:39], s70 offen offset:2048 sc1 lds
  v_exp_f32 v82, v82
  v_exp_f32 v83, v83
  v_exp_f32 v84, v84
  v_exp_f32 v85, v85
  v_exp_f32 v86, v86
  v_mfma_f32_32x32x16_bf16 v[64:79], v[188:191], v[180:183], v[160:175]
  s_waitcnt lgkmcnt(0)
  v_exp_f32 v87, v87
  v_exp_f32 v88, v88
  v_exp_f32 v89, v89
  v_exp_f32 v90, v90
  v_exp_f32 v91, v91
  v_smfmac_f32_32x32x32_bf16 v[128:143], v[192:195], v[80:87], v208
  buffer_load_dwordx4 a[116:119], v210, s[20:23], s79 offen offset:64
  v_exp_f32 v92, v92
  v_exp_f32 v93, v93
  v_exp_f32 v94, v94
  v_exp_f32 v95, v95
  v_exp_f32 v96, v96
  v_exp_f32 v97, v97
  v_smfmac_f32_32x32x32_bf16 v[128:143], v[196:199], v[88:95], v208
  ds_read_b128 v[188:191], v214 offset:13312
  v_exp_f32 v98, v98
  v_exp_f32 v99, v99
  v_exp_f32 v100, v100
  v_exp_f32 v101, v101
  v_exp_f32 v102, v102
  v_mfma_f32_32x32x16_bf16 v[80:95], v[184:187], v[176:179], v[144:159]
  ds_read_b128 v[192:195], v215 offset:14336
  v_exp_f32 v103, v103
  v_exp_f32 v104, v104
  v_exp_f32 v105, v105
  v_exp_f32 v106, v106
  v_exp_f32 v107, v107
  v_smfmac_f32_32x32x32_bf16 v[112:127], v[200:203], v[96:103], v208
  ds_read_b128 v[196:199], v215 offset:14848
  v_exp_f32 v108, v108
  v_exp_f32 v109, v109
  v_exp_f32 v110, v110
  v_exp_f32 v111, v111
  v_exp_f32 v64, v64
  v_exp_f32 v65, v65
  v_smfmac_f32_32x32x32_bf16 v[112:127], v[204:207], v[104:111], v208
  v_exp_f32 v66, v66
  v_exp_f32 v67, v67
  v_exp_f32 v68, v68
  v_exp_f32 v69, v69
  v_exp_f32 v70, v70
  v_mfma_f32_32x32x16_bf16 v[96:111], v[184:187], v[180:183], v[160:175]
  s_waitcnt vmcnt(10) lgkmcnt(0)
  s_barrier
  v_exp_f32 v71, v71
  v_exp_f32 v72, v72
  v_exp_f32 v73, v73
  v_exp_f32 v74, v74
  v_exp_f32 v75, v75
  v_smfmac_f32_32x32x32_bf16 v[128:143], v[200:203], v[64:71], v208
  buffer_load_dwordx4 a[120:123], v211, s[20:23], s79 offen offset:64
  v_exp_f32 v76, v76
  v_exp_f32 v77, v77
  v_exp_f32 v78, v78
  v_exp_f32 v79, v79
  v_exp_f32 v80, v80
  v_exp_f32 v81, v81
  v_smfmac_f32_32x32x32_bf16 v[128:143], v[204:207], v[72:79], v208
  ds_read_b128 v[184:187], v214 offset:16384
  v_exp_f32 v82, v82
  v_exp_f32 v83, v83
  v_exp_f32 v84, v84
  v_exp_f32 v85, v85
  v_exp_f32 v86, v86
  v_mfma_f32_32x32x16_bf16 v[64:79], v[188:191], v[176:179], v[144:159]
  ds_read_b128 v[200:203], v215 offset:15360
  v_exp_f32 v87, v87
  v_exp_f32 v88, v88
  v_exp_f32 v89, v89
  v_exp_f32 v90, v90
  v_exp_f32 v91, v91
  v_smfmac_f32_32x32x32_bf16 v[112:127], v[192:195], v[80:87], v208
  ds_read_b128 v[204:207], v215 offset:15872
  v_exp_f32 v92, v92
  v_exp_f32 v93, v93
  v_exp_f32 v94, v94
  v_exp_f32 v95, v95
  v_exp_f32 v96, v96
  v_exp_f32 v97, v97
  v_smfmac_f32_32x32x32_bf16 v[112:127], v[196:199], v[88:95], v208
  buffer_load_dwordx4 v1, s[36:39], s70 offen offset:3072 sc1 lds
  v_exp_f32 v98, v98
  v_exp_f32 v99, v99
  v_exp_f32 v100, v100
  v_exp_f32 v101, v101
  v_exp_f32 v102, v102
  v_mfma_f32_32x32x16_bf16 v[80:95], v[188:191], v[180:183], v[160:175]
  s_waitcnt lgkmcnt(0)
  v_exp_f32 v103, v103
  v_exp_f32 v104, v104
  v_exp_f32 v105, v105
  v_exp_f32 v106, v106
  v_exp_f32 v107, v107
  v_smfmac_f32_32x32x32_bf16 v[128:143], v[192:195], v[96:103], v208
  buffer_load_dwordx4 a[124:127], v212, s[20:23], s79 offen offset:64
  v_exp_f32 v108, v108
  v_exp_f32 v109, v109
  v_exp_f32 v110, v110
  v_exp_f32 v111, v111
  v_exp_f32 v64, v64
  v_exp_f32 v65, v65
  v_smfmac_f32_32x32x32_bf16 v[128:143], v[196:199], v[104:111], v208
  ds_read_b128 v[188:191], v214 offset:17408
  v_add_u32 v215, v215, v216
  v_exp_f32 v66, v66
  v_exp_f32 v67, v67
  v_exp_f32 v68, v68
  v_exp_f32 v69, v69
  v_exp_f32 v70, v70
  v_mfma_f32_32x32x16_bf16 v[96:111], v[184:187], v[176:179], v[144:159]
  ds_read_b128 v[192:195], v215 offset:2048
  v_exp_f32 v71, v71
  v_exp_f32 v72, v72
  v_exp_f32 v73, v73
  v_exp_f32 v74, v74
  v_exp_f32 v75, v75
  v_smfmac_f32_32x32x32_bf16 v[112:127], v[200:203], v[64:71], v208
  ds_read_b128 v[196:199], v215 offset:2560
  v_exp_f32 v76, v76
  v_exp_f32 v77, v77
  v_exp_f32 v78, v78
  v_exp_f32 v79, v79
  v_exp_f32 v80, v80
  v_exp_f32 v81, v81
  v_smfmac_f32_32x32x32_bf16 v[112:127], v[204:207], v[72:79], v208
  v_exp_f32 v82, v82
  v_exp_f32 v83, v83
  v_exp_f32 v84, v84
  v_exp_f32 v85, v85
  v_exp_f32 v86, v86
  v_mfma_f32_32x32x16_bf16 v[64:79], v[184:187], v[180:183], v[160:175]
  s_waitcnt lgkmcnt(0)
  v_exp_f32 v87, v87
  v_exp_f32 v88, v88
  v_exp_f32 v89, v89
  v_exp_f32 v90, v90
  v_exp_f32 v91, v91
  v_smfmac_f32_32x32x32_bf16 v[128:143], v[200:203], v[80:87], v208
  buffer_load_dwordx4 a[128:131], v209, s[20:23], s80 offen offset:0
  v_exp_f32 v92, v92
  v_exp_f32 v93, v93
  v_exp_f32 v94, v94
  v_exp_f32 v95, v95
  v_exp_f32 v96, v96
  v_exp_f32 v97, v97
  v_smfmac_f32_32x32x32_bf16 v[128:143], v[204:207], v[88:95], v208
  ds_read_b128 v[184:187], v214 offset:20480
  v_exp_f32 v98, v98
  v_exp_f32 v99, v99
  v_exp_f32 v100, v100
  v_exp_f32 v101, v101
  v_exp_f32 v102, v102
  v_mfma_f32_32x32x16_bf16 v[80:95], v[188:191], v[176:179], v[144:159]
  ds_read_b128 v[200:203], v215 offset:3072
  v_exp_f32 v103, v103
  v_exp_f32 v104, v104
  v_exp_f32 v105, v105
  v_exp_f32 v106, v106
  v_exp_f32 v107, v107
  v_smfmac_f32_32x32x32_bf16 v[112:127], v[192:195], v[96:103], v208
  ds_read_b128 v[204:207], v215 offset:3584
  s_add_u32 m0, s73, 147456
  v_exp_f32 v108, v108
  v_exp_f32 v109, v109
  v_exp_f32 v110, v110
  v_exp_f32 v111, v111
  v_exp_f32 v64, v64
  v_exp_f32 v65, v65
  v_smfmac_f32_32x32x32_bf16 v[112:127], v[196:199], v[104:111], v208
  buffer_load_dwordx4 v1, s[36:39], s71 offen offset:0 sc1 lds
  v_exp_f32 v66, v66
  v_exp_f32 v67, v67
  v_exp_f32 v68, v68
  v_exp_f32 v69, v69
  v_exp_f32 v70, v70
  v_mfma_f32_32x32x16_bf16 v[96:111], v[188:191], v[180:183], v[160:175]
  s_waitcnt lgkmcnt(0)
  v_exp_f32 v71, v71
  v_exp_f32 v72, v72
  v_exp_f32 v73, v73
  v_exp_f32 v74, v74
  v_exp_f32 v75, v75
  v_smfmac_f32_32x32x32_bf16 v[128:143], v[192:195], v[64:71], v208
  buffer_load_dwordx4 a[132:135], v210, s[20:23], s80 offen offset:0
  v_exp_f32 v76, v76
  v_exp_f32 v77, v77
  v_exp_f32 v78, v78
  v_exp_f32 v79, v79
  v_exp_f32 v80, v80
  v_exp_f32 v81, v81
  v_smfmac_f32_32x32x32_bf16 v[128:143], v[196:199], v[72:79], v208
  ds_read_b128 v[188:191], v214 offset:21504
  v_exp_f32 v82, v82
  v_exp_f32 v83, v83
  v_exp_f32 v84, v84
  v_exp_f32 v85, v85
  v_exp_f32 v86, v86
  v_mfma_f32_32x32x16_bf16 v[64:79], v[184:187], v[176:179], v[144:159]
  ds_read_b128 v[192:195], v215 offset:6144
  v_exp_f32 v87, v87
  v_exp_f32 v88, v88
  v_exp_f32 v89, v89
  v_exp_f32 v90, v90
  v_exp_f32 v91, v91
  v_smfmac_f32_32x32x32_bf16 v[112:127], v[200:203], v[80:87], v208
  ds_read_b128 v[196:199], v215 offset:6656
  v_exp_f32 v92, v92
  v_exp_f32 v93, v93
  v_exp_f32 v94, v94
  v_exp_f32 v95, v95
  v_exp_f32 v96, v96
  v_exp_f32 v97, v97
  v_smfmac_f32_32x32x32_bf16 v[112:127], v[204:207], v[88:95], v208
  buffer_load_dwordx4 a[136:139], v211, s[20:23], s80 offen offset:0
  v_exp_f32 v98, v98
  v_exp_f32 v99, v99
  v_exp_f32 v100, v100
  v_exp_f32 v101, v101
  v_exp_f32 v102, v102
  v_mfma_f32_32x32x16_bf16 v[80:95], v[184:187], v[180:183], v[160:175]
  s_waitcnt lgkmcnt(0)
  v_exp_f32 v103, v103
  v_exp_f32 v104, v104
  v_exp_f32 v105, v105
  v_exp_f32 v106, v106
  v_exp_f32 v107, v107
  v_smfmac_f32_32x32x32_bf16 v[128:143], v[200:203], v[96:103], v208
  v_exp_f32 v108, v108
  v_exp_f32 v109, v109
  v_exp_f32 v110, v110
  v_exp_f32 v111, v111
  v_exp_f32 v64, v64
  v_exp_f32 v65, v65
  v_smfmac_f32_32x32x32_bf16 v[128:143], v[204:207], v[104:111], v208
  ds_read_b128 v[184:187], v214 offset:24576
  v_exp_f32 v66, v66
  v_exp_f32 v67, v67
  v_exp_f32 v68, v68
  v_exp_f32 v69, v69
  v_exp_f32 v70, v70
  v_mfma_f32_32x32x16_bf16 v[96:111], v[188:191], v[176:179], v[144:159]
  ds_read_b128 v[200:203], v215 offset:7168
  v_exp_f32 v71, v71
  v_exp_f32 v72, v72
  v_exp_f32 v73, v73
  v_exp_f32 v74, v74
  v_exp_f32 v75, v75
  v_smfmac_f32_32x32x32_bf16 v[112:127], v[192:195], v[64:71], v208
  ds_read_b128 v[204:207], v215 offset:7680
  v_exp_f32 v76, v76
  v_exp_f32 v77, v77
  v_exp_f32 v78, v78
  v_exp_f32 v79, v79
  v_exp_f32 v80, v80
  v_exp_f32 v81, v81
  v_smfmac_f32_32x32x32_bf16 v[112:127], v[196:199], v[72:79], v208
  buffer_load_dwordx4 v1, s[36:39], s71 offen offset:1024 sc1 lds
  v_exp_f32 v82, v82
  v_exp_f32 v83, v83
  v_exp_f32 v84, v84
  v_exp_f32 v85, v85
  v_exp_f32 v86, v86
  v_mfma_f32_32x32x16_bf16 v[64:79], v[188:191], v[180:183], v[160:175]
  s_waitcnt lgkmcnt(0)
  v_exp_f32 v87, v87
  v_exp_f32 v88, v88
  v_exp_f32 v89, v89
  v_exp_f32 v90, v90
  v_exp_f32 v91, v91
  v_smfmac_f32_32x32x32_bf16 v[128:143], v[192:195], v[80:87], v208
  buffer_load_dwordx4 a[140:143], v212, s[20:23], s80 offen offset:0
  v_exp_f32 v92, v92
  v_exp_f32 v93, v93
  v_exp_f32 v94, v94
  v_exp_f32 v95, v95
  v_exp_f32 v96, v96
  v_exp_f32 v97, v97
  v_smfmac_f32_32x32x32_bf16 v[128:143], v[196:199], v[88:95], v208
  ds_read_b128 v[188:191], v214 offset:25600
  v_exp_f32 v98, v98
  v_exp_f32 v99, v99
  v_exp_f32 v100, v100
  v_exp_f32 v101, v101
  v_exp_f32 v102, v102
  v_mfma_f32_32x32x16_bf16 v[80:95], v[184:187], v[176:179], v[144:159]
  ds_read_b128 v[192:195], v215 offset:10240
  v_exp_f32 v103, v103
  v_exp_f32 v104, v104
  v_exp_f32 v105, v105
  v_exp_f32 v106, v106
  v_exp_f32 v107, v107
  v_smfmac_f32_32x32x32_bf16 v[112:127], v[200:203], v[96:103], v208
  ds_read_b128 v[196:199], v215 offset:10752
  v_exp_f32 v108, v108
  v_exp_f32 v109, v109
  v_exp_f32 v110, v110
  v_exp_f32 v111, v111
  v_exp_f32 v64, v64
  v_exp_f32 v65, v65
  v_smfmac_f32_32x32x32_bf16 v[112:127], v[204:207], v[104:111], v208
  buffer_load_dwordx4 a[144:147], v209, s[20:23], s80 offen offset:64
  v_exp_f32 v66, v66
  v_exp_f32 v67, v67
  v_exp_f32 v68, v68
  v_exp_f32 v69, v69
  v_exp_f32 v70, v70
  v_mfma_f32_32x32x16_bf16 v[96:111], v[184:187], v[180:183], v[160:175]
  s_waitcnt lgkmcnt(0)
  v_exp_f32 v71, v71
  v_exp_f32 v72, v72
  v_exp_f32 v73, v73
  v_exp_f32 v74, v74
  v_exp_f32 v75, v75
  v_smfmac_f32_32x32x32_bf16 v[128:143], v[200:203], v[64:71], v208
  v_exp_f32 v76, v76
  v_exp_f32 v77, v77
  v_exp_f32 v78, v78
  v_exp_f32 v79, v79
  v_exp_f32 v80, v80
  v_exp_f32 v81, v81
  v_smfmac_f32_32x32x32_bf16 v[128:143], v[204:207], v[72:79], v208
  ds_read_b128 v[184:187], v214 offset:28672
  v_exp_f32 v82, v82
  v_exp_f32 v83, v83
  v_exp_f32 v84, v84
  v_exp_f32 v85, v85
  v_exp_f32 v86, v86
  v_mfma_f32_32x32x16_bf16 v[64:79], v[188:191], v[176:179], v[144:159]
  ds_read_b128 v[200:203], v215 offset:11264
  v_exp_f32 v87, v87
  v_exp_f32 v88, v88
  v_exp_f32 v89, v89
  v_exp_f32 v90, v90
  v_exp_f32 v91, v91
  v_smfmac_f32_32x32x32_bf16 v[112:127], v[192:195], v[80:87], v208
  ds_read_b128 v[204:207], v215 offset:11776
  v_exp_f32 v92, v92
  v_exp_f32 v93, v93
  v_exp_f32 v94, v94
  v_exp_f32 v95, v95
  v_exp_f32 v96, v96
  v_exp_f32 v97, v97
  v_smfmac_f32_32x32x32_bf16 v[112:127], v[196:199], v[88:95], v208
  buffer_load_dwordx4 v1, s[36:39], s71 offen offset:2048 sc1 lds
  v_exp_f32 v98, v98
  v_exp_f32 v99, v99
  v_exp_f32 v100, v100
  v_exp_f32 v101, v101
  v_exp_f32 v102, v102
  v_mfma_f32_32x32x16_bf16 v[80:95], v[188:191], v[180:183], v[160:175]
  s_waitcnt lgkmcnt(0)
  v_exp_f32 v103, v103
  v_exp_f32 v104, v104
  v_exp_f32 v105, v105
  v_exp_f32 v106, v106
  v_exp_f32 v107, v107
  v_smfmac_f32_32x32x32_bf16 v[128:143], v[192:195], v[96:103], v208
  buffer_load_dwordx4 a[148:151], v210, s[20:23], s80 offen offset:64
  v_exp_f32 v108, v108
  v_exp_f32 v109, v109
  v_exp_f32 v110, v110
  v_exp_f32 v111, v111
  v_exp_f32 v64, v64
  v_exp_f32 v65, v65
  v_smfmac_f32_32x32x32_bf16 v[128:143], v[196:199], v[104:111], v208
  ds_read_b128 v[188:191], v214 offset:29696
  v_exp_f32 v66, v66
  v_exp_f32 v67, v67
  v_exp_f32 v68, v68
  v_exp_f32 v69, v69
  v_exp_f32 v70, v70
  v_mfma_f32_32x32x16_bf16 v[96:111], v[184:187], v[176:179], v[144:159]
  ds_read_b128 v[192:195], v215 offset:14336
  v_exp_f32 v71, v71
  v_exp_f32 v72, v72
  v_exp_f32 v73, v73
  v_exp_f32 v74, v74
  v_exp_f32 v75, v75
  v_smfmac_f32_32x32x32_bf16 v[112:127], v[200:203], v[64:71], v208
  ds_read_b128 v[196:199], v215 offset:14848
  v_exp_f32 v76, v76
  v_exp_f32 v77, v77
  v_exp_f32 v78, v78
  v_exp_f32 v79, v79
  v_exp_f32 v80, v80
  v_exp_f32 v81, v81
  v_smfmac_f32_32x32x32_bf16 v[112:127], v[204:207], v[72:79], v208
  buffer_load_dwordx4 a[152:155], v211, s[20:23], s80 offen offset:64
  v_exp_f32 v82, v82
  v_exp_f32 v83, v83
  v_exp_f32 v84, v84
  v_exp_f32 v85, v85
  v_exp_f32 v86, v86
  v_mfma_f32_32x32x16_bf16 v[64:79], v[184:187], v[180:183], v[160:175]
  s_waitcnt vmcnt(11) lgkmcnt(0)
  s_barrier
  v_exp_f32 v87, v87
  v_exp_f32 v88, v88
  v_exp_f32 v89, v89
  v_exp_f32 v90, v90
  v_exp_f32 v91, v91
  v_smfmac_f32_32x32x32_bf16 v[128:143], v[200:203], v[80:87], v208
  buffer_load_dwordx4 a[156:159], v212, s[20:23], s80 offen offset:64
  v_exp_f32 v92, v92
  v_exp_f32 v93, v93
  v_exp_f32 v94, v94
  v_exp_f32 v95, v95
  v_exp_f32 v96, v96
  v_exp_f32 v97, v97
  v_smfmac_f32_32x32x32_bf16 v[128:143], v[204:207], v[88:95], v208
  ds_read_b128 v[184:187], v214 offset:32768
  v_exp_f32 v98, v98
  v_exp_f32 v99, v99
  v_exp_f32 v100, v100
  v_exp_f32 v101, v101
  v_exp_f32 v102, v102
  v_mfma_f32_32x32x16_bf16 v[80:95], v[188:191], v[176:179], v[144:159]
  ds_read_b128 v[200:203], v215 offset:15360
  v_exp_f32 v103, v103
  v_exp_f32 v104, v104
  v_exp_f32 v105, v105
  v_exp_f32 v106, v106
  v_exp_f32 v107, v107
  v_smfmac_f32_32x32x32_bf16 v[112:127], v[192:195], v[96:103], v208
  ds_read_b128 v[204:207], v215 offset:15872
  v_exp_f32 v108, v108
  v_exp_f32 v109, v109
  v_exp_f32 v110, v110
  v_exp_f32 v111, v111
  v_exp_f32 v64, v64
  v_exp_f32 v65, v65
  v_smfmac_f32_32x32x32_bf16 v[112:127], v[196:199], v[104:111], v208
  buffer_load_dwordx4 v1, s[36:39], s71 offen offset:3072 sc1 lds
  v_exp_f32 v66, v66
  v_exp_f32 v67, v67
  v_exp_f32 v68, v68
  v_exp_f32 v69, v69
  v_exp_f32 v70, v70
  v_mfma_f32_32x32x16_bf16 v[96:111], v[188:191], v[180:183], v[160:175]
  s_waitcnt lgkmcnt(0)
  v_exp_f32 v71, v71
  v_exp_f32 v72, v72
  v_exp_f32 v73, v73
  v_exp_f32 v74, v74
  v_exp_f32 v75, v75
  v_smfmac_f32_32x32x32_bf16 v[128:143], v[192:195], v[64:71], v208
  v_exp_f32 v76, v76
  v_exp_f32 v77, v77
  v_exp_f32 v78, v78
  v_exp_f32 v79, v79
  v_exp_f32 v80, v80
  v_exp_f32 v81, v81
  v_smfmac_f32_32x32x32_bf16 v[128:143], v[196:199], v[72:79], v208
  ds_read_b128 v[188:191], v214 offset:33792
  v_add_u32 v215, v215, v216
  v_exp_f32 v82, v82
  v_exp_f32 v83, v83
  v_exp_f32 v84, v84
  v_exp_f32 v85, v85
  v_exp_f32 v86, v86
  v_mfma_f32_32x32x16_bf16 v[64:79], v[184:187], v[176:179], v[144:159]
  ds_read_b128 v[192:195], v215 offset:2048
  v_exp_f32 v87, v87
  v_exp_f32 v88, v88
  v_exp_f32 v89, v89
  v_exp_f32 v90, v90
  v_exp_f32 v91, v91
  v_smfmac_f32_32x32x32_bf16 v[112:127], v[200:203], v[80:87], v208
  ds_read_b128 v[196:199], v215 offset:2560
  v_exp_f32 v92, v92
  v_exp_f32 v93, v93
  v_exp_f32 v94, v94
  v_exp_f32 v95, v95
  v_exp_f32 v96, v96
  v_exp_f32 v97, v97
  v_smfmac_f32_32x32x32_bf16 v[112:127], v[204:207], v[88:95], v208
  buffer_load_dwordx4 a[160:163], v209, s[20:23], s81 offen offset:0
  v_exp_f32 v98, v98
  v_exp_f32 v99, v99
  v_exp_f32 v100, v100
  v_exp_f32 v101, v101
  v_exp_f32 v102, v102
  v_mfma_f32_32x32x16_bf16 v[80:95], v[184:187], v[180:183], v[160:175]
  s_waitcnt lgkmcnt(0)
  v_exp_f32 v103, v103
  v_exp_f32 v104, v104
  v_exp_f32 v105, v105
  v_exp_f32 v106, v106
  v_exp_f32 v107, v107
  v_smfmac_f32_32x32x32_bf16 v[128:143], v[200:203], v[96:103], v208
  buffer_load_dwordx4 a[164:167], v210, s[20:23], s81 offen offset:0
  v_exp_f32 v108, v108
  v_exp_f32 v109, v109
  v_exp_f32 v110, v110
  v_exp_f32 v111, v111
  v_exp_f32 v64, v64
  v_exp_f32 v65, v65
  v_smfmac_f32_32x32x32_bf16 v[128:143], v[204:207], v[104:111], v208
  ds_read_b128 v[184:187], v214 offset:36864
  v_exp_f32 v66, v66
  v_exp_f32 v67, v67
  v_exp_f32 v68, v68
  v_exp_f32 v69, v69
  v_exp_f32 v70, v70
  v_mfma_f32_32x32x16_bf16 v[96:111], v[188:191], v[176:179], v[144:159]
  ds_read_b128 v[200:203], v215 offset:3072
  v_exp_f32 v71, v71
  v_exp_f32 v72, v72
  v_exp_f32 v73, v73
  v_exp_f32 v74, v74
  v_exp_f32 v75, v75
  v_smfmac_f32_32x32x32_bf16 v[112:127], v[192:195], v[64:71], v208
  ds_read_b128 v[204:207], v215 offset:3584
  v_exp_f32 v76, v76
  v_exp_f32 v77, v77
  v_exp_f32 v78, v78
  v_exp_f32 v79, v79
  v_exp_f32 v80, v80
  v_exp_f32 v81, v81
  v_smfmac_f32_32x32x32_bf16 v[112:127], v[196:199], v[72:79], v208
  v_exp_f32 v82, v82
  v_exp_f32 v83, v83
  v_exp_f32 v84, v84
  v_exp_f32 v85, v85
  v_exp_f32 v86, v86
  v_mfma_f32_32x32x16_bf16 v[64:79], v[188:191], v[180:183], v[160:175]
  s_waitcnt lgkmcnt(0)
  v_exp_f32 v87, v87
  v_exp_f32 v88, v88
  v_exp_f32 v89, v89
  v_exp_f32 v90, v90
  v_exp_f32 v91, v91
  v_smfmac_f32_32x32x32_bf16 v[128:143], v[192:195], v[80:87], v208
  buffer_load_dwordx4 a[168:171], v211, s[20:23], s81 offen offset:0
  v_exp_f32 v92, v92
  v_exp_f32 v93, v93
  v_exp_f32 v94, v94
  v_exp_f32 v95, v95
  v_exp_f32 v96, v96
  v_exp_f32 v97, v97
  v_smfmac_f32_32x32x32_bf16 v[128:143], v[196:199], v[88:95], v208
  ds_read_b128 v[188:191], v214 offset:37888
  v_exp_f32 v98, v98
  v_exp_f32 v99, v99
  v_exp_f32 v100, v100
  v_exp_f32 v101, v101
  v_exp_f32 v102, v102
  v_mfma_f32_32x32x16_bf16 v[80:95], v[184:187], v[176:179], v[144:159]
  ds_read_b128 v[192:195], v215 offset:6144
  v_exp_f32 v103, v103
  v_exp_f32 v104, v104
  v_exp_f32 v105, v105
  v_exp_f32 v106, v106
  v_exp_f32 v107, v107
  v_smfmac_f32_32x32x32_bf16 v[112:127], v[200:203], v[96:103], v208
  ds_read_b128 v[196:199], v215 offset:6656
  v_exp_f32 v108, v108
  v_exp_f32 v109, v109
  v_exp_f32 v110, v110
  v_exp_f32 v111, v111
  v_exp_f32 v64, v64
  v_exp_f32 v65, v65
  v_smfmac_f32_32x32x32_bf16 v[112:127], v[204:207], v[104:111], v208
  buffer_load_dwordx4 a[172:175], v212, s[20:23], s81 offen offset:0
  v_exp_f32 v66, v66
  v_exp_f32 v67, v67
  v_exp_f32 v68, v68
  v_exp_f32 v69, v69
  v_exp_f32 v70, v70
  v_mfma_f32_32x32x16_bf16 v[96:111], v[184:187], v[180:183], v[160:175]
  s_waitcnt lgkmcnt(0)
  v_exp_f32 v71, v71
  v_exp_f32 v72, v72
  v_exp_f32 v73, v73
  v_exp_f32 v74, v74
  v_exp_f32 v75, v75
  v_smfmac_f32_32x32x32_bf16 v[128:143], v[200:203], v[64:71], v208
  buffer_load_dwordx4 a[176:179], v209, s[20:23], s81 offen offset:64
  v_exp_f32 v76, v76
  v_exp_f32 v77, v77
  v_exp_f32 v78, v78
  v_exp_f32 v79, v79
  v_exp_f32 v80, v80
  v_exp_f32 v81, v81
  v_smfmac_f32_32x32x32_bf16 v[128:143], v[204:207], v[72:79], v208
  ds_read_b128 v[184:187], v214 offset:40960
  v_exp_f32 v82, v82
  v_exp_f32 v83, v83
  v_exp_f32 v84, v84
  v_exp_f32 v85, v85
  v_exp_f32 v86, v86
  v_mfma_f32_32x32x16_bf16 v[64:79], v[188:191], v[176:179], v[144:159]
  ds_read_b128 v[200:203], v215 offset:7168
  v_exp_f32 v87, v87
  v_exp_f32 v88, v88
  v_exp_f32 v89, v89
  v_exp_f32 v90, v90
  v_exp_f32 v91, v91
  v_smfmac_f32_32x32x32_bf16 v[112:127], v[192:195], v[80:87], v208
  ds_read_b128 v[204:207], v215 offset:7680
  v_exp_f32 v92, v92
  v_exp_f32 v93, v93
  v_exp_f32 v94, v94
  v_exp_f32 v95, v95
  v_exp_f32 v96, v96
  v_exp_f32 v97, v97
  v_smfmac_f32_32x32x32_bf16 v[112:127], v[196:199], v[88:95], v208
  v_exp_f32 v98, v98
  v_exp_f32 v99, v99
  v_exp_f32 v100, v100
  v_exp_f32 v101, v101
  v_exp_f32 v102, v102
  v_mfma_f32_32x32x16_bf16 v[80:95], v[188:191], v[180:183], v[160:175]
  s_waitcnt lgkmcnt(0)
  v_exp_f32 v103, v103
  v_exp_f32 v104, v104
  v_exp_f32 v105, v105
  v_exp_f32 v106, v106
  v_exp_f32 v107, v107
  v_smfmac_f32_32x32x32_bf16 v[128:143], v[192:195], v[96:103], v208
  buffer_load_dwordx4 a[180:183], v210, s[20:23], s81 offen offset:64
  v_exp_f32 v108, v108
  v_exp_f32 v109, v109
  v_exp_f32 v110, v110
  v_exp_f32 v111, v111
  v_exp_f32 v64, v64
  v_exp_f32 v65, v65
  v_smfmac_f32_32x32x32_bf16 v[128:143], v[196:199], v[104:111], v208
  ds_read_b128 v[188:191], v214 offset:41984
  v_exp_f32 v66, v66
  v_exp_f32 v67, v67
  v_exp_f32 v68, v68
  v_exp_f32 v69, v69
  v_exp_f32 v70, v70
  v_mfma_f32_32x32x16_bf16 v[96:111], v[184:187], v[176:179], v[144:159]
  ds_read_b128 v[192:195], v215 offset:10240
  v_exp_f32 v71, v71
  v_exp_f32 v72, v72
  v_exp_f32 v73, v73
  v_exp_f32 v74, v74
  v_exp_f32 v75, v75
  v_smfmac_f32_32x32x32_bf16 v[112:127], v[200:203], v[64:71], v208
  ds_read_b128 v[196:199], v215 offset:10752
  v_exp_f32 v76, v76
  v_exp_f32 v77, v77
  v_exp_f32 v78, v78
  v_exp_f32 v79, v79
  v_exp_f32 v80, v80
  v_exp_f32 v81, v81
  v_smfmac_f32_32x32x32_bf16 v[112:127], v[204:207], v[72:79], v208
  buffer_load_dwordx4 a[184:187], v211, s[20:23], s81 offen offset:64
  v_exp_f32 v82, v82
  v_exp_f32 v83, v83
  v_exp_f32 v84, v84
  v_exp_f32 v85, v85
  v_exp_f32 v86, v86
  v_mfma_f32_32x32x16_bf16 v[64:79], v[184:187], v[180:183], v[160:175]
  s_waitcnt lgkmcnt(0)
  v_exp_f32 v87, v87
  v_exp_f32 v88, v88
  v_exp_f32 v89, v89
  v_exp_f32 v90, v90
  v_exp_f32 v91, v91
  v_smfmac_f32_32x32x32_bf16 v[128:143], v[200:203], v[80:87], v208
  v_exp_f32 v92, v92
  v_exp_f32 v93, v93
  v_exp_f32 v94, v94
  v_exp_f32 v95, v95
  v_exp_f32 v96, v96
  v_exp_f32 v97, v97
  v_smfmac_f32_32x32x32_bf16 v[128:143], v[204:207], v[88:95], v208
  ds_read_b128 v[184:187], v214 offset:45056
  v_exp_f32 v98, v98
  v_exp_f32 v99, v99
  v_exp_f32 v100, v100
  v_exp_f32 v101, v101
  v_exp_f32 v102, v102
  v_mfma_f32_32x32x16_bf16 v[80:95], v[188:191], v[176:179], v[144:159]
  ds_read_b128 v[200:203], v215 offset:11264
  v_exp_f32 v103, v103
  v_exp_f32 v104, v104
  v_exp_f32 v105, v105
  v_exp_f32 v106, v106
  v_exp_f32 v107, v107
  v_smfmac_f32_32x32x32_bf16 v[112:127], v[192:195], v[96:103], v208
  ds_read_b128 v[204:207], v215 offset:11776
  v_exp_f32 v108, v108
  v_exp_f32 v109, v109
  v_exp_f32 v110, v110
  v_exp_f32 v111, v111
  v_exp_f32 v64, v64
  v_exp_f32 v65, v65
  v_smfmac_f32_32x32x32_bf16 v[112:127], v[196:199], v[104:111], v208
  buffer_load_dwordx4 a[188:191], v212, s[20:23], s81 offen offset:64
  v_exp_f32 v66, v66
  v_exp_f32 v67, v67
  v_exp_f32 v68, v68
  v_exp_f32 v69, v69
  v_exp_f32 v70, v70
  v_mfma_f32_32x32x16_bf16 v[96:111], v[188:191], v[180:183], v[160:175]
  s_waitcnt lgkmcnt(0)
  v_exp_f32 v71, v71
  v_exp_f32 v72, v72
  v_exp_f32 v73, v73
  v_exp_f32 v74, v74
  v_exp_f32 v75, v75
  v_smfmac_f32_32x32x32_bf16 v[128:143], v[192:195], v[64:71], v208
  buffer_load_dwordx4 a[192:195], v209, s[20:23], s82 offen offset:0
  v_exp_f32 v76, v76
  v_exp_f32 v77, v77
  v_exp_f32 v78, v78
  v_exp_f32 v79, v79
  v_exp_f32 v80, v80
  v_exp_f32 v81, v81
  v_smfmac_f32_32x32x32_bf16 v[128:143], v[196:199], v[72:79], v208
  ds_read_b128 v[188:191], v214 offset:46080
  v_exp_f32 v82, v82
  v_exp_f32 v83, v83
  v_exp_f32 v84, v84
  v_exp_f32 v85, v85
  v_exp_f32 v86, v86
  v_mfma_f32_32x32x16_bf16 v[64:79], v[184:187], v[176:179], v[144:159]
  ds_read_b128 v[192:195], v215 offset:14336
  v_exp_f32 v87, v87
  v_exp_f32 v88, v88
  v_exp_f32 v89, v89
  v_exp_f32 v90, v90
  v_exp_f32 v91, v91
  v_smfmac_f32_32x32x32_bf16 v[112:127], v[200:203], v[80:87], v208
  ds_read_b128 v[196:199], v215 offset:14848
  v_exp_f32 v92, v92
  v_exp_f32 v93, v93
  v_exp_f32 v94, v94
  v_exp_f32 v95, v95
  v_exp_f32 v96, v96
  v_exp_f32 v97, v97
  v_smfmac_f32_32x32x32_bf16 v[112:127], v[204:207], v[88:95], v208
  buffer_load_dwordx4 a[196:199], v210, s[20:23], s82 offen offset:0
  v_exp_f32 v98, v98
  v_exp_f32 v99, v99
  v_exp_f32 v100, v100
  v_exp_f32 v101, v101
  v_exp_f32 v102, v102
  v_mfma_f32_32x32x16_bf16 v[80:95], v[184:187], v[180:183], v[160:175]
  s_waitcnt vmcnt(10) lgkmcnt(0)
  s_barrier
  v_exp_f32 v103, v103
  v_exp_f32 v104, v104
  v_exp_f32 v105, v105
  v_exp_f32 v106, v106
  v_exp_f32 v107, v107
  v_smfmac_f32_32x32x32_bf16 v[128:143], v[200:203], v[96:103], v208
  v_exp_f32 v108, v108
  v_exp_f32 v109, v109
  v_exp_f32 v110, v110
  v_exp_f32 v111, v111
  v_exp_f32 v64, v64
  v_exp_f32 v65, v65
  v_smfmac_f32_32x32x32_bf16 v[128:143], v[204:207], v[104:111], v208
  ds_read_b128 v[184:187], v214 offset:49152
  v_exp_f32 v66, v66
  v_exp_f32 v67, v67
  v_exp_f32 v68, v68
  v_exp_f32 v69, v69
  v_exp_f32 v70, v70
  v_mfma_f32_32x32x16_bf16 v[96:111], v[188:191], v[176:179], v[144:159]
  ds_read_b128 v[200:203], v215 offset:15360
  v_exp_f32 v71, v71
  v_exp_f32 v72, v72
  v_exp_f32 v73, v73
  v_exp_f32 v74, v74
  v_exp_f32 v75, v75
  v_smfmac_f32_32x32x32_bf16 v[112:127], v[192:195], v[64:71], v208
  ds_read_b128 v[204:207], v215 offset:15872
  v_exp_f32 v76, v76
  v_exp_f32 v77, v77
  v_exp_f32 v78, v78
  v_exp_f32 v79, v79
  v_exp_f32 v80, v80
  v_exp_f32 v81, v81
  v_smfmac_f32_32x32x32_bf16 v[112:127], v[196:199], v[72:79], v208
  buffer_load_dwordx4 a[200:203], v211, s[20:23], s82 offen offset:0
  v_exp_f32 v82, v82
  v_exp_f32 v83, v83
  v_exp_f32 v84, v84
  v_exp_f32 v85, v85
  v_exp_f32 v86, v86
  v_mfma_f32_32x32x16_bf16 v[64:79], v[188:191], v[180:183], v[160:175]
  s_waitcnt lgkmcnt(0)
  v_exp_f32 v87, v87
  v_exp_f32 v88, v88
  v_exp_f32 v89, v89
  v_exp_f32 v90, v90
  v_exp_f32 v91, v91
  v_smfmac_f32_32x32x32_bf16 v[128:143], v[192:195], v[80:87], v208
  buffer_load_dwordx4 a[204:207], v212, s[20:23], s82 offen offset:0
  v_exp_f32 v92, v92
  v_exp_f32 v93, v93
  v_exp_f32 v94, v94
  v_exp_f32 v95, v95
  v_exp_f32 v96, v96
  v_exp_f32 v97, v97
  v_smfmac_f32_32x32x32_bf16 v[128:143], v[196:199], v[88:95], v208
  ds_read_b128 v[188:191], v214 offset:50176
  v_add_u32 v215, v215, v216
  v_exp_f32 v98, v98
  v_exp_f32 v99, v99
  v_exp_f32 v100, v100
  v_exp_f32 v101, v101
  v_exp_f32 v102, v102
  v_mfma_f32_32x32x16_bf16 v[80:95], v[184:187], v[176:179], v[144:159]
  ds_read_b128 v[192:195], v215 offset:2048
  v_exp_f32 v103, v103
  v_exp_f32 v104, v104
  v_exp_f32 v105, v105
  v_exp_f32 v106, v106
  v_exp_f32 v107, v107
  v_smfmac_f32_32x32x32_bf16 v[112:127], v[200:203], v[96:103], v208
  ds_read_b128 v[196:199], v215 offset:2560
  v_exp_f32 v108, v108
  v_exp_f32 v109, v109
  v_exp_f32 v110, v110
  v_exp_f32 v111, v111
  v_exp_f32 v64, v64
  v_exp_f32 v65, v65
  v_smfmac_f32_32x32x32_bf16 v[112:127], v[204:207], v[104:111], v208
  v_exp_f32 v66, v66
  v_exp_f32 v67, v67
  v_exp_f32 v68, v68
  v_exp_f32 v69, v69
  v_exp_f32 v70, v70
  v_mfma_f32_32x32x16_bf16 v[96:111], v[184:187], v[180:183], v[160:175]
  s_waitcnt lgkmcnt(0)
  v_exp_f32 v71, v71
  v_exp_f32 v72, v72
  v_exp_f32 v73, v73
  v_exp_f32 v74, v74
  v_exp_f32 v75, v75
  v_smfmac_f32_32x32x32_bf16 v[128:143], v[200:203], v[64:71], v208
  buffer_load_dwordx4 a[208:211], v209, s[20:23], s82 offen offset:64
  v_exp_f32 v76, v76
  v_exp_f32 v77, v77
  v_exp_f32 v78, v78
  v_exp_f32 v79, v79
  v_exp_f32 v80, v80
  v_exp_f32 v81, v81
  v_smfmac_f32_32x32x32_bf16 v[128:143], v[204:207], v[72:79], v208
  ds_read_b128 v[184:187], v214 offset:53248
  v_exp_f32 v82, v82
  v_exp_f32 v83, v83
  v_exp_f32 v84, v84
  v_exp_f32 v85, v85
  v_exp_f32 v86, v86
  v_mfma_f32_32x32x16_bf16 v[64:79], v[188:191], v[176:179], v[144:159]
  ds_read_b128 v[200:203], v215 offset:3072
  v_exp_f32 v87, v87
  v_exp_f32 v88, v88
  v_exp_f32 v89, v89
  v_exp_f32 v90, v90
  v_exp_f32 v91, v91
  v_smfmac_f32_32x32x32_bf16 v[112:127], v[192:195], v[80:87], v208
  ds_read_b128 v[204:207], v215 offset:3584
  v_exp_f32 v92, v92
  v_exp_f32 v93, v93
  v_exp_f32 v94, v94
  v_exp_f32 v95, v95
  v_exp_f32 v96, v96
  v_exp_f32 v97, v97
  v_smfmac_f32_32x32x32_bf16 v[112:127], v[196:199], v[88:95], v208
  buffer_load_dwordx4 a[212:215], v210, s[20:23], s82 offen offset:64
  v_exp_f32 v98, v98
  v_exp_f32 v99, v99
  v_exp_f32 v100, v100
  v_exp_f32 v101, v101
  v_exp_f32 v102, v102
  v_mfma_f32_32x32x16_bf16 v[80:95], v[188:191], v[180:183], v[160:175]
  s_waitcnt lgkmcnt(0)
  v_exp_f32 v103, v103
  v_exp_f32 v104, v104
  v_exp_f32 v105, v105
  v_exp_f32 v106, v106
  v_exp_f32 v107, v107
  v_smfmac_f32_32x32x32_bf16 v[128:143], v[192:195], v[96:103], v208
  buffer_load_dwordx4 a[216:219], v211, s[20:23], s82 offen offset:64
  v_exp_f32 v108, v108
  v_exp_f32 v109, v109
  v_exp_f32 v110, v110
  v_exp_f32 v111, v111
  v_exp_f32 v64, v64
  v_exp_f32 v65, v65
  v_smfmac_f32_32x32x32_bf16 v[128:143], v[196:199], v[104:111], v208
  ds_read_b128 v[188:191], v214 offset:54272
  v_exp_f32 v66, v66
  v_exp_f32 v67, v67
  v_exp_f32 v68, v68
  v_exp_f32 v69, v69
  v_exp_f32 v70, v70
  v_mfma_f32_32x32x16_bf16 v[96:111], v[184:187], v[176:179], v[144:159]
  ds_read_b128 v[192:195], v215 offset:6144
  v_exp_f32 v71, v71
  v_exp_f32 v72, v72
  v_exp_f32 v73, v73
  v_exp_f32 v74, v74
  v_exp_f32 v75, v75
  v_smfmac_f32_32x32x32_bf16 v[112:127], v[200:203], v[64:71], v208
  ds_read_b128 v[196:199], v215 offset:6656
  v_exp_f32 v76, v76
  v_exp_f32 v77, v77
  v_exp_f32 v78, v78
  v_exp_f32 v79, v79
  v_exp_f32 v80, v80
  v_exp_f32 v81, v81
  v_smfmac_f32_32x32x32_bf16 v[112:127], v[204:207], v[72:79], v208
  v_exp_f32 v82, v82
  v_exp_f32 v83, v83
  v_exp_f32 v84, v84
  v_exp_f32 v85, v85
  v_exp_f32 v86, v86
  v_mfma_f32_32x32x16_bf16 v[64:79], v[184:187], v[180:183], v[160:175]
  s_waitcnt lgkmcnt(0)
  v_exp_f32 v87, v87
  v_exp_f32 v88, v88
  v_exp_f32 v89, v89
  v_exp_f32 v90, v90
  v_exp_f32 v91, v91
  v_smfmac_f32_32x32x32_bf16 v[128:143], v[200:203], v[80:87], v208
  buffer_load_dwordx4 a[220:223], v212, s[20:23], s82 offen offset:64
  v_exp_f32 v92, v92
  v_exp_f32 v93, v93
  v_exp_f32 v94, v94
  v_exp_f32 v95, v95
  v_exp_f32 v96, v96
  v_exp_f32 v97, v97
  v_smfmac_f32_32x32x32_bf16 v[128:143], v[204:207], v[88:95], v208
  ds_read_b128 v[184:187], v214 offset:57344
  v_exp_f32 v98, v98
  v_exp_f32 v99, v99
  v_exp_f32 v100, v100
  v_exp_f32 v101, v101
  v_exp_f32 v102, v102
  v_mfma_f32_32x32x16_bf16 v[80:95], v[188:191], v[176:179], v[144:159]
  ds_read_b128 v[200:203], v215 offset:7168
  v_exp_f32 v103, v103
  v_exp_f32 v104, v104
  v_exp_f32 v105, v105
  v_exp_f32 v106, v106
  v_exp_f32 v107, v107
  v_smfmac_f32_32x32x32_bf16 v[112:127], v[192:195], v[96:103], v208
  ds_read_b128 v[204:207], v215 offset:7680
  v_exp_f32 v108, v108
  v_exp_f32 v109, v109
  v_exp_f32 v110, v110
  v_exp_f32 v111, v111
  v_exp_f32 v64, v64
  v_exp_f32 v65, v65
  v_smfmac_f32_32x32x32_bf16 v[112:127], v[196:199], v[104:111], v208
  buffer_load_dwordx4 a[224:227], v209, s[20:23], s83 offen offset:0
  v_exp_f32 v66, v66
  v_exp_f32 v67, v67
  v_exp_f32 v68, v68
  v_exp_f32 v69, v69
  v_exp_f32 v70, v70
  v_mfma_f32_32x32x16_bf16 v[96:111], v[188:191], v[180:183], v[160:175]
  s_waitcnt lgkmcnt(0)
  v_exp_f32 v71, v71
  v_exp_f32 v72, v72
  v_exp_f32 v73, v73
  v_exp_f32 v74, v74
  v_exp_f32 v75, v75
  v_smfmac_f32_32x32x32_bf16 v[128:143], v[192:195], v[64:71], v208
  v_exp_f32 v76, v76
  v_exp_f32 v77, v77
  v_exp_f32 v78, v78
  v_exp_f32 v79, v79
  v_exp_f32 v80, v80
  v_exp_f32 v81, v81
  v_smfmac_f32_32x32x32_bf16 v[128:143], v[196:199], v[72:79], v208
  ds_read_b128 v[188:191], v214 offset:58368
  v_exp_f32 v82, v82
  v_exp_f32 v83, v83
  v_exp_f32 v84, v84
  v_exp_f32 v85, v85
  v_exp_f32 v86, v86
  v_mfma_f32_32x32x16_bf16 v[64:79], v[184:187], v[176:179], v[144:159]
  ds_read_b128 v[192:195], v215 offset:10240
  v_exp_f32 v87, v87
  v_exp_f32 v88, v88
  v_exp_f32 v89, v89
  v_exp_f32 v90, v90
  v_exp_f32 v91, v91
  v_smfmac_f32_32x32x32_bf16 v[112:127], v[200:203], v[80:87], v208
  ds_read_b128 v[196:199], v215 offset:10752
  v_exp_f32 v92, v92
  v_exp_f32 v93, v93
  v_exp_f32 v94, v94
  v_exp_f32 v95, v95
  v_exp_f32 v96, v96
  v_exp_f32 v97, v97
  v_smfmac_f32_32x32x32_bf16 v[112:127], v[204:207], v[88:95], v208
  buffer_load_dwordx4 a[228:231], v210, s[20:23], s83 offen offset:0
  v_exp_f32 v98, v98
  v_exp_f32 v99, v99
  v_exp_f32 v100, v100
  v_exp_f32 v101, v101
  v_exp_f32 v102, v102
  v_mfma_f32_32x32x16_bf16 v[80:95], v[184:187], v[180:183], v[160:175]
  s_waitcnt lgkmcnt(0)
  v_exp_f32 v103, v103
  v_exp_f32 v104, v104
  v_exp_f32 v105, v105
  v_exp_f32 v106, v106
  v_exp_f32 v107, v107
  v_smfmac_f32_32x32x32_bf16 v[128:143], v[200:203], v[96:103], v208
  buffer_load_dwordx4 a[232:235], v211, s[20:23], s83 offen offset:0
  v_exp_f32 v108, v108
  v_exp_f32 v109, v109
  v_exp_f32 v110, v110
  v_exp_f32 v111, v111
  v_exp_f32 v64, v64
  v_exp_f32 v65, v65
  v_smfmac_f32_32x32x32_bf16 v[128:143], v[204:207], v[104:111], v208
  ds_read_b128 v[184:187], v214 offset:61440
  v_exp_f32 v66, v66
  v_exp_f32 v67, v67
  v_exp_f32 v68, v68
  v_exp_f32 v69, v69
  v_exp_f32 v70, v70
  v_mfma_f32_32x32x16_bf16 v[96:111], v[188:191], v[176:179], v[144:159]
  ds_read_b128 v[200:203], v215 offset:11264
  v_exp_f32 v71, v71
  v_exp_f32 v72, v72
  v_exp_f32 v73, v73
  v_exp_f32 v74, v74
  v_exp_f32 v75, v75
  v_smfmac_f32_32x32x32_bf16 v[112:127], v[192:195], v[64:71], v208
  ds_read_b128 v[204:207], v215 offset:11776
  v_exp_f32 v76, v76
  v_exp_f32 v77, v77
  v_exp_f32 v78, v78
  v_exp_f32 v79, v79
  v_exp_f32 v80, v80
  v_exp_f32 v81, v81
  v_smfmac_f32_32x32x32_bf16 v[112:127], v[196:199], v[72:79], v208
  buffer_load_dwordx4 a[236:239], v212, s[20:23], s83 offen offset:0
  v_exp_f32 v82, v82
  v_exp_f32 v83, v83
  v_exp_f32 v84, v84
  v_exp_f32 v85, v85
  v_exp_f32 v86, v86
  v_mfma_f32_32x32x16_bf16 v[64:79], v[188:191], v[180:183], v[160:175]
  s_waitcnt lgkmcnt(0)
  v_exp_f32 v87, v87
  v_exp_f32 v88, v88
  v_exp_f32 v89, v89
  v_exp_f32 v90, v90
  v_exp_f32 v91, v91
  v_smfmac_f32_32x32x32_bf16 v[128:143], v[192:195], v[80:87], v208
  v_exp_f32 v92, v92
  v_exp_f32 v93, v93
  v_exp_f32 v94, v94
  v_exp_f32 v95, v95
  v_exp_f32 v96, v96
  v_exp_f32 v97, v97
  v_smfmac_f32_32x32x32_bf16 v[128:143], v[196:199], v[88:95], v208
  ds_read_b128 v[188:191], v214 offset:62464
  v_exp_f32 v98, v98
  v_exp_f32 v99, v99
  v_exp_f32 v100, v100
  v_exp_f32 v101, v101
  v_exp_f32 v102, v102
  v_mfma_f32_32x32x16_bf16 v[80:95], v[184:187], v[176:179], v[144:159]
  ds_read_b128 v[192:195], v215 offset:14336
  v_exp_f32 v103, v103
  v_exp_f32 v104, v104
  v_exp_f32 v105, v105
  v_exp_f32 v106, v106
  v_exp_f32 v107, v107
  v_smfmac_f32_32x32x32_bf16 v[112:127], v[200:203], v[96:103], v208
  ds_read_b128 v[196:199], v215 offset:14848
  v_exp_f32 v108, v108
  v_exp_f32 v109, v109
  v_exp_f32 v110, v110
  v_exp_f32 v111, v111
  v_exp_f32 v64, v64
  v_exp_f32 v65, v65
  v_smfmac_f32_32x32x32_bf16 v[112:127], v[204:207], v[104:111], v208
  buffer_load_dwordx4 a[240:243], v209, s[20:23], s83 offen offset:64
  v_exp_f32 v66, v66
  v_exp_f32 v67, v67
  v_exp_f32 v68, v68
  v_exp_f32 v69, v69
  v_exp_f32 v70, v70
  v_mfma_f32_32x32x16_bf16 v[96:111], v[184:187], v[180:183], v[160:175]
  s_waitcnt lgkmcnt(0)
  v_exp_f32 v71, v71
  v_exp_f32 v72, v72
  v_exp_f32 v73, v73
  v_exp_f32 v74, v74
  v_exp_f32 v75, v75
  v_smfmac_f32_32x32x32_bf16 v[128:143], v[200:203], v[64:71], v208
  buffer_load_dwordx4 a[244:247], v210, s[20:23], s83 offen offset:64
  v_exp_f32 v76, v76
  v_exp_f32 v77, v77
  v_exp_f32 v78, v78
  v_exp_f32 v79, v79
  v_exp_f32 v80, v80
  v_exp_f32 v81, v81
  v_smfmac_f32_32x32x32_bf16 v[128:143], v[204:207], v[72:79], v208
  v_exp_f32 v82, v82
  v_exp_f32 v83, v83
  v_exp_f32 v84, v84
  v_exp_f32 v85, v85
  v_exp_f32 v86, v86
  v_mfma_f32_32x32x16_bf16 v[64:79], v[188:191], v[176:179], v[144:159]
  ds_read_b128 v[200:203], v215 offset:15360
  v_exp_f32 v87, v87
  v_exp_f32 v88, v88
  v_exp_f32 v89, v89
  v_exp_f32 v90, v90
  v_exp_f32 v91, v91
  v_smfmac_f32_32x32x32_bf16 v[112:127], v[192:195], v[80:87], v208
  ds_read_b128 v[204:207], v215 offset:15872
  v_exp_f32 v92, v92
  v_exp_f32 v93, v93
  v_exp_f32 v94, v94
  v_exp_f32 v95, v95
  v_exp_f32 v96, v96
  v_exp_f32 v97, v97
  v_smfmac_f32_32x32x32_bf16 v[112:127], v[196:199], v[88:95], v208
  v_exp_f32 v98, v98
  v_exp_f32 v99, v99
  v_exp_f32 v100, v100
  v_exp_f32 v101, v101
  v_exp_f32 v102, v102
  v_mfma_f32_32x32x16_bf16 v[80:95], v[188:191], v[180:183], v[160:175]
  s_waitcnt lgkmcnt(0)
  v_exp_f32 v103, v103
  v_exp_f32 v104, v104
  v_exp_f32 v105, v105
  v_exp_f32 v106, v106
  v_exp_f32 v107, v107
  v_smfmac_f32_32x32x32_bf16 v[128:143], v[192:195], v[96:103], v208
  buffer_load_dwordx4 a[248:251], v211, s[20:23], s83 offen offset:64
  v_exp_f32 v108, v108
  v_exp_f32 v109, v109
  v_exp_f32 v110, v110
  v_exp_f32 v111, v111
  v_exp_f32 v64, v64
  v_exp_f32 v65, v65
  v_smfmac_f32_32x32x32_bf16 v[128:143], v[196:199], v[104:111], v208
  v_exp_f32 v66, v66
  v_exp_f32 v67, v67
  v_exp_f32 v68, v68
  v_exp_f32 v69, v69
  v_exp_f32 v70, v70
  v_exp_f32 v71, v71
  v_exp_f32 v72, v72
  v_exp_f32 v73, v73
  v_exp_f32 v74, v74
  v_exp_f32 v75, v75
  v_smfmac_f32_32x32x32_bf16 v[112:127], v[200:203], v[64:71], v208
  v_exp_f32 v76, v76
  v_exp_f32 v77, v77
  v_exp_f32 v78, v78
  v_exp_f32 v79, v79
  v_exp_f32 v80, v80
  v_exp_f32 v81, v81
  v_smfmac_f32_32x32x32_bf16 v[112:127], v[204:207], v[72:79], v208
  buffer_load_dwordx4 a[252:255], v212, s[20:23], s83 offen offset:64
  v_exp_f32 v82, v82
  v_exp_f32 v83, v83
  v_exp_f32 v84, v84
  v_exp_f32 v85, v85
  v_exp_f32 v86, v86
  v_exp_f32 v87, v87
  v_exp_f32 v88, v88
  v_exp_f32 v89, v89
  v_exp_f32 v90, v90
  v_exp_f32 v91, v91
  v_smfmac_f32_32x32x32_bf16 v[128:143], v[200:203], v[80:87], v208
  v_exp_f32 v92, v92
  v_exp_f32 v93, v93
  v_exp_f32 v94, v94
  v_exp_f32 v95, v95
  s_nop 1
  v_smfmac_f32_32x32x32_bf16 v[128:143], v[204:207], v[88:95], v208
  s_barrier
  v_pk_add_f32 v[8:9], v[112:113], v[114:115]
  v_pk_add_f32 v[10:11], v[116:117], v[118:119]
  s_nop 8
  v_pk_add_f32 v[12:13], v[128:129], v[130:131]
  v_pk_add_f32 v[14:15], v[132:133], v[134:135]
  v_pk_add_f32 v[8:9], v[8:9], v[10:11]
  v_pk_add_f32 v[12:13], v[12:13], v[14:15]
  v_add_f32 v8, v8, v9
  v_add_f32 v12, v12, v13
  v_add_f32 v8, v8, v12
  v_max_f32 v9, v120, v136
  v_add_f32 v10, v120, v136
  v_add_f32 v8, v8, v10
  s_mov_b32 s62, 0x207
  v_cmp_class_f32_e64 vcc, v8, s62
  s_nop 1
  s_mov_b64 s[60:61], vcc
  v_cmp_le_f32 vcc, 0x5f800000, v9
  s_nop 1
  s_or_b64 vcc, vcc, s[60:61]
  s_cbranch_vccnz L_attn_slow
L_attn_done:
  v_rcp_f32 v8, v120
  v_rcp_f32 v9, v136
  v_mul_f32 v112, v112, v8
  v_mul_f32 v113, v113, v8
  v_mul_f32 v114, v114, v8
  v_mul_f32 v115, v115, v8
  v_mul_f32 v116, v116, v8
  v_mul_f32 v117, v117, v8
  v_mul_f32 v118, v118, v8
  v_mul_f32 v119, v119, v8
  v_cvt_pk_bf16_f32 v192, v112, v113
  v_cvt_pk_bf16_f32 v193, v114, v115
  v_cvt_pk_bf16_f32 v194, v116, v117
  v_cvt_pk_bf16_f32 v195, v118, v119
  buffer_store_dwordx2 v[192:193], v227, s[36:39], s84 offen offset:0 sc1
  buffer_store_dwordx2 v[194:195], v227, s[36:39], s84 offen offset:256 sc1
  v_mul_f32 v128, v128, v9
  v_mul_f32 v129, v129, v9
  v_mul_f32 v130, v130, v9
  v_mul_f32 v131, v131, v9
  v_mul_f32 v132, v132, v9
  v_mul_f32 v133, v133, v9
  v_mul_f32 v134, v134, v9
  v_mul_f32 v135, v135, v9
  v_cvt_pk_bf16_f32 v196, v128, v129
  v_cvt_pk_bf16_f32 v197, v130, v131
  v_cvt_pk_bf16_f32 v198, v132, v133
  v_cvt_pk_bf16_f32 v199, v134, v135
  buffer_store_dwordx2 v[196:197], v227, s[36:39], s85 offen offset:0 sc1
  buffer_store_dwordx2 v[198:199], v227, s[36:39], s85 offen offset:256 sc1
  s_lshl_b32 s75, s44, 14
  s_add_u32 m0, s75, 98304
  s_nop 0
  buffer_load_dwordx4 v217, s[12:15], s56 offen offset:0 lds
  buffer_load_dwordx4 v218, s[12:15], s56 offen offset:1024 lds
  buffer_load_dwordx4 v219, s[12:15], s56 offen offset:2048 lds
  buffer_load_dwordx4 v220, s[12:15], s56 offen offset:3072 lds
  s_lshl_b32 s75, s44, 14
  s_add_u32 m0, s75, 102400
  s_nop 0
  buffer_load_dwordx4 v217, s[12:15], s57 offen offset:0 lds
  buffer_load_dwordx4 v218, s[12:15], s57 offen offset:1024 lds
  buffer_load_dwordx4 v219, s[12:15], s57 offen offset:2048 lds
  buffer_load_dwordx4 v220, s[12:15], s57 offen offset:3072 lds
  s_waitcnt vmcnt(8)
  s_mov_b64 exec, 1
  buffer_store_dwordx2 v[4:5], off, s[36:39], s86 sc1
  s_mov_b64 exec, -1
  s_lshl_b32 s75, s44, 14
  s_add_u32 m0, s75, 106496
  s_nop 0
  buffer_load_dwordx4 v217, s[12:15], s58 offen offset:0 lds
  buffer_load_dwordx4 v218, s[12:15], s58 offen offset:1024 lds
  buffer_load_dwordx4 v219, s[12:15], s58 offen offset:2048 lds
  buffer_load_dwordx4 v220, s[12:15], s58 offen offset:3072 lds
  s_lshl_b32 s75, s44, 14
  s_add_u32 m0, s75, 110592
  s_nop 0
  buffer_load_dwordx4 v217, s[12:15], s59 offen offset:0 lds
  buffer_load_dwordx4 v218, s[12:15], s59 offen offset:1024 lds
  buffer_load_dwordx4 v219, s[12:15], s59 offen offset:2048 lds
  buffer_load_dwordx4 v220, s[12:15], s59 offen offset:3072 lds
  buffer_load_dwordx2 v[240:241], v62, s[4:7], s87 offen offset:0
  buffer_load_dwordx2 v[242:243], v62, s[4:7], s87 offen offset:32
  buffer_load_dwordx2 v[244:245], v62, s[4:7], s88 offen offset:0
  buffer_load_dwordx2 v[246:247], v62, s[4:7], s88 offen offset:32
  s_mov_b32 s76, s42
  s_lshr_b32 s56, s45, 4
  s_add_u32 s56, s56, s44
  s_mul_i32 s56, s56, 16384
  s_add_u32 s72, s56, 7340032
  s_mul_i32 s57, s44, 16384
  s_add_u32 s73, s57, 98304
  s_add_u32 s86, s76, 0
  s_and_b32 s86, s86, 7
  s_lshl_b32 s86, s86, 11
  s_add_u32 s86, s86, s72
  s_add_u32 s87, s76, 1
  s_and_b32 s87, s87, 7
  s_lshl_b32 s87, s87, 11
  s_add_u32 s87, s87, s72
  s_add_u32 s88, s76, 2
  s_and_b32 s88, s88, 7
  s_lshl_b32 s88, s88, 11
  s_add_u32 s88, s88, s72
  s_add_u32 s89, s76, 3
  s_and_b32 s89, s89, 7
  s_lshl_b32 s89, s89, 11
  s_add_u32 s89, s89, s72
  s_lshl_b32 s59, s54, 12
  s_add_u32 s59, s59, 589824
  s_lshl_b32 s60, s46, 15
  s_add_u32 s60, s60, 98304
  v_add_u32 v30, s60, v1
  s_cmp_eq_u32 s44, 0
  s_cbranch_scc1 L_s2poll_8
  s_sub_u32 s61, s44, 1
L_s2poll_8:
  s_waitcnt vmcnt(4)
  s_barrier
  ds_read_b64_tr_b16 v[64:65], v28 offset:0
  ds_read_b64_tr_b16 v[66:67], v28 offset:512
  ds_read_b64_tr_b16 v[128:129], v29 offset:0
  ds_read_b64_tr_b16 v[130:131], v29 offset:512
  ds_read_b64_tr_b16 v[68:69], v28 offset:4096
  ds_read_b64_tr_b16 v[70:71], v28 offset:4608
  ds_read_b64_tr_b16 v[132:133], v29 offset:4096
  ds_read_b64_tr_b16 v[134:135], v29 offset:4608
  ds_read_b64_tr_b16 v[72:73], v28 offset:8192
  ds_read_b64_tr_b16 v[74:75], v28 offset:8704
  ds_read_b64_tr_b16 v[136:137], v29 offset:8192
  ds_read_b64_tr_b16 v[138:139], v29 offset:8704
  ds_read_b64_tr_b16 v[76:77], v28 offset:12288
  ds_read_b64_tr_b16 v[78:79], v28 offset:12800
  ds_read_b64_tr_b16 v[140:141], v29 offset:12288
  ds_read_b64_tr_b16 v[142:143], v29 offset:12800
  ds_read_b64_tr_b16 v[80:81], v28 offset:16384
  ds_read_b64_tr_b16 v[82:83], v28 offset:16896
  ds_read_b64_tr_b16 v[144:145], v29 offset:16384
  ds_read_b64_tr_b16 v[146:147], v29 offset:16896
  ds_read_b64_tr_b16 v[84:85], v28 offset:20480
  ds_read_b64_tr_b16 v[86:87], v28 offset:20992
  ds_read_b64_tr_b16 v[148:149], v29 offset:20480
  ds_read_b64_tr_b16 v[150:151], v29 offset:20992
  ds_read_b64_tr_b16 v[88:89], v28 offset:24576
  ds_read_b64_tr_b16 v[90:91], v28 offset:25088
  ds_read_b64_tr_b16 v[152:153], v29 offset:24576
  ds_read_b64_tr_b16 v[154:155], v29 offset:25088
  ds_read_b64_tr_b16 v[92:93], v28 offset:28672
  ds_read_b64_tr_b16 v[94:95], v28 offset:29184
  ds_read_b64_tr_b16 v[156:157], v29 offset:28672
  ds_read_b64_tr_b16 v[158:159], v29 offset:29184
  ds_read_b64_tr_b16 v[96:97], v28 offset:32768
  ds_read_b64_tr_b16 v[98:99], v28 offset:33280
  ds_read_b64_tr_b16 v[160:161], v29 offset:32768
  ds_read_b64_tr_b16 v[162:163], v29 offset:33280
  ds_read_b64_tr_b16 v[100:101], v28 offset:36864
  ds_read_b64_tr_b16 v[102:103], v28 offset:37376
  ds_read_b64_tr_b16 v[164:165], v29 offset:36864
  ds_read_b64_tr_b16 v[166:167], v29 offset:37376
  ds_read_b64_tr_b16 v[104:105], v28 offset:40960
  ds_read_b64_tr_b16 v[106:107], v28 offset:41472
  ds_read_b64_tr_b16 v[168:169], v29 offset:40960
  ds_read_b64_tr_b16 v[170:171], v29 offset:41472
  ds_read_b64_tr_b16 v[108:109], v28 offset:45056
  ds_read_b64_tr_b16 v[110:111], v28 offset:45568
  ds_read_b64_tr_b16 v[172:173], v29 offset:45056
  ds_read_b64_tr_b16 v[174:175], v29 offset:45568
  ds_read_b64_tr_b16 v[112:113], v28 offset:49152
  ds_read_b64_tr_b16 v[114:115], v28 offset:49664
  ds_read_b64_tr_b16 v[176:177], v29 offset:49152
  ds_read_b64_tr_b16 v[178:179], v29 offset:49664
  ds_read_b64_tr_b16 v[116:117], v28 offset:53248
  ds_read_b64_tr_b16 v[118:119], v28 offset:53760
  ds_read_b64_tr_b16 v[180:181], v29 offset:53248
  ds_read_b64_tr_b16 v[182:183], v29 offset:53760
  ds_read_b64_tr_b16 v[120:121], v28 offset:57344
  ds_read_b64_tr_b16 v[122:123], v28 offset:57856
  ds_read_b64_tr_b16 v[184:185], v29 offset:57344
  ds_read_b64_tr_b16 v[186:187], v29 offset:57856
  ds_read_b64_tr_b16 v[124:125], v28 offset:61440
  ds_read_b64_tr_b16 v[126:127], v28 offset:61952
  ds_read_b64_tr_b16 v[188:189], v29 offset:61440
  ds_read_b64_tr_b16 v[190:191], v29 offset:61952
  s_cmp_eq_u32 s44, 0
  s_cbranch_scc1 L_s2poll_10
  s_sub_u32 s61, s44, 1
  s_lshl_b32 s77, s48, 5
  s_mul_i32 s78, s61, 4
  s_lshl_b32 s74, s76, 2
  s_add_u32 s74, s74, s78
  s_mul_i32 s78, s78, 3072
  s_add_u32 s79, s74, 0
  s_and_b32 s79, s79, 31
  s_mul_i32 s79, s79, 44032
  s_add_u32 s79, s79, s77
  s_add_u32 s79, s79, 1376
  s_add_u32 m0, s78, 0
  s_nop 0
  buffer_load_dwordx4 v56, s[16:19], s79 offen offset:0 lds
  buffer_load_dwordx4 v57, s[16:19], s79 offen offset:1024 lds
  buffer_load_dwordx4 v58, s[16:19], s79 offen offset:2048 lds
  s_add_u32 s79, s74, 1
  s_and_b32 s79, s79, 31
  s_mul_i32 s79, s79, 44032
  s_add_u32 s79, s79, s77
  s_add_u32 s79, s79, 1376
  s_add_u32 m0, s78, 3072
  s_nop 0
  buffer_load_dwordx4 v56, s[16:19], s79 offen offset:0 lds
  buffer_load_dwordx4 v57, s[16:19], s79 offen offset:1024 lds
  buffer_load_dwordx4 v58, s[16:19], s79 offen offset:2048 lds
  s_add_u32 s79, s74, 2
  s_and_b32 s79, s79, 31
  s_mul_i32 s79, s79, 44032
  s_add_u32 s79, s79, s77
  s_add_u32 s79, s79, 1376
  s_add_u32 m0, s78, 6144
  s_nop 0
  buffer_load_dwordx4 v56, s[16:19], s79 offen offset:0 lds
  buffer_load_dwordx4 v57, s[16:19], s79 offen offset:1024 lds
  buffer_load_dwordx4 v58, s[16:19], s79 offen offset:2048 lds
  s_add_u32 s79, s74, 3
  s_and_b32 s79, s79, 31
  s_mul_i32 s79, s79, 44032
  s_add_u32 s79, s79, s77
  s_add_u32 s79, s79, 1376
  s_add_u32 m0, s78, 9216
  s_nop 0
  buffer_load_dwordx4 v56, s[16:19], s79 offen offset:0 lds
  buffer_load_dwordx4 v57, s[16:19], s79 offen offset:1024 lds
  buffer_load_dwordx4 v58, s[16:19], s79 offen offset:2048 lds
  s_branch L_s2end_9
L_s2poll_10:
  s_mov_b32 s55, 0x40000
L_poll_11:
  buffer_load_dwordx2 v[52:53], v6, s[36:39], s59 offen sc1
  s_waitcnt vmcnt(0)
  v_cmp_ne_u64 vcc, s[50:51], v[52:53]
  s_sub_u32 s55, s55, 1
  s_cbranch_scc1 L_polled_12
  s_cbranch_vccnz L_poll_11
L_polled_12:
L_s2end_9:
  s_waitcnt lgkmcnt(0)
  s_barrier
  s_add_u32 m0, s73, 0
  s_nop 0
  buffer_load_dwordx4 v1, s[36:39], s86 offen offset:0 sc1 lds
  buffer_load_dwordx4 v1, s[36:39], s86 offen offset:1024 sc1 lds
  s_add_u32 m0, s73, 2048
  s_nop 0
  buffer_load_dwordx4 v1, s[36:39], s87 offen offset:0 sc1 lds
  buffer_load_dwordx4 v1, s[36:39], s87 offen offset:1024 sc1 lds
  s_add_u32 m0, s73, 4096
  s_nop 0
  buffer_load_dwordx4 v1, s[36:39], s88 offen offset:0 sc1 lds
  buffer_load_dwordx4 v1, s[36:39], s88 offen offset:1024 sc1 lds
  s_add_u32 m0, s73, 6144
  s_nop 0
  buffer_load_dwordx4 v1, s[36:39], s89 offen offset:0 sc1 lds
  buffer_load_dwordx4 v1, s[36:39], s89 offen offset:1024 sc1 lds
  s_waitcnt vmcnt(6)
  v_lshlrev_b32 v32, 16, v240
  v_and_b32 v33, s53, v240
  v_lshlrev_b32 v34, 16, v241
  v_and_b32 v35, s53, v241
  v_lshlrev_b32 v36, 16, v242
  v_and_b32 v37, s53, v242
  v_lshlrev_b32 v38, 16, v243
  v_and_b32 v39, s53, v243
  v_lshlrev_b32 v40, 16, v244
  v_and_b32 v41, s53, v244
  v_lshlrev_b32 v42, 16, v245
  v_and_b32 v43, s53, v245
  v_lshlrev_b32 v44, 16, v246
  v_and_b32 v45, s53, v246
  v_lshlrev_b32 v46, 16, v247
  v_and_b32 v47, s53, v247
  s_barrier
  ds_read_b128 v[208:211], v30 offset:0
  ds_read_b128 v[212:215], v30 offset:16384
  ds_read_b128 v[216:219], v30 offset:1024
  ds_read_b128 v[220:223], v30 offset:17408
  s_waitcnt lgkmcnt(2)
  s_waitcnt vmcnt(4)
  s_barrier
  v_mfma_f32_16x16x32_bf16 v[192:195], v[64:67], v[208:211], v[32:35]
  ds_read_b128 v[224:227], v30 offset:2048
  v_mfma_f32_16x16x32_bf16 v[196:199], v[128:131], v[208:211], v[36:39]
  ds_read_b128 v[228:231], v30 offset:18432
  v_mfma_f32_16x16x32_bf16 v[200:203], v[64:67], v[212:215], v[40:43]
  s_add_u32 s58, s76, 4
  s_and_b32 s58, s58, 7
  s_lshl_b32 s58, s58, 11
  s_add_u32 s58, s58, s72
  s_add_u32 m0, s73, 8192
  s_nop 0
  buffer_load_dwordx4 v1, s[36:39], s58 offen offset:0 sc1 lds
  v_mfma_f32_16x16x32_bf16 v[204:207], v[128:131], v[212:215], v[44:47]
  buffer_load_dwordx4 v1, s[36:39], s58 offen offset:1024 sc1 lds
  s_waitcnt lgkmcnt(2)
  v_mfma_f32_16x16x32_bf16 v[192:195], v[68:71], v[216:219], v[192:195]
  ds_read_b128 v[232:235], v30 offset:3072
  v_mfma_f32_16x16x32_bf16 v[196:199], v[132:135], v[216:219], v[196:199]
  ds_read_b128 v[236:239], v30 offset:19456
  v_mfma_f32_16x16x32_bf16 v[200:203], v[68:71], v[220:223], v[200:203]
  s_add_u32 s58, s76, 5
  s_and_b32 s58, s58, 7
  s_lshl_b32 s58, s58, 11
  s_add_u32 s58, s58, s72
  s_add_u32 m0, s73, 10240
  s_nop 0
  buffer_load_dwordx4 v1, s[36:39], s58 offen offset:0 sc1 lds
  v_mfma_f32_16x16x32_bf16 v[204:207], v[132:135], v[220:223], v[204:207]
  buffer_load_dwordx4 v1, s[36:39], s58 offen offset:1024 sc1 lds
  s_waitcnt lgkmcnt(2)
  s_waitcnt vmcnt(4)
  s_barrier
  v_mfma_f32_16x16x32_bf16 v[192:195], v[72:75], v[224:227], v[192:195]
  ds_read_b128 v[208:211], v30 offset:4096
  v_mfma_f32_16x16x32_bf16 v[196:199], v[136:139], v[224:227], v[196:199]
  ds_read_b128 v[212:215], v30 offset:20480
  v_mfma_f32_16x16x32_bf16 v[200:203], v[72:75], v[228:231], v[200:203]
  s_add_u32 s58, s76, 6
  s_and_b32 s58, s58, 7
  s_lshl_b32 s58, s58, 11
  s_add_u32 s58, s58, s72
  s_add_u32 m0, s73, 12288
  s_nop 0
  buffer_load_dwordx4 v1, s[36:39], s58 offen offset:0 sc1 lds
  v_mfma_f32_16x16x32_bf16 v[204:207], v[136:139], v[228:231], v[204:207]
  buffer_load_dwordx4 v1, s[36:39], s58 offen offset:1024 sc1 lds
  s_waitcnt lgkmcnt(2)
  v_mfma_f32_16x16x32_bf16 v[192:195], v[76:79], v[232:235], v[192:195]
  ds_read_b128 v[216:219], v30 offset:5120
  ds_read_b128 v[220:223], v30 offset:21504
  v_mfma_f32_16x16x32_bf16 v[196:199], v[140:143], v[232:235], v[196:199]
  s_add_u32 s58, s76, 7
  s_and_b32 s58, s58, 7
  s_lshl_b32 s58, s58, 11
  s_add_u32 s58, s58, s72
  s_add_u32 m0, s73, 14336
  s_nop 0
  buffer_load_dwordx4 v1, s[36:39], s58 offen offset:0 sc1 lds
  v_mfma_f32_16x16x32_bf16 v[200:203], v[76:79], v[236:239], v[200:203]
  buffer_load_dwordx4 v1, s[36:39], s58 offen offset:1024 sc1 lds
  v_mfma_f32_16x16x32_bf16 v[204:207], v[140:143], v[236:239], v[204:207]
  s_lshl_b32 s77, s48, 5
  s_mul_i32 s78, s44, 4
  s_lshl_b32 s74, s76, 2
  s_add_u32 s74, s74, s78
  s_mul_i32 s78, s78, 3072
  s_add_u32 s79, s74, 12
  s_and_b32 s79, s79, 31
  s_mul_i32 s79, s79, 44032
  s_add_u32 s79, s79, s77
  s_add_u32 s79, s79, 1376
  s_add_u32 m0, s78, 36864
  s_nop 0
  buffer_load_dwordx4 v56, s[16:19], s79 offen offset:0 lds
  s_waitcnt lgkmcnt(2)
  v_mfma_f32_16x16x32_bf16 v[192:195], v[80:83], v[208:211], v[192:195]
  ds_read_b128 v[224:227], v30 offset:6144
  v_mfma_f32_16x16x32_bf16 v[196:199], v[144:147], v[208:211], v[196:199]
  ds_read_b128 v[228:231], v30 offset:22528
  v_mfma_f32_16x16x32_bf16 v[200:203], v[80:83], v[212:215], v[200:203]
  v_mfma_f32_16x16x32_bf16 v[204:207], v[144:147], v[212:215], v[204:207]
  buffer_load_dwordx4 v57, s[16:19], s79 offen offset:1024 lds
  s_waitcnt lgkmcnt(2)
  v_mfma_f32_16x16x32_bf16 v[192:195], v[84:87], v[216:219], v[192:195]
  ds_read_b128 v[232:235], v30 offset:7168
  v_mfma_f32_16x16x32_bf16 v[196:199], v[148:151], v[216:219], v[196:199]
  ds_read_b128 v[236:239], v30 offset:23552
  v_mfma_f32_16x16x32_bf16 v[200:203], v[84:87], v[220:223], v[200:203]
  v_mfma_f32_16x16x32_bf16 v[204:207], v[148:151], v[220:223], v[204:207]
  buffer_load_dwordx4 v58, s[16:19], s79 offen offset:2048 lds
  s_waitcnt lgkmcnt(2)
  s_waitcnt vmcnt(7)
  s_barrier
  v_mfma_f32_16x16x32_bf16 v[192:195], v[88:91], v[224:227], v[192:195]
  ds_read_b128 v[208:211], v30 offset:8192
  v_mfma_f32_16x16x32_bf16 v[196:199], v[152:155], v[224:227], v[196:199]
  ds_read_b128 v[212:215], v30 offset:24576
  v_mfma_f32_16x16x32_bf16 v[200:203], v[88:91], v[228:231], v[200:203]
  v_mfma_f32_16x16x32_bf16 v[204:207], v[152:155], v[228:231], v[204:207]
  s_add_u32 s79, s74, 13
  s_and_b32 s79, s79, 31
  s_mul_i32 s79, s79, 44032
  s_add_u32 s79, s79, s77
  s_add_u32 s79, s79, 1376
  s_add_u32 m0, s78, 39936
  s_nop 0
  buffer_load_dwordx4 v56, s[16:19], s79 offen offset:0 lds
  s_waitcnt lgkmcnt(2)
  v_mfma_f32_16x16x32_bf16 v[192:195], v[92:95], v[232:235], v[192:195]
  ds_read_b128 v[216:219], v30 offset:9216
  v_mfma_f32_16x16x32_bf16 v[196:199], v[156:159], v[232:235], v[196:199]
  ds_read_b128 v[220:223], v30 offset:25600
  v_mfma_f32_16x16x32_bf16 v[200:203], v[92:95], v[236:239], v[200:203]
  v_mfma_f32_16x16x32_bf16 v[204:207], v[156:159], v[236:239], v[204:207]
  buffer_load_dwordx4 v57, s[16:19], s79 offen offset:1024 lds
  s_waitcnt lgkmcnt(2)
  v_mfma_f32_16x16x32_bf16 v[192:195], v[96:99], v[208:211], v[192:195]
  ds_read_b128 v[224:227], v30 offset:10240
  v_mfma_f32_16x16x32_bf16 v[196:199], v[160:163], v[208:211], v[196:199]
  ds_read_b128 v[228:231], v30 offset:26624
  v_mfma_f32_16x16x32_bf16 v[200:203], v[96:99], v[212:215], v[200:203]
  v_mfma_f32_16x16x32_bf16 v[204:207], v[160:163], v[212:215], v[204:207]
  buffer_load_dwordx4 v58, s[16:19], s79 offen offset:2048 lds
  s_waitcnt lgkmcnt(2)
  v_mfma_f32_16x16x32_bf16 v[192:195], v[100:103], v[216:219], v[192:195]
  ds_read_b128 v[232:235], v30 offset:11264
  v_mfma_f32_16x16x32_bf16 v[196:199], v[164:167], v[216:219], v[196:199]
  ds_read_b128 v[236:239], v30 offset:27648
  v_mfma_f32_16x16x32_bf16 v[200:203], v[100:103], v[220:223], v[200:203]
  v_mfma_f32_16x16x32_bf16 v[204:207], v[164:167], v[220:223], v[204:207]
  s_add_u32 s79, s74, 14
  s_and_b32 s79, s79, 31
  s_mul_i32 s79, s79, 44032
  s_add_u32 s79, s79, s77
  s_add_u32 s79, s79, 1376
  s_add_u32 m0, s78, 43008
  s_nop 0
  buffer_load_dwordx4 v56, s[16:19], s79 offen offset:0 lds
  s_waitcnt lgkmcnt(2)
  s_waitcnt vmcnt(7)
  s_barrier
  v_mfma_f32_16x16x32_bf16 v[192:195], v[104:107], v[224:227], v[192:195]
  ds_read_b128 v[208:211], v30 offset:12288
  v_mfma_f32_16x16x32_bf16 v[196:199], v[168:171], v[224:227], v[196:199]
  ds_read_b128 v[212:215], v30 offset:28672
  v_mfma_f32_16x16x32_bf16 v[200:203], v[104:107], v[228:231], v[200:203]
  v_mfma_f32_16x16x32_bf16 v[204:207], v[168:171], v[228:231], v[204:207]
  buffer_load_dwordx4 v57, s[16:19], s79 offen offset:1024 lds
  s_waitcnt lgkmcnt(2)
  v_mfma_f32_16x16x32_bf16 v[192:195], v[108:111], v[232:235], v[192:195]
  ds_read_b128 v[216:219], v30 offset:13312
  v_mfma_f32_16x16x32_bf16 v[196:199], v[172:175], v[232:235], v[196:199]
  ds_read_b128 v[220:223], v30 offset:29696
  v_mfma_f32_16x16x32_bf16 v[200:203], v[108:111], v[236:239], v[200:203]
  v_mfma_f32_16x16x32_bf16 v[204:207], v[172:175], v[236:239], v[204:207]
  buffer_load_dwordx4 v58, s[16:19], s79 offen offset:2048 lds
  s_waitcnt lgkmcnt(2)
  v_mfma_f32_16x16x32_bf16 v[192:195], v[112:115], v[208:211], v[192:195]
  ds_read_b128 v[224:227], v30 offset:14336
  v_mfma_f32_16x16x32_bf16 v[196:199], v[176:179], v[208:211], v[196:199]
  ds_read_b128 v[228:231], v30 offset:30720
  v_mfma_f32_16x16x32_bf16 v[200:203], v[112:115], v[212:215], v[200:203]
  v_mfma_f32_16x16x32_bf16 v[204:207], v[176:179], v[212:215], v[204:207]
  s_add_u32 s79, s74, 15
  s_and_b32 s79, s79, 31
  s_mul_i32 s79, s79, 44032
  s_add_u32 s79, s79, s77
  s_add_u32 s79, s79, 1376
  s_add_u32 m0, s78, 46080
  s_nop 0
  buffer_load_dwordx4 v56, s[16:19], s79 offen offset:0 lds
  s_waitcnt lgkmcnt(2)
  v_mfma_f32_16x16x32_bf16 v[192:195], v[116:119], v[216:219], v[192:195]
  ds_read_b128 v[232:235], v30 offset:15360
  v_mfma_f32_16x16x32_bf16 v[196:199], v[180:183], v[216:219], v[196:199]
  ds_read_b128 v[236:239], v30 offset:31744
  v_mfma_f32_16x16x32_bf16 v[200:203], v[116:119], v[220:223], v[200:203]
  v_mfma_f32_16x16x32_bf16 v[204:207], v[180:183], v[220:223], v[204:207]
  buffer_load_dwordx4 v57, s[16:19], s79 offen offset:1024 lds
  s_waitcnt lgkmcnt(2)
  v_mfma_f32_16x16x32_bf16 v[192:195], v[120:123], v[224:227], v[192:195]
  v_mfma_f32_16x16x32_bf16 v[196:199], v[184:187], v[224:227], v[196:199]
  v_mfma_f32_16x16x32_bf16 v[200:203], v[120:123], v[228:231], v[200:203]
  v_mfma_f32_16x16x32_bf16 v[204:207], v[184:187], v[228:231], v[204:207]
  buffer_load_dwordx4 v58, s[16:19], s79 offen offset:2048 lds
  s_waitcnt lgkmcnt(0)
  v_mfma_f32_16x16x32_bf16 v[192:195], v[124:127], v[232:235], v[192:195]
  v_mfma_f32_16x16x32_bf16 v[196:199], v[188:191], v[232:235], v[196:199]
  s_lshr_b32 s56, s45, 4
  s_lshl_b32 s57, s46, 1
  s_add_u32 s56, s56, s57
  s_lshl_b32 s56, s56, 14
  v_mfma_f32_16x16x32_bf16 v[200:203], v[124:127], v[236:239], v[200:203]
  s_lshl_b32 s57, s42, 1
  s_add_u32 s57, s57, s47
  s_lshl_b32 s57, s57, 10
  s_add_u32 s56, s56, s57
  v_mfma_f32_16x16x32_bf16 v[204:207], v[188:191], v[236:239], v[204:207]
  s_add_u32 s56, s56, 9437184
  s_add_u32 s57, s56, 0x4000
  v_cvt_pk_bf16_f32 v8, v192, v193
  v_cvt_pk_bf16_f32 v9, v194, v195
  v_cvt_pk_bf16_f32 v10, v196, v197
  v_cvt_pk_bf16_f32 v11, v198, v199
  v_cvt_pk_bf16_f32 v12, v200, v201
  v_cvt_pk_bf16_f32 v13, v202, v203
  v_cvt_pk_bf16_f32 v14, v204, v205
  v_cvt_pk_bf16_f32 v15, v206, v207
  buffer_store_dwordx2 v[8:9], v2, s[36:39], s56 offen offset:0 sc1
  buffer_store_dwordx2 v[10:11], v2, s[36:39], s56 offen offset:512 sc1
  buffer_store_dwordx2 v[12:13], v2, s[36:39], s57 offen offset:0 sc1
  buffer_store_dwordx2 v[14:15], v2, s[36:39], s57 offen offset:512 sc1
  v_dot2_f32_bf16 v32, v8, s52, 0
  v_dot2_f32_bf16 v33, v8, v8, 0
  v_dot2_f32_bf16 v34, v12, s52, 0
  v_dot2_f32_bf16 v35, v12, v12, 0
  v_dot2_f32_bf16 v32, v9, s52, v32
  v_dot2_f32_bf16 v33, v9, v9, v33
  v_dot2_f32_bf16 v34, v13, s52, v34
  v_dot2_f32_bf16 v35, v13, v13, v35
  v_dot2_f32_bf16 v32, v10, s52, v32
  v_dot2_f32_bf16 v33, v10, v10, v33
  v_dot2_f32_bf16 v34, v14, s52, v34
  v_dot2_f32_bf16 v35, v14, v14, v35
  v_dot2_f32_bf16 v32, v11, s52, v32
  v_dot2_f32_bf16 v33, v11, v11, v33
  v_dot2_f32_bf16 v34, v15, s52, v34
  v_dot2_f32_bf16 v35, v15, v15, v35
  s_nop 0
  v_permlane32_swap_b32 v32, v33
  s_nop 0
  v_permlane32_swap_b32 v34, v35
  v_add_f32 v32, v32, v33
  v_add_f32 v34, v34, v35
  s_nop 1
  v_permlane16_swap_b32 v32, v34
  v_add_f32 v32, v32, v34
  v_mov_b32 v33, v32
  v_mov_b32 v34, v4
  v_mov_b32 v35, v5
  v_permlane32_swap_b32 v32, v33
  s_lshl_b32 s60, s54, 14
  s_add_u32 s60, s60, 18153472
  s_lshl_b32 s61, s46, 13
  s_add_u32 s60, s60, s61
  s_lshl_b32 s61, s42, 1
  s_add_u32 s61, s61, s47
  s_lshl_b32 s61, s61, 9
  s_add_u32 s60, s60, s61
  s_mov_b32 exec_hi, 0
  buffer_store_dwordx4 v[32:35], v1, s[36:39], s60 offen sc1
  s_mov_b32 exec_hi, -1
  s_lshl_b32 s56, s54, 8
  s_add_u32 s56, s56, 28672
  s_lshl_b32 s63, s42, 3
  s_add_u32 s56, s56, s63
  s_waitcnt vmcnt(0)
  s_barrier
  s_cmp_lg_u32 s44, 0
  s_cbranch_scc1 L_noflag_13
  s_mov_b64 exec, 1
  buffer_store_dwordx2 v[4:5], off, s[36:39], s56 sc1
  s_mov_b64 exec, -1
L_noflag_13:
  v_mov_b32 v252, s52
  v_mov_b32 v253, s52
  v_mov_b32 v254, s52
  v_mov_b32 v255, s52
  s_lshl_b32 s60, s46, 15
  s_add_u32 s60, s60, 98304
  v_add_u32 v62, s60, v1
  s_lshr_b32 s56, s45, 4
  s_add_u32 s56, s56, s44
  s_mul_i32 s56, s56, 16384
  s_add_u32 s72, s56, 9437184
  s_mul_i32 s57, s44, 16384
  s_add_u32 s73, s57, 98304
  s_add_u32 s86, s76, 0
  s_and_b32 s86, s86, 7
  s_lshl_b32 s86, s86, 11
  s_add_u32 s86, s86, s72
  s_add_u32 s87, s76, 1
  s_and_b32 s87, s87, 7
  s_lshl_b32 s87, s87, 11
  s_add_u32 s87, s87, s72
  s_add_u32 s88, s76, 2
  s_and_b32 s88, s88, 7
  s_lshl_b32 s88, s88, 11
  s_add_u32 s88, s88, s72
  s_add_u32 s89, s76, 3
  s_and_b32 s89, s89, 7
  s_lshl_b32 s89, s89, 11
  s_add_u32 s89, s89, s72
  s_lshl_b32 s59, s54, 8
  s_add_u32 s59, s59, 28672
  ds_read_b64_tr_b16 v[28:29], v59 offset:0
  ds_read_b64_tr_b16 v[30:31], v59 offset:768
  ds_read_b64_tr_b16 v[32:33], v59 offset:64
  ds_read_b64_tr_b16 v[34:35], v59 offset:832
  ds_read_b64_tr_b16 v[36:37], v59 offset:128
  ds_read_b64_tr_b16 v[38:39], v59 offset:896
  ds_read_b64_tr_b16 v[40:41], v59 offset:6144
  ds_read_b64_tr_b16 v[42:43], v59 offset:6912
  ds_read_b64_tr_b16 v[44:45], v59 offset:6208
  ds_read_b64_tr_b16 v[46:47], v59 offset:6976
  ds_read_b64_tr_b16 v[48:49], v59 offset:6272
  ds_read_b64_tr_b16 v[50:51], v59 offset:7040
  s_waitcnt lgkmcnt(6)
  v_mfma_f32_16x16x32_bf16 v[240:243], v[28:31], v[252:255], 0
  ds_read_b64_tr_b16 v[16:17], v59 offset:12288
  ds_read_b64_tr_b16 v[18:19], v59 offset:13056
  ds_read_b64_tr_b16 v[20:21], v59 offset:12352
  v_mfma_f32_16x16x32_bf16 v[244:247], v[32:35], v[252:255], 0
  ds_read_b64_tr_b16 v[22:23], v59 offset:13120
  ds_read_b64_tr_b16 v[24:25], v59 offset:12416
  ds_read_b64_tr_b16 v[26:27], v59 offset:13184
  v_mfma_f32_16x16x32_bf16 v[248:251], v[36:39], v[252:255], 0
  s_waitcnt lgkmcnt(6)
  v_mfma_f32_16x16x32_bf16 v[240:243], v[40:43], v[252:255], v[240:243]
  ds_read_b64_tr_b16 v[28:29], v59 offset:18432
  ds_read_b64_tr_b16 v[30:31], v59 offset:19200
  ds_read_b64_tr_b16 v[32:33], v59 offset:18496
  v_mfma_f32_16x16x32_bf16 v[244:247], v[44:47], v[252:255], v[244:247]
  ds_read_b64_tr_b16 v[34:35], v59 offset:19264
  ds_read_b64_tr_b16 v[36:37], v59 offset:18560
  ds_read_b64_tr_b16 v[38:39], v59 offset:19328
  v_mfma_f32_16x16x32_bf16 v[248:251], v[48:51], v[252:255], v[248:251]
  s_waitcnt lgkmcnt(6)
  v_mfma_f32_16x16x32_bf16 v[240:243], v[16:19], v[252:255], v[240:243]
  ds_read_b64_tr_b16 v[40:41], v59 offset:24576
  ds_read_b64_tr_b16 v[42:43], v59 offset:25344
  ds_read_b64_tr_b16 v[44:45], v59 offset:24640
  v_mfma_f32_16x16x32_bf16 v[244:247], v[20:23], v[252:255], v[244:247]
  ds_read_b64_tr_b16 v[46:47], v59 offset:25408
  ds_read_b64_tr_b16 v[48:49], v59 offset:24704
  ds_read_b64_tr_b16 v[50:51], v59 offset:25472
  v_mfma_f32_16x16x32_bf16 v[248:251], v[24:27], v[252:255], v[248:251]
  s_waitcnt lgkmcnt(6)
  v_mfma_f32_16x16x32_bf16 v[240:243], v[28:31], v[252:255], v[240:243]
  ds_read_b64_tr_b16 v[16:17], v59 offset:30720
  ds_read_b64_tr_b16 v[18:19], v59 offset:31488
  ds_read_b64_tr_b16 v[20:21], v59 offset:30784
  v_mfma_f32_16x16x32_bf16 v[244:247], v[32:35], v[252:255], v[244:247]
  ds_read_b64_tr_b16 v[22:23], v59 offset:31552
  ds_read_b64_tr_b16 v[24:25], v59 offset:30848
  ds_read_b64_tr_b16 v[26:27], v59 offset:31616
  v_mfma_f32_16x16x32_bf16 v[248:251], v[36:39], v[252:255], v[248:251]
  s_waitcnt lgkmcnt(6)
  v_mfma_f32_16x16x32_bf16 v[240:243], v[40:43], v[252:255], v[240:243]
  ds_read_b64_tr_b16 v[28:29], v59 offset:36864
  ds_read_b64_tr_b16 v[30:31], v59 offset:37632
  ds_read_b64_tr_b16 v[32:33], v59 offset:36928
  v_mfma_f32_16x16x32_bf16 v[244:247], v[44:47], v[252:255], v[244:247]
  ds_read_b64_tr_b16 v[34:35], v59 offset:37696
  ds_read_b64_tr_b16 v[36:37], v59 offset:36992
  ds_read_b64_tr_b16 v[38:39], v59 offset:37760
  v_mfma_f32_16x16x32_bf16 v[248:251], v[48:51], v[252:255], v[248:251]
  s_waitcnt lgkmcnt(6)
  v_mfma_f32_16x16x32_bf16 v[240:243], v[16:19], v[252:255], v[240:243]
  ds_read_b64_tr_b16 v[40:41], v59 offset:43008
  ds_read_b64_tr_b16 v[42:43], v59 offset:43776
  ds_read_b64_tr_b16 v[44:45], v59 offset:43072
  v_mfma_f32_16x16x32_bf16 v[244:247], v[20:23], v[252:255], v[244:247]
  ds_read_b64_tr_b16 v[46:47], v59 offset:43840
  ds_read_b64_tr_b16 v[48:49], v59 offset:43136
  ds_read_b64_tr_b16 v[50:51], v59 offset:43904
  v_mfma_f32_16x16x32_bf16 v[248:251], v[24:27], v[252:255], v[248:251]
  s_waitcnt lgkmcnt(6)
  v_mfma_f32_16x16x32_bf16 v[240:243], v[28:31], v[252:255], v[240:243]
  ds_read_b64_tr_b16 v[16:17], v60 offset:0
  ds_read_b64_tr_b16 v[18:19], v60 offset:768
  ds_read_b64_tr_b16 v[20:21], v60 offset:64
  v_mfma_f32_16x16x32_bf16 v[244:247], v[32:35], v[252:255], v[244:247]
  ds_read_b64_tr_b16 v[22:23], v60 offset:832
  ds_read_b64_tr_b16 v[24:25], v60 offset:128
  ds_read_b64_tr_b16 v[26:27], v60 offset:896
  v_mfma_f32_16x16x32_bf16 v[248:251], v[36:39], v[252:255], v[248:251]
  s_waitcnt lgkmcnt(6)
  v_mfma_f32_16x16x32_bf16 v[240:243], v[40:43], v[252:255], v[240:243]
  ds_read_b64_tr_b16 v[28:29], v60 offset:6144
  ds_read_b64_tr_b16 v[30:31], v60 offset:6912
  ds_read_b64_tr_b16 v[32:33], v60 offset:6208
  v_mfma_f32_16x16x32_bf16 v[244:247], v[44:47], v[252:255], v[244:247]
  ds_read_b64_tr_b16 v[34:35], v60 offset:6976
  ds_read_b64_tr_b16 v[36:37], v60 offset:6272
  ds_read_b64_tr_b16 v[38:39], v60 offset:7040
  v_mfma_f32_16x16x32_bf16 v[248:251], v[48:51], v[252:255], v[248:251]
  s_waitcnt lgkmcnt(6)
  v_mfma_f32_16x16x32_bf16 v[240:243], v[16:19], v[252:255], v[240:243]
  ds_read_b64_tr_b16 v[40:41], v60 offset:12288
  ds_read_b64_tr_b16 v[42:43], v60 offset:13056
  ds_read_b64_tr_b16 v[44:45], v60 offset:12352
  v_mfma_f32_16x16x32_bf16 v[244:247], v[20:23], v[252:255], v[244:247]
  ds_read_b64_tr_b16 v[46:47], v60 offset:13120
  ds_read_b64_tr_b16 v[48:49], v60 offset:12416
  ds_read_b64_tr_b16 v[50:51], v60 offset:13184
  v_mfma_f32_16x16x32_bf16 v[248:251], v[24:27], v[252:255], v[248:251]
  s_waitcnt lgkmcnt(6)
  v_mfma_f32_16x16x32_bf16 v[240:243], v[28:31], v[252:255], v[240:243]
  ds_read_b64_tr_b16 v[16:17], v60 offset:18432
  ds_read_b64_tr_b16 v[18:19], v60 offset:19200
  ds_read_b64_tr_b16 v[20:21], v60 offset:18496
  v_mfma_f32_16x16x32_bf16 v[244:247], v[32:35], v[252:255], v[244:247]
  ds_read_b64_tr_b16 v[22:23], v60 offset:19264
  ds_read_b64_tr_b16 v[24:25], v60 offset:18560
  ds_read_b64_tr_b16 v[26:27], v60 offset:19328
  v_mfma_f32_16x16x32_bf16 v[248:251], v[36:39], v[252:255], v[248:251]
  s_waitcnt lgkmcnt(6)
  v_mfma_f32_16x16x32_bf16 v[240:243], v[40:43], v[252:255], v[240:243]
  ds_read_b64_tr_b16 v[28:29], v60 offset:24576
  ds_read_b64_tr_b16 v[30:31], v60 offset:25344
  ds_read_b64_tr_b16 v[32:33], v60 offset:24640
  v_mfma_f32_16x16x32_bf16 v[244:247], v[44:47], v[252:255], v[244:247]
  ds_read_b64_tr_b16 v[34:35], v60 offset:25408
  ds_read_b64_tr_b16 v[36:37], v60 offset:24704
  ds_read_b64_tr_b16 v[38:39], v60 offset:25472
  v_mfma_f32_16x16x32_bf16 v[248:251], v[48:51], v[252:255], v[248:251]
  s_waitcnt lgkmcnt(6)
  v_mfma_f32_16x16x32_bf16 v[240:243], v[16:19], v[252:255], v[240:243]
  ds_read_b64_tr_b16 v[40:41], v60 offset:30720
  ds_read_b64_tr_b16 v[42:43], v60 offset:31488
  ds_read_b64_tr_b16 v[44:45], v60 offset:30784
  v_mfma_f32_16x16x32_bf16 v[244:247], v[20:23], v[252:255], v[244:247]
  ds_read_b64_tr_b16 v[46:47], v60 offset:31552
  ds_read_b64_tr_b16 v[48:49], v60 offset:30848
  ds_read_b64_tr_b16 v[50:51], v60 offset:31616
  v_mfma_f32_16x16x32_bf16 v[248:251], v[24:27], v[252:255], v[248:251]
  s_waitcnt lgkmcnt(6)
  v_mfma_f32_16x16x32_bf16 v[240:243], v[28:31], v[252:255], v[240:243]
  ds_read_b64_tr_b16 v[16:17], v60 offset:36864
  ds_read_b64_tr_b16 v[18:19], v60 offset:37632
  ds_read_b64_tr_b16 v[20:21], v60 offset:36928
  v_mfma_f32_16x16x32_bf16 v[244:247], v[32:35], v[252:255], v[244:247]
  ds_read_b64_tr_b16 v[22:23], v60 offset:37696
  ds_read_b64_tr_b16 v[24:25], v60 offset:36992
  ds_read_b64_tr_b16 v[26:27], v60 offset:37760
  v_mfma_f32_16x16x32_bf16 v[248:251], v[36:39], v[252:255], v[248:251]
  buffer_load_dwordx2 v[52:53], v7, s[36:39], s59 offen sc1
  s_waitcnt lgkmcnt(6)
  v_mfma_f32_16x16x32_bf16 v[240:243], v[40:43], v[252:255], v[240:243]
  ds_read_b64_tr_b16 v[28:29], v60 offset:43008
  ds_read_b64_tr_b16 v[30:31], v60 offset:43776
  ds_read_b64_tr_b16 v[32:33], v60 offset:43072
  v_mfma_f32_16x16x32_bf16 v[244:247], v[44:47], v[252:255], v[244:247]
  ds_read_b64_tr_b16 v[34:35], v60 offset:43840
  ds_read_b64_tr_b16 v[36:37], v60 offset:43136
  ds_read_b64_tr_b16 v[38:39], v60 offset:43904
  v_mfma_f32_16x16x32_bf16 v[248:251], v[48:51], v[252:255], v[248:251]
  s_waitcnt lgkmcnt(6)
  v_mfma_f32_16x16x32_bf16 v[240:243], v[16:19], v[252:255], v[240:243]
  v_mfma_f32_16x16x32_bf16 v[244:247], v[20:23], v[252:255], v[244:247]
  v_mfma_f32_16x16x32_bf16 v[248:251], v[24:27], v[252:255], v[248:251]
  s_waitcnt lgkmcnt(0)
  v_mfma_f32_16x16x32_bf16 v[240:243], v[28:31], v[252:255], v[240:243]
  v_mfma_f32_16x16x32_bf16 v[244:247], v[32:35], v[252:255], v[244:247]
  v_mfma_f32_16x16x32_bf16 v[248:251], v[36:39], v[252:255], v[248:251]
  s_cmp_lg_u32 s44, 0
  s_cbranch_scc1 L_late_14
  s_waitcnt vmcnt(0)
  v_cmp_ne_u64 vcc, s[50:51], v[52:53]
  s_nop 1
  s_cbranch_vccz L_late_14
  s_mov_b32 s55, 0x40000
L_poll_15:
  buffer_load_dwordx2 v[52:53], v7, s[36:39], s59 offen sc1
  s_waitcnt vmcnt(0)
  v_cmp_ne_u64 vcc, s[50:51], v[52:53]
  s_sub_u32 s55, s55, 1
  s_cbranch_scc1 L_polled_16
  s_cbranch_vccnz L_poll_15
L_polled_16:
L_late_14:
  s_barrier
  s_add_u32 m0, s73, 0
  s_nop 0
  buffer_load_dwordx4 v1, s[36:39], s86 offen offset:0 sc1 lds
  buffer_load_dwordx4 v1, s[36:39], s86 offen offset:1024 sc1 lds
  s_add_u32 m0, s73, 2048
  s_nop 0
  buffer_load_dwordx4 v1, s[36:39], s87 offen offset:0 sc1 lds
  buffer_load_dwordx4 v1, s[36:39], s87 offen offset:1024 sc1 lds
  s_add_u32 m0, s73, 4096
  s_nop 0
  buffer_load_dwordx4 v1, s[36:39], s88 offen offset:0 sc1 lds
  buffer_load_dwordx4 v1, s[36:39], s88 offen offset:1024 sc1 lds
  s_add_u32 m0, s73, 6144
  s_nop 0
  buffer_load_dwordx4 v1, s[36:39], s89 offen offset:0 sc1 lds
  buffer_load_dwordx4 v1, s[36:39], s89 offen offset:1024 sc1 lds
  s_waitcnt vmcnt(6)
  s_barrier
  ds_read_b64_tr_b16 v[28:29], v59 offset:0
  ds_read_b64_tr_b16 v[30:31], v59 offset:768
  ds_read_b128 v[64:67], v62 offset:0
  ds_read_b128 v[128:131], v62 offset:16384
  ds_read_b64_tr_b16 v[32:33], v59 offset:64
  ds_read_b64_tr_b16 v[34:35], v59 offset:832
  ds_read_b64_tr_b16 v[36:37], v59 offset:128
  ds_read_b64_tr_b16 v[38:39], v59 offset:896
  ds_read_b64_tr_b16 v[40:41], v59 offset:6144
  ds_read_b64_tr_b16 v[42:43], v59 offset:6912
  ds_read_b128 v[68:71], v62 offset:1024
  ds_read_b128 v[132:135], v62 offset:17408
  ds_read_b64_tr_b16 v[44:45], v59 offset:6208
  ds_read_b64_tr_b16 v[46:47], v59 offset:6976
  ds_read_b64_tr_b16 v[48:49], v59 offset:6272
  ds_read_b64_tr_b16 v[50:51], v59 offset:7040
  s_waitcnt lgkmcnt(8)
  s_waitcnt vmcnt(4)
  s_barrier
  v_mfma_f32_16x16x32_bf16 v[192:195], v[28:31], v[64:67], 0
  ds_read_b64_tr_b16 v[16:17], v59 offset:12288
  ds_read_b64_tr_b16 v[18:19], v59 offset:13056
  ds_read_b128 v[72:75], v62 offset:2048
  v_mfma_f32_16x16x32_bf16 v[204:207], v[28:31], v[128:131], 0
  ds_read_b128 v[136:139], v62 offset:18432
  ds_read_b64_tr_b16 v[20:21], v59 offset:12352
  ds_read_b64_tr_b16 v[22:23], v59 offset:13120
  v_mfma_f32_16x16x32_bf16 v[196:199], v[32:35], v[64:67], 0
  ds_read_b64_tr_b16 v[24:25], v59 offset:12416
  ds_read_b64_tr_b16 v[26:27], v59 offset:13184
  v_mfma_f32_16x16x32_bf16 v[208:211], v[32:35], v[128:131], 0
  v_mfma_f32_16x16x32_bf16 v[200:203], v[36:39], v[64:67], 0
  s_add_u32 s58, s76, 4
  s_and_b32 s58, s58, 7
  s_lshl_b32 s58, s58, 11
  s_add_u32 s58, s58, s72
  s_add_u32 m0, s73, 8192
  s_nop 0
  buffer_load_dwordx4 v1, s[36:39], s58 offen offset:0 sc1 lds
  v_mfma_f32_16x16x32_bf16 v[212:215], v[36:39], v[128:131], 0
  buffer_load_dwordx4 v1, s[36:39], s58 offen offset:1024 sc1 lds
  s_waitcnt lgkmcnt(8)
  v_mfma_f32_16x16x32_bf16 v[192:195], v[40:43], v[68:71], v[192:195]
  ds_read_b64_tr_b16 v[28:29], v59 offset:18432
  ds_read_b64_tr_b16 v[30:31], v59 offset:19200
  ds_read_b128 v[76:79], v62 offset:3072
  v_mfma_f32_16x16x32_bf16 v[204:207], v[40:43], v[132:135], v[204:207]
  ds_read_b128 v[140:143], v62 offset:19456
  ds_read_b64_tr_b16 v[32:33], v59 offset:18496
  ds_read_b64_tr_b16 v[34:35], v59 offset:19264
  v_mfma_f32_16x16x32_bf16 v[196:199], v[44:47], v[68:71], v[196:199]
  ds_read_b64_tr_b16 v[36:37], v59 offset:18560
  ds_read_b64_tr_b16 v[38:39], v59 offset:19328
  v_mfma_f32_16x16x32_bf16 v[208:211], v[44:47], v[132:135], v[208:211]
  v_mfma_f32_16x16x32_bf16 v[200:203], v[48:51], v[68:71], v[200:203]
  s_add_u32 s58, s76, 5
  s_and_b32 s58, s58, 7
  s_lshl_b32 s58, s58, 11
  s_add_u32 s58, s58, s72
  s_add_u32 m0, s73, 10240
  s_nop 0
  buffer_load_dwordx4 v1, s[36:39], s58 offen offset:0 sc1 lds
  v_mfma_f32_16x16x32_bf16 v[212:215], v[48:51], v[132:135], v[212:215]
  buffer_load_dwordx4 v1, s[36:39], s58 offen offset:1024 sc1 lds
  s_waitcnt lgkmcnt(8)
  s_waitcnt vmcnt(4)
  s_barrier
  v_mfma_f32_16x16x32_bf16 v[192:195], v[16:19], v[72:75], v[192:195]
  ds_read_b64_tr_b16 v[40:41], v59 offset:24576
  ds_read_b64_tr_b16 v[42:43], v59 offset:25344
  ds_read_b128 v[80:83], v62 offset:4096
  v_mfma_f32_16x16x32_bf16 v[204:207], v[16:19], v[136:139], v[204:207]
  ds_read_b128 v[144:147], v62 offset:20480
  ds_read_b64_tr_b16 v[44:45], v59 offset:24640
  ds_read_b64_tr_b16 v[46:47], v59 offset:25408
  v_mfma_f32_16x16x32_bf16 v[196:199], v[20:23], v[72:75], v[196:199]
  ds_read_b64_tr_b16 v[48:49], v59 offset:24704
  ds_read_b64_tr_b16 v[50:51], v59 offset:25472
  v_mfma_f32_16x16x32_bf16 v[208:211], v[20:23], v[136:139], v[208:211]
  v_mfma_f32_16x16x32_bf16 v[200:203], v[24:27], v[72:75], v[200:203]
  s_add_u32 s58, s76, 6
  s_and_b32 s58, s58, 7
  s_lshl_b32 s58, s58, 11
  s_add_u32 s58, s58, s72
  s_add_u32 m0, s73, 12288
  s_nop 0
  buffer_load_dwordx4 v1, s[36:39], s58 offen offset:0 sc1 lds
  v_mfma_f32_16x16x32_bf16 v[212:215], v[24:27], v[136:139], v[212:215]
  buffer_load_dwordx4 v1, s[36:39], s58 offen offset:1024 sc1 lds
  s_waitcnt lgkmcnt(8)
  v_mfma_f32_16x16x32_bf16 v[192:195], v[28:31], v[76:79], v[192:195]
  ds_read_b64_tr_b16 v[16:17], v59 offset:30720
  ds_read_b64_tr_b16 v[18:19], v59 offset:31488
  ds_read_b128 v[84:87], v62 offset:5120
  v_mfma_f32_16x16x32_bf16 v[204:207], v[28:31], v[140:143], v[204:207]
  ds_read_b128 v[148:151], v62 offset:21504
  ds_read_b64_tr_b16 v[20:21], v59 offset:30784
  ds_read_b64_tr_b16 v[22:23], v59 offset:31552
  v_mfma_f32_16x16x32_bf16 v[196:199], v[32:35], v[76:79], v[196:199]
  ds_read_b64_tr_b16 v[24:25], v59 offset:30848
  ds_read_b64_tr_b16 v[26:27], v59 offset:31616
  v_mfma_f32_16x16x32_bf16 v[208:211], v[32:35], v[140:143], v[208:211]
  v_mfma_f32_16x16x32_bf16 v[200:203], v[36:39], v[76:79], v[200:203]
  s_add_u32 s58, s76, 7
  s_and_b32 s58, s58, 7
  s_lshl_b32 s58, s58, 11
  s_add_u32 s58, s58, s72
  s_add_u32 m0, s73, 14336
  s_nop 0
  buffer_load_dwordx4 v1, s[36:39], s58 offen offset:0 sc1 lds
  v_mfma_f32_16x16x32_bf16 v[212:215], v[36:39], v[140:143], v[212:215]
  buffer_load_dwordx4 v1, s[36:39], s58 offen offset:1024 sc1 lds
  s_waitcnt lgkmcnt(8)
  v_mfma_f32_16x16x32_bf16 v[192:195], v[40:43], v[80:83], v[192:195]
  ds_read_b64_tr_b16 v[28:29], v59 offset:36864
  ds_read_b64_tr_b16 v[30:31], v59 offset:37632
  ds_read_b128 v[88:91], v62 offset:6144
  v_mfma_f32_16x16x32_bf16 v[204:207], v[40:43], v[144:147], v[204:207]
  ds_read_b128 v[152:155], v62 offset:22528
  ds_read_b64_tr_b16 v[32:33], v59 offset:36928
  ds_read_b64_tr_b16 v[34:35], v59 offset:37696
  v_mfma_f32_16x16x32_bf16 v[196:199], v[44:47], v[80:83], v[196:199]
  ds_read_b64_tr_b16 v[36:37], v59 offset:36992
  ds_read_b64_tr_b16 v[38:39], v59 offset:37760
  v_mfma_f32_16x16x32_bf16 v[208:211], v[44:47], v[144:147], v[208:211]
  v_mfma_f32_16x16x32_bf16 v[200:203], v[48:51], v[80:83], v[200:203]
  s_lshl_b32 s75, s54, 14
  s_add_u32 s75, s75, 18153472
  s_lshl_b32 s61, s46, 13
  s_add_u32 s75, s75, s61
  v_and_b32 v61, 31, v0
  v_lshlrev_b32 v61, 4, v61
  v_lshrrev_b32 v54, 5, v0
  v_lshl_add_u32 v61, v54, 12, v61
  buffer_load_dwordx4 v[216:219], v61, s[36:39], s75 offen offset:0 sc1
  v_mfma_f32_16x16x32_bf16 v[212:215], v[48:51], v[144:147], v[212:215]
  buffer_load_dwordx4 v[220:223], v61, s[36:39], s75 offen offset:512 sc1
  s_waitcnt lgkmcnt(8)
  v_mfma_f32_16x16x32_bf16 v[192:195], v[16:19], v[84:87], v[192:195]
  ds_read_b64_tr_b16 v[40:41], v59 offset:43008
  ds_read_b64_tr_b16 v[42:43], v59 offset:43776
  ds_read_b128 v[92:95], v62 offset:7168
  v_mfma_f32_16x16x32_bf16 v[204:207], v[16:19], v[148:151], v[204:207]
  ds_read_b128 v[156:159], v62 offset:23552
  ds_read_b64_tr_b16 v[44:45], v59 offset:43072
  ds_read_b64_tr_b16 v[46:47], v59 offset:43840
  v_mfma_f32_16x16x32_bf16 v[196:199], v[20:23], v[84:87], v[196:199]
  ds_read_b64_tr_b16 v[48:49], v59 offset:43136
  ds_read_b64_tr_b16 v[50:51], v59 offset:43904
  v_mfma_f32_16x16x32_bf16 v[208:211], v[20:23], v[148:151], v[208:211]
  v_mfma_f32_16x16x32_bf16 v[200:203], v[24:27], v[84:87], v[200:203]
  buffer_load_dwordx4 v[224:227], v61, s[36:39], s75 offen offset:1024 sc1
  v_mfma_f32_16x16x32_bf16 v[212:215], v[24:27], v[148:151], v[212:215]
  buffer_load_dwordx4 v[228:231], v61, s[36:39], s75 offen offset:1536 sc1
  s_waitcnt lgkmcnt(8)
  s_waitcnt vmcnt(8)
  s_barrier
  v_mfma_f32_16x16x32_bf16 v[192:195], v[28:31], v[88:91], v[192:195]
  ds_read_b64_tr_b16 v[16:17], v60 offset:0
  ds_read_b64_tr_b16 v[18:19], v60 offset:768
  ds_read_b128 v[96:99], v62 offset:8192
  v_mfma_f32_16x16x32_bf16 v[204:207], v[28:31], v[152:155], v[204:207]
  ds_read_b128 v[160:163], v62 offset:24576
  ds_read_b64_tr_b16 v[20:21], v60 offset:64
  ds_read_b64_tr_b16 v[22:23], v60 offset:832
  v_mfma_f32_16x16x32_bf16 v[196:199], v[32:35], v[88:91], v[196:199]
  ds_read_b64_tr_b16 v[24:25], v60 offset:128
  ds_read_b64_tr_b16 v[26:27], v60 offset:896
  v_mfma_f32_16x16x32_bf16 v[208:211], v[32:35], v[152:155], v[208:211]
  v_mfma_f32_16x16x32_bf16 v[200:203], v[36:39], v[88:91], v[200:203]
  buffer_load_dwordx4 v[232:235], v61, s[36:39], s75 offen offset:2048 sc1
  v_mfma_f32_16x16x32_bf16 v[212:215], v[36:39], v[152:155], v[212:215]
  buffer_load_dwordx4 v[236:239], v61, s[36:39], s75 offen offset:2560 sc1
  s_waitcnt lgkmcnt(8)
  v_mfma_f32_16x16x32_bf16 v[192:195], v[40:43], v[92:95], v[192:195]
  ds_read_b64_tr_b16 v[28:29], v60 offset:6144
  ds_read_b64_tr_b16 v[30:31], v60 offset:6912
  ds_read_b128 v[100:103], v62 offset:9216
  v_mfma_f32_16x16x32_bf16 v[204:207], v[40:43], v[156:159], v[204:207]
  ds_read_b128 v[164:167], v62 offset:25600
  ds_read_b64_tr_b16 v[32:33], v60 offset:6208
  ds_read_b64_tr_b16 v[34:35], v60 offset:6976
  v_mfma_f32_16x16x32_bf16 v[196:199], v[44:47], v[92:95], v[196:199]
  ds_read_b64_tr_b16 v[36:37], v60 offset:6272
  ds_read_b64_tr_b16 v[38:39], v60 offset:7040
  v_mfma_f32_16x16x32_bf16 v[208:211], v[44:47], v[156:159], v[208:211]
  v_mfma_f32_16x16x32_bf16 v[200:203], v[48:51], v[92:95], v[200:203]
  buffer_load_dwordx4 v[52:55], v61, s[36:39], s75 offen offset:3072 sc1
  v_mfma_f32_16x16x32_bf16 v[212:215], v[48:51], v[156:159], v[212:215]
  buffer_load_dwordx4 v[252:255], v61, s[36:39], s75 offen offset:3584 sc1
  s_waitcnt lgkmcnt(8)
  v_mfma_f32_16x16x32_bf16 v[192:195], v[16:19], v[96:99], v[192:195]
  ds_read_b64_tr_b16 v[40:41], v60 offset:12288
  ds_read_b64_tr_b16 v[42:43], v60 offset:13056
  ds_read_b128 v[104:107], v62 offset:10240
  v_mfma_f32_16x16x32_bf16 v[204:207], v[16:19], v[160:163], v[204:207]
  ds_read_b128 v[168:171], v62 offset:26624
  ds_read_b64_tr_b16 v[44:45], v60 offset:12352
  ds_read_b64_tr_b16 v[46:47], v60 offset:13120
  v_mfma_f32_16x16x32_bf16 v[196:199], v[20:23], v[96:99], v[196:199]
  ds_read_b64_tr_b16 v[48:49], v60 offset:12416
  ds_read_b64_tr_b16 v[50:51], v60 offset:13184
  v_mfma_f32_16x16x32_bf16 v[208:211], v[20:23], v[160:163], v[208:211]
  v_mfma_f32_16x16x32_bf16 v[200:203], v[24:27], v[96:99], v[200:203]
  v_mfma_f32_16x16x32_bf16 v[212:215], v[24:27], v[160:163], v[212:215]
  s_lshl_b32 s77, s48, 5
  s_mul_i32 s78, s44, 3
  s_lshl_b32 s74, s76, 2
  s_add_u32 s74, s74, s78
  s_mul_i32 s78, s78, 3072
  s_add_u32 s79, s74, 0
  s_and_b32 s79, s79, 31
  s_mul_i32 s79, s79, 44032
  s_add_u32 s79, s79, s77
  s_add_u32 m0, s78, 0
  s_nop 0
  buffer_load_dwordx4 v56, s[16:19], s79 offen offset:0 lds
  s_waitcnt lgkmcnt(8)
  v_mfma_f32_16x16x32_bf16 v[192:195], v[28:31], v[100:103], v[192:195]
  ds_read_b64_tr_b16 v[16:17], v60 offset:18432
  ds_read_b64_tr_b16 v[18:19], v60 offset:19200
  ds_read_b128 v[108:111], v62 offset:11264
  v_mfma_f32_16x16x32_bf16 v[204:207], v[28:31], v[164:167], v[204:207]
  ds_read_b128 v[172:175], v62 offset:27648
  ds_read_b64_tr_b16 v[20:21], v60 offset:18496
  ds_read_b64_tr_b16 v[22:23], v60 offset:19264
  v_mfma_f32_16x16x32_bf16 v[196:199], v[32:35], v[100:103], v[196:199]
  ds_read_b64_tr_b16 v[24:25], v60 offset:18560
  ds_read_b64_tr_b16 v[26:27], v60 offset:19328
  v_mfma_f32_16x16x32_bf16 v[208:211], v[32:35], v[164:167], v[208:211]
  v_mfma_f32_16x16x32_bf16 v[200:203], v[36:39], v[100:103], v[200:203]
  v_mfma_f32_16x16x32_bf16 v[212:215], v[36:39], v[164:167], v[212:215]
  buffer_load_dwordx4 v57, s[16:19], s79 offen offset:1024 lds
  s_waitcnt lgkmcnt(8)
  s_waitcnt vmcnt(10)
  s_barrier
  v_mfma_f32_16x16x32_bf16 v[192:195], v[40:43], v[104:107], v[192:195]
  ds_read_b64_tr_b16 v[28:29], v60 offset:24576
  ds_read_b64_tr_b16 v[30:31], v60 offset:25344
  ds_read_b128 v[112:115], v62 offset:12288
  v_mfma_f32_16x16x32_bf16 v[204:207], v[40:43], v[168:171], v[204:207]
  ds_read_b128 v[176:179], v62 offset:28672
  ds_read_b64_tr_b16 v[32:33], v60 offset:24640
  ds_read_b64_tr_b16 v[34:35], v60 offset:25408
  v_mfma_f32_16x16x32_bf16 v[196:199], v[44:47], v[104:107], v[196:199]
  ds_read_b64_tr_b16 v[36:37], v60 offset:24704
  ds_read_b64_tr_b16 v[38:39], v60 offset:25472
  v_mfma_f32_16x16x32_bf16 v[208:211], v[44:47], v[168:171], v[208:211]
  v_mfma_f32_16x16x32_bf16 v[200:203], v[48:51], v[104:107], v[200:203]
  v_mfma_f32_16x16x32_bf16 v[212:215], v[48:51], v[168:171], v[212:215]
  buffer_load_dwordx4 v58, s[16:19], s79 offen offset:2048 lds
  s_waitcnt lgkmcnt(8)
  v_mfma_f32_16x16x32_bf16 v[192:195], v[16:19], v[108:111], v[192:195]
  ds_read_b64_tr_b16 v[40:41], v60 offset:30720
  ds_read_b64_tr_b16 v[42:43], v60 offset:31488
  ds_read_b128 v[116:119], v62 offset:13312
  v_mfma_f32_16x16x32_bf16 v[204:207], v[16:19], v[172:175], v[204:207]
  ds_read_b128 v[180:183], v62 offset:29696
  ds_read_b64_tr_b16 v[44:45], v60 offset:30784
  ds_read_b64_tr_b16 v[46:47], v60 offset:31552
  v_mfma_f32_16x16x32_bf16 v[196:199], v[20:23], v[108:111], v[196:199]
  ds_read_b64_tr_b16 v[48:49], v60 offset:30848
  ds_read_b64_tr_b16 v[50:51], v60 offset:31616
  v_mfma_f32_16x16x32_bf16 v[208:211], v[20:23], v[172:175], v[208:211]
  v_mfma_f32_16x16x32_bf16 v[200:203], v[24:27], v[108:111], v[200:203]
  v_mfma_f32_16x16x32_bf16 v[212:215], v[24:27], v[172:175], v[212:215]
  s_add_u32 s79, s74, 1
  s_and_b32 s79, s79, 31
  s_mul_i32 s79, s79, 44032
  s_add_u32 s79, s79, s77
  s_add_u32 m0, s78, 3072
  s_nop 0
  buffer_load_dwordx4 v56, s[16:19], s79 offen offset:0 lds
  s_waitcnt lgkmcnt(8)
  v_mfma_f32_16x16x32_bf16 v[192:195], v[28:31], v[112:115], v[192:195]
  ds_read_b64_tr_b16 v[16:17], v60 offset:36864
  ds_read_b64_tr_b16 v[18:19], v60 offset:37632
  ds_read_b128 v[120:123], v62 offset:14336
  v_mfma_f32_16x16x32_bf16 v[204:207], v[28:31], v[176:179], v[204:207]
  ds_read_b128 v[184:187], v62 offset:30720
  ds_read_b64_tr_b16 v[20:21], v60 offset:36928
  ds_read_b64_tr_b16 v[22:23], v60 offset:37696
  v_mfma_f32_16x16x32_bf16 v[196:199], v[32:35], v[112:115], v[196:199]
  ds_read_b64_tr_b16 v[24:25], v60 offset:36992
  ds_read_b64_tr_b16 v[26:27], v60 offset:37760
  v_mfma_f32_16x16x32_bf16 v[208:211], v[32:35], v[176:179], v[208:211]
  s_waitcnt vmcnt(4)
  v_add_f32 v216, v216, v232
  v_add_f32 v217, v217, v233
  v_mfma_f32_16x16x32_bf16 v[200:203], v[36:39], v[112:115], v[200:203]
  v_add_f32 v220, v220, v236
  v_add_f32 v221, v221, v237
  v_add_f32 v224, v224, v52
  v_add_f32 v225, v225, v53
  v_add_f32 v228, v228, v252
  v_add_f32 v229, v229, v253
  v_mfma_f32_16x16x32_bf16 v[212:215], v[36:39], v[176:179], v[212:215]
  buffer_load_dwordx4 v57, s[16:19], s79 offen offset:1024 lds
  s_waitcnt lgkmcnt(8)
  v_mfma_f32_16x16x32_bf16 v[192:195], v[40:43], v[116:119], v[192:195]
  ds_read_b64_tr_b16 v[28:29], v60 offset:43008
  ds_read_b64_tr_b16 v[30:31], v60 offset:43776
  ds_read_b128 v[124:127], v62 offset:15360
  v_mfma_f32_16x16x32_bf16 v[204:207], v[40:43], v[180:183], v[204:207]
  ds_read_b128 v[188:191], v62 offset:31744
  ds_read_b64_tr_b16 v[32:33], v60 offset:43072
  ds_read_b64_tr_b16 v[34:35], v60 offset:43840
  v_mfma_f32_16x16x32_bf16 v[196:199], v[44:47], v[116:119], v[196:199]
  ds_read_b64_tr_b16 v[36:37], v60 offset:43136
  ds_read_b64_tr_b16 v[38:39], v60 offset:43904
  v_mfma_f32_16x16x32_bf16 v[208:211], v[44:47], v[180:183], v[208:211]
  v_add_f32 v216, v216, v224
  v_add_f32 v217, v217, v225
  v_add_f32 v220, v220, v228
  v_mfma_f32_16x16x32_bf16 v[200:203], v[48:51], v[116:119], v[200:203]
  v_add_f32 v221, v221, v229
  v_add_f32 v216, v216, v220
  v_add_f32 v217, v217, v221
  v_mov_b32 v220, v216
  v_mov_b32 v221, v217
  v_mfma_f32_16x16x32_bf16 v[212:215], v[48:51], v[180:183], v[212:215]
  buffer_load_dwordx4 v58, s[16:19], s79 offen offset:2048 lds
  s_waitcnt lgkmcnt(8)
  v_mfma_f32_16x16x32_bf16 v[192:195], v[16:19], v[120:123], v[192:195]
  v_permlane32_swap_b32 v216, v220
  v_permlane32_swap_b32 v217, v221
  v_add_f32 v220, v216, v220
  v_mfma_f32_16x16x32_bf16 v[204:207], v[16:19], v[184:187], v[204:207]
  v_add_f32 v221, v217, v221
  v_mul_f32 v220, 0x3b000000, v220
  v_mul_f32 v221, 0x3b000000, v221
  v_mfma_f32_16x16x32_bf16 v[196:199], v[20:23], v[120:123], v[196:199]
  v_fma_f32 v221, -v220, v220, v221
  v_max_f32 v221, 0, v221
  v_mfma_f32_16x16x32_bf16 v[208:211], v[20:23], v[184:187], v[208:211]
  v_mfma_f32_16x16x32_bf16 v[200:203], v[24:27], v[120:123], v[200:203]
  v_mfma_f32_16x16x32_bf16 v[212:215], v[24:27], v[184:187], v[212:215]
  s_add_u32 s79, s74, 2
  s_and_b32 s79, s79, 31
  s_mul_i32 s79, s79, 44032
  s_add_u32 s79, s79, s77
  s_add_u32 m0, s78, 6144
  s_nop 0
  buffer_load_dwordx4 v56, s[16:19], s79 offen offset:0 lds
  s_waitcnt lgkmcnt(0)
  v_mfma_f32_16x16x32_bf16 v[192:195], v[28:31], v[124:127], v[192:195]
  v_add_f32 v221, 0x3727c5ac, v221
  v_rsq_f32 v216, v221
  s_nop 0
  v_mul_f32_e64 v217, -v220, v216
  v_mfma_f32_16x16x32_bf16 v[204:207], v[28:31], v[188:191], v[204:207]
  v_mov_b32 v218, v216
  v_mov_b32 v219, v217
  s_nop 0
  v_permlane16_swap_b32 v216, v218
  v_mfma_f32_16x16x32_bf16 v[196:199], v[32:35], v[124:127], v[196:199]
  v_permlane16_swap_b32 v217, v219
  v_mfma_f32_16x16x32_bf16 v[208:211], v[32:35], v[188:191], v[208:211]
  v_mfma_f32_16x16x32_bf16 v[200:203], v[36:39], v[124:127], v[200:203]
  buffer_load_dwordx4 v57, s[16:19], s79 offen offset:1024 lds
  v_mfma_f32_16x16x32_bf16 v[212:215], v[36:39], v[188:191], v[212:215]
  buffer_load_dwordx4 v58, s[16:19], s79 offen offset:2048 lds
  s_barrier
  s_lshl_b32 s77, s48, 5
  s_mul_i32 s78, s44, 3
  s_lshl_b32 s74, s76, 2
  s_add_u32 s74, s74, s78
  s_mul_i32 s78, s78, 3072
  s_add_u32 s79, s74, 12
  s_and_b32 s79, s79, 31
  s_mul_i32 s79, s79, 44032
  s_add_u32 s79, s79, s77
  s_add_u32 m0, s78, 36864
  s_nop 0
  buffer_load_dwordx4 v56, s[16:19], s79 offen offset:0 lds
  buffer_load_dwordx4 v57, s[16:19], s79 offen offset:1024 lds
  buffer_load_dwordx4 v58, s[16:19], s79 offen offset:2048 lds
  s_add_u32 s79, s74, 13
  s_and_b32 s79, s79, 31
  s_mul_i32 s79, s79, 44032
  s_add_u32 s79, s79, s77
  s_add_u32 m0, s78, 39936
  s_nop 0
  buffer_load_dwordx4 v56, s[16:19], s79 offen offset:0 lds
  buffer_load_dwordx4 v57, s[16:19], s79 offen offset:1024 lds
  buffer_load_dwordx4 v58, s[16:19], s79 offen offset:2048 lds
  s_add_u32 s79, s74, 14
  s_and_b32 s79, s79, 31
  s_mul_i32 s79, s79, 44032
  s_add_u32 s79, s79, s77
  s_add_u32 m0, s78, 43008
  s_nop 0
  buffer_load_dwordx4 v56, s[16:19], s79 offen offset:0 lds
  buffer_load_dwordx4 v57, s[16:19], s79 offen offset:1024 lds
  buffer_load_dwordx4 v58, s[16:19], s79 offen offset:2048 lds
  v_mov_b32 v34, v216
  v_mov_b32 v35, v217
  v_mov_b32 v36, v218
  v_mov_b32 v37, v219
  v_mov_b32 v252, s52
  v_mov_b32 v253, s52
  v_mov_b32 v254, s52
  v_mov_b32 v255, s52
  v_mov_b32 v32, 1.0
  v_mov_b32 v33, 1.0
  s_mov_b32 s60, 0xbdd2d3e8
  s_mov_b32 s61, 0xbdd2d3e8
  v_mov_b32 v52, 0xc0135761
  v_mov_b32 v53, 0xc0135761
  v_pk_mul_f32 v[40:41], v[240:241], v[34:35] op_sel:[0,1] op_sel_hi:[1,1]
  v_pk_mul_f32 v[42:43], v[242:243], v[34:35] op_sel:[0,1] op_sel_hi:[1,1]
  v_pk_mul_f32 v[44:45], v[240:241], v[36:37] op_sel:[0,1] op_sel_hi:[1,1]
  v_pk_mul_f32 v[46:47], v[242:243], v[36:37] op_sel:[0,1] op_sel_hi:[1,1]
  v_pk_fma_f32 v[192:193], v[192:193], v[34:35], v[40:41] op_sel:[0,0,0] op_sel_hi:[1,0,1]
  v_pk_fma_f32 v[194:195], v[194:195], v[34:35], v[42:43] op_sel:[0,0,0] op_sel_hi:[1,0,1]
  v_pk_fma_f32 v[204:205], v[204:205], v[36:37], v[44:45] op_sel:[0,0,0] op_sel_hi:[1,0,1]
  v_pk_fma_f32 v[206:207], v[206:207], v[36:37], v[46:47] op_sel:[0,0,0] op_sel_hi:[1,0,1]
  v_pk_mul_f32 v[40:41], v[192:193], v[192:193]
  v_pk_mul_f32 v[42:43], v[194:195], v[194:195]
  v_pk_mul_f32 v[44:45], v[204:205], v[204:205]
  v_pk_mul_f32 v[46:47], v[206:207], v[206:207]
  v_pk_fma_f32 v[40:41], v[40:41], s[60:61], v[52:53]
  v_pk_fma_f32 v[42:43], v[42:43], s[60:61], v[52:53]
  v_pk_fma_f32 v[44:45], v[44:45], s[60:61], v[52:53]
  v_pk_fma_f32 v[46:47], v[46:47], s[60:61], v[52:53]
  v_pk_mul_f32 v[40:41], v[40:41], v[192:193]
  v_pk_mul_f32 v[42:43], v[42:43], v[194:195]
  v_pk_mul_f32 v[44:45], v[44:45], v[204:205]
  v_pk_mul_f32 v[46:47], v[46:47], v[206:207]
  v_exp_f32 v40, v40
  v_exp_f32 v41, v41
  v_exp_f32 v42, v42
  v_exp_f32 v43, v43
  v_exp_f32 v44, v44
  v_exp_f32 v45, v45
  v_exp_f32 v46, v46
  v_exp_f32 v47, v47
  v_pk_add_f32 v[40:41], v[40:41], v[32:33]
  v_pk_add_f32 v[42:43], v[42:43], v[32:33]
  v_pk_add_f32 v[44:45], v[44:45], v[32:33]
  v_pk_add_f32 v[46:47], v[46:47], v[32:33]
  v_rcp_f32 v40, v40
  v_rcp_f32 v41, v41
  v_rcp_f32 v42, v42
  v_rcp_f32 v43, v43
  v_rcp_f32 v44, v44
  v_rcp_f32 v45, v45
  v_rcp_f32 v46, v46
  v_rcp_f32 v47, v47
  v_pk_mul_f32 v[192:193], v[192:193], v[40:41]
  v_pk_mul_f32 v[194:195], v[194:195], v[42:43]
  v_pk_mul_f32 v[204:205], v[204:205], v[44:45]
  v_pk_mul_f32 v[206:207], v[206:207], v[46:47]
  v_pk_mul_f32 v[40:41], v[244:245], v[34:35] op_sel:[0,1] op_sel_hi:[1,1]
  v_pk_mul_f32 v[42:43], v[246:247], v[34:35] op_sel:[0,1] op_sel_hi:[1,1]
  v_pk_mul_f32 v[44:45], v[244:245], v[36:37] op_sel:[0,1] op_sel_hi:[1,1]
  v_pk_mul_f32 v[46:47], v[246:247], v[36:37] op_sel:[0,1] op_sel_hi:[1,1]
  v_pk_fma_f32 v[196:197], v[196:197], v[34:35], v[40:41] op_sel:[0,0,0] op_sel_hi:[1,0,1]
  v_pk_fma_f32 v[198:199], v[198:199], v[34:35], v[42:43] op_sel:[0,0,0] op_sel_hi:[1,0,1]
  v_pk_fma_f32 v[208:209], v[208:209], v[36:37], v[44:45] op_sel:[0,0,0] op_sel_hi:[1,0,1]
  v_pk_fma_f32 v[210:211], v[210:211], v[36:37], v[46:47] op_sel:[0,0,0] op_sel_hi:[1,0,1]
  v_pk_mul_f32 v[40:41], v[196:197], v[196:197]
  v_pk_mul_f32 v[42:43], v[198:199], v[198:199]
  v_pk_mul_f32 v[44:45], v[208:209], v[208:209]
  v_pk_mul_f32 v[46:47], v[210:211], v[210:211]
  v_pk_fma_f32 v[40:41], v[40:41], s[60:61], v[52:53]
  v_pk_fma_f32 v[42:43], v[42:43], s[60:61], v[52:53]
  v_pk_fma_f32 v[44:45], v[44:45], s[60:61], v[52:53]
  v_pk_fma_f32 v[46:47], v[46:47], s[60:61], v[52:53]
  v_pk_mul_f32 v[40:41], v[40:41], v[196:197]
  v_pk_mul_f32 v[42:43], v[42:43], v[198:199]
  v_pk_mul_f32 v[44:45], v[44:45], v[208:209]
  v_pk_mul_f32 v[46:47], v[46:47], v[210:211]
  v_exp_f32 v40, v40
  v_exp_f32 v41, v41
  v_exp_f32 v42, v42
  v_exp_f32 v43, v43
  v_exp_f32 v44, v44
  v_exp_f32 v45, v45
  v_exp_f32 v46, v46
  v_exp_f32 v47, v47
  v_pk_add_f32 v[40:41], v[40:41], v[32:33]
  v_pk_add_f32 v[42:43], v[42:43], v[32:33]
  v_pk_add_f32 v[44:45], v[44:45], v[32:33]
  v_pk_add_f32 v[46:47], v[46:47], v[32:33]
  v_rcp_f32 v40, v40
  v_rcp_f32 v41, v41
  v_rcp_f32 v42, v42
  v_rcp_f32 v43, v43
  v_rcp_f32 v44, v44
  v_rcp_f32 v45, v45
  v_rcp_f32 v46, v46
  v_rcp_f32 v47, v47
  v_pk_mul_f32 v[196:197], v[196:197], v[40:41]
  v_pk_mul_f32 v[198:199], v[198:199], v[42:43]
  v_pk_mul_f32 v[208:209], v[208:209], v[44:45]
  v_pk_mul_f32 v[210:211], v[210:211], v[46:47]
  v_pk_mul_f32 v[40:41], v[248:249], v[34:35] op_sel:[0,1] op_sel_hi:[1,1]
  v_pk_mul_f32 v[42:43], v[250:251], v[34:35] op_sel:[0,1] op_sel_hi:[1,1]
  v_pk_mul_f32 v[44:45], v[248:249], v[36:37] op_sel:[0,1] op_sel_hi:[1,1]
  v_pk_mul_f32 v[46:47], v[250:251], v[36:37] op_sel:[0,1] op_sel_hi:[1,1]
  v_pk_fma_f32 v[200:201], v[200:201], v[34:35], v[40:41] op_sel:[0,0,0] op_sel_hi:[1,0,1]
  v_pk_fma_f32 v[202:203], v[202:203], v[34:35], v[42:43] op_sel:[0,0,0] op_sel_hi:[1,0,1]
  v_pk_fma_f32 v[212:213], v[212:213], v[36:37], v[44:45] op_sel:[0,0,0] op_sel_hi:[1,0,1]
  v_pk_fma_f32 v[214:215], v[214:215], v[36:37], v[46:47] op_sel:[0,0,0] op_sel_hi:[1,0,1]
  v_pk_mul_f32 v[40:41], v[200:201], v[200:201]
  v_pk_mul_f32 v[42:43], v[202:203], v[202:203]
  v_pk_mul_f32 v[44:45], v[212:213], v[212:213]
  v_pk_mul_f32 v[46:47], v[214:215], v[214:215]
  v_pk_fma_f32 v[40:41], v[40:41], s[60:61], v[52:53]
  v_pk_fma_f32 v[42:43], v[42:43], s[60:61], v[52:53]
  v_pk_fma_f32 v[44:45], v[44:45], s[60:61], v[52:53]
  v_pk_fma_f32 v[46:47], v[46:47], s[60:61], v[52:53]
  v_pk_mul_f32 v[40:41], v[40:41], v[200:201]
  v_pk_mul_f32 v[42:43], v[42:43], v[202:203]
  v_pk_mul_f32 v[44:45], v[44:45], v[212:213]
  v_pk_mul_f32 v[46:47], v[46:47], v[214:215]
  v_exp_f32 v40, v40
  v_exp_f32 v41, v41
  v_exp_f32 v42, v42
  v_exp_f32 v43, v43
  v_exp_f32 v44, v44
  v_exp_f32 v45, v45
  v_exp_f32 v46, v46
  v_exp_f32 v47, v47
  v_pk_add_f32 v[40:41], v[40:41], v[32:33]
  v_pk_add_f32 v[42:43], v[42:43], v[32:33]
  v_pk_add_f32 v[44:45], v[44:45], v[32:33]
  v_pk_add_f32 v[46:47], v[46:47], v[32:33]
  v_rcp_f32 v40, v40
  v_rcp_f32 v41, v41
  v_rcp_f32 v42, v42
  v_rcp_f32 v43, v43
  v_rcp_f32 v44, v44
  v_rcp_f32 v45, v45
  v_rcp_f32 v46, v46
  v_rcp_f32 v47, v47
  v_pk_mul_f32 v[200:201], v[200:201], v[40:41]
  v_pk_mul_f32 v[202:203], v[202:203], v[42:43]
  v_pk_mul_f32 v[212:213], v[212:213], v[44:45]
  v_pk_mul_f32 v[214:215], v[214:215], v[46:47]
  v_pk_add_f32 v[40:41], v[192:193], v[194:195]
  v_pk_mul_f32 v[42:43], v[192:193], v[192:193]
  v_pk_fma_f32 v[42:43], v[194:195], v[194:195], v[42:43]
  v_pk_add_f32 v[40:41], v[40:41], v[196:197]
  v_pk_fma_f32 v[42:43], v[196:197], v[196:197], v[42:43]
  v_pk_add_f32 v[40:41], v[40:41], v[198:199]
  v_pk_fma_f32 v[42:43], v[198:199], v[198:199], v[42:43]
  v_pk_add_f32 v[44:45], v[204:205], v[206:207]
  v_pk_mul_f32 v[46:47], v[204:205], v[204:205]
  v_pk_fma_f32 v[46:47], v[206:207], v[206:207], v[46:47]
  v_pk_add_f32 v[44:45], v[44:45], v[208:209]
  v_pk_fma_f32 v[46:47], v[208:209], v[208:209], v[46:47]
  v_pk_add_f32 v[44:45], v[44:45], v[210:211]
  v_pk_fma_f32 v[46:47], v[210:211], v[210:211], v[46:47]
  s_and_b32 s80, s49, s47
  s_cmp_lg_u32 s80, 0
  s_cbranch_scc1 L_skip_st
  v_pk_add_f32 v[40:41], v[40:41], v[200:201]
  v_pk_fma_f32 v[42:43], v[200:201], v[200:201], v[42:43]
  v_pk_add_f32 v[40:41], v[40:41], v[202:203]
  v_pk_fma_f32 v[42:43], v[202:203], v[202:203], v[42:43]
  v_pk_add_f32 v[44:45], v[44:45], v[212:213]
  v_pk_fma_f32 v[46:47], v[212:213], v[212:213], v[46:47]
  v_pk_add_f32 v[44:45], v[44:45], v[214:215]
  v_pk_fma_f32 v[46:47], v[214:215], v[214:215], v[46:47]
L_skip_st:
  v_add_f32 v48, v40, v41
  v_add_f32 v49, v42, v43
  v_add_f32 v50, v44, v45
  v_add_f32 v51, v46, v47
  v_permlane32_swap_b32 v48, v49
  s_nop 0
  v_permlane32_swap_b32 v50, v51
  v_add_f32 v48, v48, v49
  v_add_f32 v50, v50, v51
  s_nop 1
  v_permlane16_swap_b32 v48, v50
  v_add_f32 v48, v48, v50
  v_mov_b32 v49, v48
  v_mov_b32 v50, v4
  v_mov_b32 v51, v5
  v_permlane32_swap_b32 v48, v49
  s_lshl_b32 s60, s54, 14
  s_add_u32 s60, s60, 17629184
  s_lshl_b32 s61, s46, 13
  s_add_u32 s60, s60, s61
  s_lshl_b32 s61, s42, 1
  s_add_u32 s61, s61, s47
  s_lshl_b32 s61, s61, 9
  s_add_u32 s60, s60, s61
  s_mov_b32 exec_hi, 0
  buffer_store_dwordx4 v[48:51], v1, s[36:39], s60 offen sc1
  s_mov_b32 exec_hi, -1
  v_mov_b32 v52, v34
  v_mov_b32 v53, v35
  v_mov_b32 v62, v36
  v_mov_b32 v63, v37
  v_and_b32 v54, 15, v0
  v_lshrrev_b32 v55, 4, v0
  v_lshlrev_b32 v55, 2, v55
  v_sub_u32 v54, v54, v55
  v_mov_b32 v55, 0x3f80
  v_mov_b32 v250, 0x3f800000
  v_cmp_eq_u32 vcc, 0, v54
  s_nop 1
  v_cndmask_b32 v248, v3, v55, vcc
  v_cmp_eq_u32 vcc, 1, v54
  s_nop 1
  v_cndmask_b32 v248, v248, v250, vcc
  v_cmp_eq_u32 vcc, 2, v54
  s_nop 1
  v_cndmask_b32 v249, v3, v55, vcc
  v_cmp_eq_u32 vcc, 3, v54
  s_nop 1
  v_cndmask_b32 v249, v249, v250, vcc
  s_add_u32 s56, s48, s47
  s_lshl_b32 s56, s56, 16
  s_lshl_b32 s57, s45, 5
  s_add_u32 s56, s56, s57
  s_lshl_b32 s57, s46, 10
  s_add_u32 s56, s56, s57
  s_add_u32 s81, s56, 11534336
  s_add_u32 s82, s81, 0x20000
  s_add_u32 s83, s81, 0x40000
  s_lshl_b32 s84, s41, 3
  s_add_u32 s84, s84, s42
  s_lshl_b32 s84, s84, 8
  s_lshl_b32 s57, s40, 3
  s_add_u32 s84, s84, s57
  s_add_u32 s84, s84, 45056
  s_waitcnt vmcnt(10)
  s_barrier
  ds_read_b64_tr_b16 v[28:29], v59 offset:0
  ds_read_b64_tr_b16 v[30:31], v59 offset:768
  ds_read_b64_tr_b16 v[32:33], v59 offset:64
  ds_read_b64_tr_b16 v[34:35], v59 offset:832
  ds_read_b64_tr_b16 v[36:37], v59 offset:128
  ds_read_b64_tr_b16 v[38:39], v59 offset:896
  ds_read_b64_tr_b16 v[40:41], v59 offset:6144
  ds_read_b64_tr_b16 v[42:43], v59 offset:6912
  ds_read_b64_tr_b16 v[44:45], v59 offset:6208
  ds_read_b64_tr_b16 v[46:47], v59 offset:6976
  ds_read_b64_tr_b16 v[48:49], v59 offset:6272
  ds_read_b64_tr_b16 v[50:51], v59 offset:7040
  s_waitcnt lgkmcnt(6)
  v_mfma_f32_16x16x32_bf16 v[216:219], v[28:31], v[64:67], 0
  ds_read_b64_tr_b16 v[16:17], v59 offset:12288
  ds_read_b64_tr_b16 v[18:19], v59 offset:13056
  v_mfma_f32_16x16x32_bf16 v[228:231], v[28:31], v[128:131], 0
  ds_read_b64_tr_b16 v[20:21], v59 offset:12352
  ds_read_b64_tr_b16 v[22:23], v59 offset:13120
  v_mfma_f32_16x16x32_bf16 v[220:223], v[32:35], v[64:67], 0
  ds_read_b64_tr_b16 v[24:25], v59 offset:12416
  ds_read_b64_tr_b16 v[26:27], v59 offset:13184
  v_mfma_f32_16x16x32_bf16 v[232:235], v[32:35], v[128:131], 0
  v_mfma_f32_16x16x32_bf16 v[224:227], v[36:39], v[64:67], 0
  s_lshl_b32 s77, s48, 5
  s_mul_i32 s78, s44, 2
  s_lshl_b32 s74, s76, 2
  s_add_u32 s74, s74, s78
  s_mul_i32 s78, s78, 3072
  s_add_u32 s79, s74, 24
  s_and_b32 s79, s79, 31
  s_mul_i32 s79, s79, 44032
  s_add_u32 s79, s79, s77
  s_add_u32 m0, s78, 73728
  s_nop 0
  buffer_load_dwordx4 v56, s[16:19], s79 offen offset:0 lds
  v_mfma_f32_16x16x32_bf16 v[236:239], v[36:39], v[128:131], 0
  buffer_load_dwordx4 v57, s[16:19], s79 offen offset:1024 lds
  s_waitcnt lgkmcnt(6)
  v_mfma_f32_16x16x32_bf16 v[216:219], v[40:43], v[68:71], v[216:219]
  ds_read_b64_tr_b16 v[28:29], v59 offset:18432
  ds_read_b64_tr_b16 v[30:31], v59 offset:19200
  v_mfma_f32_16x16x32_bf16 v[228:231], v[40:43], v[132:135], v[228:231]
  ds_read_b64_tr_b16 v[32:33], v59 offset:18496
  ds_read_b64_tr_b16 v[34:35], v59 offset:19264
  v_mfma_f32_16x16x32_bf16 v[220:223], v[44:47], v[68:71], v[220:223]
  ds_read_b64_tr_b16 v[36:37], v59 offset:18560
  ds_read_b64_tr_b16 v[38:39], v59 offset:19328
  v_mfma_f32_16x16x32_bf16 v[232:235], v[44:47], v[132:135], v[232:235]
  v_mfma_f32_16x16x32_bf16 v[224:227], v[48:51], v[68:71], v[224:227]
  buffer_load_dwordx4 v58, s[16:19], s79 offen offset:2048 lds
  v_mfma_f32_16x16x32_bf16 v[236:239], v[48:51], v[132:135], v[236:239]
  s_add_u32 s79, s74, 25
  s_and_b32 s79, s79, 31
  s_mul_i32 s79, s79, 44032
  s_add_u32 s79, s79, s77
  s_add_u32 m0, s78, 76800
  s_nop 0
  buffer_load_dwordx4 v56, s[16:19], s79 offen offset:0 lds
  s_waitcnt lgkmcnt(6)
  v_mfma_f32_16x16x32_bf16 v[216:219], v[16:19], v[72:75], v[216:219]
  ds_read_b64_tr_b16 v[40:41], v59 offset:24576
  ds_read_b64_tr_b16 v[42:43], v59 offset:25344
  v_mfma_f32_16x16x32_bf16 v[228:231], v[16:19], v[136:139], v[228:231]
  ds_read_b64_tr_b16 v[44:45], v59 offset:24640
  ds_read_b64_tr_b16 v[46:47], v59 offset:25408
  v_mfma_f32_16x16x32_bf16 v[220:223], v[20:23], v[72:75], v[220:223]
  ds_read_b64_tr_b16 v[48:49], v59 offset:24704
  ds_read_b64_tr_b16 v[50:51], v59 offset:25472
  v_mfma_f32_16x16x32_bf16 v[232:235], v[20:23], v[136:139], v[232:235]
  v_mfma_f32_16x16x32_bf16 v[224:227], v[24:27], v[72:75], v[224:227]
  buffer_load_dwordx4 v57, s[16:19], s79 offen offset:1024 lds
  v_mfma_f32_16x16x32_bf16 v[236:239], v[24:27], v[136:139], v[236:239]
  buffer_load_dwordx4 v58, s[16:19], s79 offen offset:2048 lds
  s_waitcnt lgkmcnt(6)
  v_mfma_f32_16x16x32_bf16 v[216:219], v[28:31], v[76:79], v[216:219]
  ds_read_b64_tr_b16 v[16:17], v59 offset:30720
  ds_read_b64_tr_b16 v[18:19], v59 offset:31488
  v_mfma_f32_16x16x32_bf16 v[228:231], v[28:31], v[140:143], v[228:231]
  ds_read_b64_tr_b16 v[20:21], v59 offset:30784
  ds_read_b64_tr_b16 v[22:23], v59 offset:31552
  v_mfma_f32_16x16x32_bf16 v[220:223], v[32:35], v[76:79], v[220:223]
  ds_read_b64_tr_b16 v[24:25], v59 offset:30848
  ds_read_b64_tr_b16 v[26:27], v59 offset:31616
  v_mfma_f32_16x16x32_bf16 v[232:235], v[32:35], v[140:143], v[232:235]
  v_mfma_f32_16x16x32_bf16 v[224:227], v[36:39], v[76:79], v[224:227]
  v_mfma_f32_16x16x32_bf16 v[236:239], v[36:39], v[140:143], v[236:239]
  s_waitcnt lgkmcnt(6)
  s_waitcnt vmcnt(7)
  s_barrier
  v_mfma_f32_16x16x32_bf16 v[216:219], v[40:43], v[80:83], v[216:219]
  ds_read_b64_tr_b16 v[28:29], v59 offset:36864
  ds_read_b64_tr_b16 v[30:31], v59 offset:37632
  v_mfma_f32_16x16x32_bf16 v[228:231], v[40:43], v[144:147], v[228:231]
  ds_read_b64_tr_b16 v[32:33], v59 offset:36928
  ds_read_b64_tr_b16 v[34:35], v59 offset:37696
  v_mfma_f32_16x16x32_bf16 v[220:223], v[44:47], v[80:83], v[220:223]
  ds_read_b64_tr_b16 v[36:37], v59 offset:36992
  ds_read_b64_tr_b16 v[38:39], v59 offset:37760
  v_mfma_f32_16x16x32_bf16 v[232:235], v[44:47], v[144:147], v[232:235]
  v_mfma_f32_16x16x32_bf16 v[224:227], v[48:51], v[80:83], v[224:227]
  v_mfma_f32_16x16x32_bf16 v[236:239], v[48:51], v[144:147], v[236:239]
  s_waitcnt lgkmcnt(6)
  v_mfma_f32_16x16x32_bf16 v[216:219], v[16:19], v[84:87], v[216:219]
  ds_read_b64_tr_b16 v[40:41], v59 offset:43008
  ds_read_b64_tr_b16 v[42:43], v59 offset:43776
  v_mfma_f32_16x16x32_bf16 v[228:231], v[16:19], v[148:151], v[228:231]
  ds_read_b64_tr_b16 v[44:45], v59 offset:43072
  ds_read_b64_tr_b16 v[46:47], v59 offset:43840
  v_mfma_f32_16x16x32_bf16 v[220:223], v[20:23], v[84:87], v[220:223]
  ds_read_b64_tr_b16 v[48:49], v59 offset:43136
  ds_read_b64_tr_b16 v[50:51], v59 offset:43904
  v_mfma_f32_16x16x32_bf16 v[232:235], v[20:23], v[148:151], v[232:235]
  v_mfma_f32_16x16x32_bf16 v[224:227], v[24:27], v[84:87], v[224:227]
  v_mfma_f32_16x16x32_bf16 v[236:239], v[24:27], v[148:151], v[236:239]
  s_waitcnt lgkmcnt(6)
  v_mfma_f32_16x16x32_bf16 v[216:219], v[28:31], v[88:91], v[216:219]
  ds_read_b64_tr_b16 v[16:17], v60 offset:0
  ds_read_b64_tr_b16 v[18:19], v60 offset:768
  v_mfma_f32_16x16x32_bf16 v[228:231], v[28:31], v[152:155], v[228:231]
  ds_read_b64_tr_b16 v[20:21], v60 offset:64
  ds_read_b64_tr_b16 v[22:23], v60 offset:832
  v_mfma_f32_16x16x32_bf16 v[220:223], v[32:35], v[88:91], v[220:223]
  ds_read_b64_tr_b16 v[24:25], v60 offset:128
  ds_read_b64_tr_b16 v[26:27], v60 offset:896
  v_mfma_f32_16x16x32_bf16 v[232:235], v[32:35], v[152:155], v[232:235]
  v_mfma_f32_16x16x32_bf16 v[224:227], v[36:39], v[88:91], v[224:227]
  v_mfma_f32_16x16x32_bf16 v[236:239], v[36:39], v[152:155], v[236:239]
  s_waitcnt lgkmcnt(6)
  v_mfma_f32_16x16x32_bf16 v[216:219], v[40:43], v[92:95], v[216:219]
  ds_read_b64_tr_b16 v[28:29], v60 offset:6144
  ds_read_b64_tr_b16 v[30:31], v60 offset:6912
  v_mfma_f32_16x16x32_bf16 v[228:231], v[40:43], v[156:159], v[228:231]
  ds_read_b64_tr_b16 v[32:33], v60 offset:6208
  ds_read_b64_tr_b16 v[34:35], v60 offset:6976
  v_mfma_f32_16x16x32_bf16 v[220:223], v[44:47], v[92:95], v[220:223]
  ds_read_b64_tr_b16 v[36:37], v60 offset:6272
  ds_read_b64_tr_b16 v[38:39], v60 offset:7040
  v_mfma_f32_16x16x32_bf16 v[232:235], v[44:47], v[156:159], v[232:235]
  v_mfma_f32_16x16x32_bf16 v[224:227], v[48:51], v[92:95], v[224:227]
  v_mfma_f32_16x16x32_bf16 v[236:239], v[48:51], v[156:159], v[236:239]
  s_waitcnt lgkmcnt(6)
  v_mfma_f32_16x16x32_bf16 v[216:219], v[16:19], v[96:99], v[216:219]
  ds_read_b64_tr_b16 v[40:41], v60 offset:12288
  ds_read_b64_tr_b16 v[42:43], v60 offset:13056
  v_mfma_f32_16x16x32_bf16 v[228:231], v[16:19], v[160:163], v[228:231]
  ds_read_b64_tr_b16 v[44:45], v60 offset:12352
  ds_read_b64_tr_b16 v[46:47], v60 offset:13120
  v_mfma_f32_16x16x32_bf16 v[220:223], v[20:23], v[96:99], v[220:223]
  ds_read_b64_tr_b16 v[48:49], v60 offset:12416
  ds_read_b64_tr_b16 v[50:51], v60 offset:13184
  v_mfma_f32_16x16x32_bf16 v[232:235], v[20:23], v[160:163], v[232:235]
  v_mfma_f32_16x16x32_bf16 v[224:227], v[24:27], v[96:99], v[224:227]
  v_mfma_f32_16x16x32_bf16 v[236:239], v[24:27], v[160:163], v[236:239]
  s_waitcnt lgkmcnt(6)
  v_mfma_f32_16x16x32_bf16 v[216:219], v[28:31], v[100:103], v[216:219]
  ds_read_b64_tr_b16 v[16:17], v60 offset:18432
  ds_read_b64_tr_b16 v[18:19], v60 offset:19200
  v_mfma_f32_16x16x32_bf16 v[228:231], v[28:31], v[164:167], v[228:231]
  ds_read_b64_tr_b16 v[20:21], v60 offset:18496
  ds_read_b64_tr_b16 v[22:23], v60 offset:19264
  v_mfma_f32_16x16x32_bf16 v[220:223], v[32:35], v[100:103], v[220:223]
  ds_read_b64_tr_b16 v[24:25], v60 offset:18560
  ds_read_b64_tr_b16 v[26:27], v60 offset:19328
  v_mfma_f32_16x16x32_bf16 v[232:235], v[32:35], v[164:167], v[232:235]
  v_mfma_f32_16x16x32_bf16 v[224:227], v[36:39], v[100:103], v[224:227]
  s_lshl_b32 s75, s54, 14
  s_add_u32 s75, s75, 17629184
  s_lshl_b32 s61, s46, 13
  s_add_u32 s75, s75, s61
  v_and_b32 v61, 31, v0
  v_lshlrev_b32 v61, 4, v61
  v_lshrrev_b32 v54, 5, v0
  v_lshl_add_u32 v61, v54, 12, v61
  buffer_load_dwordx4 v[64:67], v61, s[36:39], s75 offen offset:0 sc1
  v_mfma_f32_16x16x32_bf16 v[236:239], v[36:39], v[164:167], v[236:239]
  buffer_load_dwordx4 v[68:71], v61, s[36:39], s75 offen offset:512 sc1
  s_waitcnt lgkmcnt(6)
  s_waitcnt vmcnt(2)
  s_barrier
  v_mfma_f32_16x16x32_bf16 v[216:219], v[40:43], v[104:107], v[216:219]
  ds_read_b64_tr_b16 v[28:29], v60 offset:24576
  ds_read_b64_tr_b16 v[30:31], v60 offset:25344
  v_mfma_f32_16x16x32_bf16 v[228:231], v[40:43], v[168:171], v[228:231]
  ds_read_b64_tr_b16 v[32:33], v60 offset:24640
  ds_read_b64_tr_b16 v[34:35], v60 offset:25408
  v_mfma_f32_16x16x32_bf16 v[220:223], v[44:47], v[104:107], v[220:223]
  ds_read_b64_tr_b16 v[36:37], v60 offset:24704
  ds_read_b64_tr_b16 v[38:39], v60 offset:25472
  v_mfma_f32_16x16x32_bf16 v[232:235], v[44:47], v[168:171], v[232:235]
  v_mfma_f32_16x16x32_bf16 v[224:227], v[48:51], v[104:107], v[224:227]
  buffer_load_dwordx4 v[72:75], v61, s[36:39], s75 offen offset:1024 sc1
  v_mfma_f32_16x16x32_bf16 v[236:239], v[48:51], v[168:171], v[236:239]
  buffer_load_dwordx4 v[76:79], v61, s[36:39], s75 offen offset:1536 sc1
  s_waitcnt lgkmcnt(6)
  v_mfma_f32_16x16x32_bf16 v[216:219], v[16:19], v[108:111], v[216:219]
  ds_read_b64_tr_b16 v[40:41], v60 offset:30720
  ds_read_b64_tr_b16 v[42:43], v60 offset:31488
  v_mfma_f32_16x16x32_bf16 v[228:231], v[16:19], v[172:175], v[228:231]
  ds_read_b64_tr_b16 v[44:45], v60 offset:30784
  ds_read_b64_tr_b16 v[46:47], v60 offset:31552
  v_mfma_f32_16x16x32_bf16 v[220:223], v[20:23], v[108:111], v[220:223]
  ds_read_b64_tr_b16 v[48:49], v60 offset:30848
  ds_read_b64_tr_b16 v[50:51], v60 offset:31616
  v_mfma_f32_16x16x32_bf16 v[232:235], v[20:23], v[172:175], v[232:235]
  v_mfma_f32_16x16x32_bf16 v[224:227], v[24:27], v[108:111], v[224:227]
  buffer_load_dwordx4 v[80:83], v61, s[36:39], s75 offen offset:2048 sc1
  v_mfma_f32_16x16x32_bf16 v[236:239], v[24:27], v[172:175], v[236:239]
  buffer_load_dwordx4 v[84:87], v61, s[36:39], s75 offen offset:2560 sc1
  s_waitcnt lgkmcnt(6)
  v_mfma_f32_16x16x32_bf16 v[216:219], v[28:31], v[112:115], v[216:219]
  ds_read_b64_tr_b16 v[16:17], v60 offset:36864
  ds_read_b64_tr_b16 v[18:19], v60 offset:37632
  v_mfma_f32_16x16x32_bf16 v[228:231], v[28:31], v[176:179], v[228:231]
  ds_read_b64_tr_b16 v[20:21], v60 offset:36928
  ds_read_b64_tr_b16 v[22:23], v60 offset:37696
  v_mfma_f32_16x16x32_bf16 v[220:223], v[32:35], v[112:115], v[220:223]
  ds_read_b64_tr_b16 v[24:25], v60 offset:36992
  ds_read_b64_tr_b16 v[26:27], v60 offset:37760
  v_mfma_f32_16x16x32_bf16 v[232:235], v[32:35], v[176:179], v[232:235]
  v_mfma_f32_16x16x32_bf16 v[224:227], v[36:39], v[112:115], v[224:227]
  buffer_load_dwordx4 v[88:91], v61, s[36:39], s75 offen offset:3072 sc1
  v_mfma_f32_16x16x32_bf16 v[236:239], v[36:39], v[176:179], v[236:239]
  buffer_load_dwordx4 v[92:95], v61, s[36:39], s75 offen offset:3584 sc1
  s_waitcnt lgkmcnt(6)
  v_mfma_f32_16x16x32_bf16 v[216:219], v[40:43], v[116:119], v[216:219]
  ds_read_b64_tr_b16 v[28:29], v60 offset:43008
  ds_read_b64_tr_b16 v[30:31], v60 offset:43776
  v_mfma_f32_16x16x32_bf16 v[228:231], v[40:43], v[180:183], v[228:231]
  ds_read_b64_tr_b16 v[32:33], v60 offset:43072
  ds_read_b64_tr_b16 v[34:35], v60 offset:43840
  v_mfma_f32_16x16x32_bf16 v[220:223], v[44:47], v[116:119], v[220:223]
  ds_read_b64_tr_b16 v[36:37], v60 offset:43136
  ds_read_b64_tr_b16 v[38:39], v60 offset:43904
  v_mfma_f32_16x16x32_bf16 v[232:235], v[44:47], v[180:183], v[232:235]
  v_mfma_f32_16x16x32_bf16 v[224:227], v[48:51], v[116:119], v[224:227]
  v_mfma_f32_16x16x32_bf16 v[236:239], v[48:51], v[180:183], v[236:239]
  s_waitcnt lgkmcnt(6)
  v_mfma_f32_16x16x32_bf16 v[216:219], v[16:19], v[120:123], v[216:219]
  v_mfma_f32_16x16x32_bf16 v[228:231], v[16:19], v[184:187], v[228:231]
  v_mfma_f32_16x16x32_bf16 v[220:223], v[20:23], v[120:123], v[220:223]
  v_mfma_f32_16x16x32_bf16 v[232:235], v[20:23], v[184:187], v[232:235]
  v_mfma_f32_16x16x32_bf16 v[224:227], v[24:27], v[120:123], v[224:227]
  v_mfma_f32_16x16x32_bf16 v[236:239], v[24:27], v[184:187], v[236:239]
  s_waitcnt lgkmcnt(0)
  v_mfma_f32_16x16x32_bf16 v[216:219], v[28:31], v[124:127], v[216:219]
  v_mfma_f32_16x16x32_bf16 v[228:231], v[28:31], v[188:191], v[228:231]
  v_mfma_f32_16x16x32_bf16 v[220:223], v[32:35], v[124:127], v[220:223]
  v_mfma_f32_16x16x32_bf16 v[232:235], v[32:35], v[188:191], v[232:235]
  v_mfma_f32_16x16x32_bf16 v[224:227], v[36:39], v[124:127], v[224:227]
  v_mfma_f32_16x16x32_bf16 v[236:239], v[36:39], v[188:191], v[236:239]
  s_mov_b32 s55, 0x40000
L_st_retry_17:
  s_waitcnt vmcnt(0)
  v_cmp_ne_u64 s[60:61], s[50:51], v[66:67]
  v_cmp_ne_u64 vcc, s[50:51], v[70:71]
  s_nop 1
  s_or_b64 s[60:61], s[60:61], vcc
  v_cmp_ne_u64 vcc, s[50:51], v[74:75]
  s_nop 1
  s_or_b64 s[60:61], s[60:61], vcc
  v_cmp_ne_u64 vcc, s[50:51], v[78:79]
  s_nop 1
  s_or_b64 s[60:61], s[60:61], vcc
  v_cmp_ne_u64 vcc, s[50:51], v[82:83]
  s_nop 1
  s_or_b64 s[60:61], s[60:61], vcc
  v_cmp_ne_u64 vcc, s[50:51], v[86:87]
  s_nop 1
  s_or_b64 s[60:61], s[60:61], vcc
  v_cmp_ne_u64 vcc, s[50:51], v[90:91]
  s_nop 1
  s_or_b64 s[60:61], s[60:61], vcc
  v_cmp_ne_u64 vcc, s[50:51], v[94:95]
  s_nop 1
  s_or_b64 s[60:61], s[60:61], vcc
  s_cmp_eq_u64 s[60:61], 0
  s_cbranch_scc1 L_st_ok_18
  s_sub_u32 s55, s55, 1
  s_cbranch_scc1 L_st_ok_18
  buffer_load_dwordx4 v[64:67], v61, s[36:39], s75 offen offset:0 sc1
  buffer_load_dwordx4 v[68:71], v61, s[36:39], s75 offen offset:512 sc1
  buffer_load_dwordx4 v[72:75], v61, s[36:39], s75 offen offset:1024 sc1
  buffer_load_dwordx4 v[76:79], v61, s[36:39], s75 offen offset:1536 sc1
  buffer_load_dwordx4 v[80:83], v61, s[36:39], s75 offen offset:2048 sc1
  buffer_load_dwordx4 v[84:87], v61, s[36:39], s75 offen offset:2560 sc1
  buffer_load_dwordx4 v[88:91], v61, s[36:39], s75 offen offset:3072 sc1
  buffer_load_dwordx4 v[92:95], v61, s[36:39], s75 offen offset:3584 sc1
  s_branch L_st_retry_17
L_st_ok_18:
  v_pk_add_f32 v[64:65], v[64:65], v[80:81]
  v_pk_add_f32 v[68:69], v[68:69], v[84:85]
  v_pk_add_f32 v[72:73], v[72:73], v[88:89]
  v_pk_add_f32 v[76:77], v[76:77], v[92:93]
  v_pk_add_f32 v[64:65], v[64:65], v[72:73]
  v_pk_add_f32 v[68:69], v[68:69], v[76:77]
  v_pk_add_f32 v[64:65], v[64:65], v[68:69]
  v_mov_b32 v66, v64
  v_mov_b32 v67, v65
  s_nop 0
  v_permlane32_swap_b32 v64, v66
  v_permlane32_swap_b32 v65, v67
  v_pk_add_f32 v[64:65], v[64:65], v[66:67]
  v_mul_f32 v64, 0x3abe82fa, v64
  v_mul_f32 v65, 0x3abe82fa, v65
  v_fma_f32 v65, -v64, v64, v65
  v_max_f32 v65, 0, v65
  v_add_f32 v65, 0x3727c5ac, v65
  v_rsq_f32 v20, v65
  s_nop 0
  v_mul_f32_e64 v21, -v64, v20
  v_mov_b32 v22, v20
  v_mov_b32 v23, v21
  s_nop 0
  v_permlane16_swap_b32 v20, v22
  v_permlane16_swap_b32 v21, v23
  v_pk_fma_f32 v[192:193], v[192:193], v[20:21], v[20:21] op_sel:[0,0,1] op_sel_hi:[1,0,1]
  v_pk_fma_f32 v[194:195], v[194:195], v[20:21], v[20:21] op_sel:[0,0,1] op_sel_hi:[1,0,1]
  v_pk_fma_f32 v[204:205], v[204:205], v[22:23], v[22:23] op_sel:[0,0,1] op_sel_hi:[1,0,1]
  v_pk_fma_f32 v[206:207], v[206:207], v[22:23], v[22:23] op_sel:[0,0,1] op_sel_hi:[1,0,1]
  v_cvt_pk_bf16_f32 v192, v192, v193
  v_cvt_pk_bf16_f32 v193, v194, v195
  v_cvt_pk_bf16_f32 v204, v204, v205
  v_cvt_pk_bf16_f32 v205, v206, v207
  v_mfma_f32_16x16x16_bf16 v[28:31], v[192:193], v[248:249], 0
  s_nop 0
  v_mfma_f32_16x16x16_bf16 v[32:35], v[204:205], v[248:249], 0
  v_pk_fma_f32 v[196:197], v[196:197], v[20:21], v[20:21] op_sel:[0,0,1] op_sel_hi:[1,0,1]
  v_pk_fma_f32 v[198:199], v[198:199], v[20:21], v[20:21] op_sel:[0,0,1] op_sel_hi:[1,0,1]
  v_pk_fma_f32 v[208:209], v[208:209], v[22:23], v[22:23] op_sel:[0,0,1] op_sel_hi:[1,0,1]
  v_pk_fma_f32 v[210:211], v[210:211], v[22:23], v[22:23] op_sel:[0,0,1] op_sel_hi:[1,0,1]
  v_cvt_pk_bf16_f32 v196, v196, v197
  v_cvt_pk_bf16_f32 v197, v198, v199
  v_cvt_pk_bf16_f32 v208, v208, v209
  v_cvt_pk_bf16_f32 v209, v210, v211
  v_mfma_f32_16x16x16_bf16 v[36:39], v[196:197], v[248:249], 0
  s_nop 0
  v_mfma_f32_16x16x16_bf16 v[40:43], v[208:209], v[248:249], 0
  v_cvt_pk_bf16_f32 v28, v28, v29
  v_cvt_pk_bf16_f32 v29, v30, v31
  buffer_store_dwordx2 v[28:29], v2, s[36:39], s81 offen offset:0 sc1
  v_cvt_pk_bf16_f32 v32, v32, v33
  v_cvt_pk_bf16_f32 v33, v34, v35
  buffer_store_dwordx2 v[32:33], v2, s[36:39], s81 offen offset:512 sc1
  s_cmp_lg_u32 s80, 0
  s_cbranch_scc1 L_skip_z
  v_pk_fma_f32 v[200:201], v[200:201], v[20:21], v[20:21] op_sel:[0,0,1] op_sel_hi:[1,0,1]
  v_pk_fma_f32 v[202:203], v[202:203], v[20:21], v[20:21] op_sel:[0,0,1] op_sel_hi:[1,0,1]
  v_pk_fma_f32 v[212:213], v[212:213], v[22:23], v[22:23] op_sel:[0,0,1] op_sel_hi:[1,0,1]
  v_pk_fma_f32 v[214:215], v[214:215], v[22:23], v[22:23] op_sel:[0,0,1] op_sel_hi:[1,0,1]
  v_cvt_pk_bf16_f32 v200, v200, v201
  v_cvt_pk_bf16_f32 v201, v202, v203
  v_cvt_pk_bf16_f32 v212, v212, v213
  v_cvt_pk_bf16_f32 v213, v214, v215
  v_mfma_f32_16x16x16_bf16 v[28:31], v[200:201], v[248:249], 0
  s_nop 0
  v_mfma_f32_16x16x16_bf16 v[32:35], v[212:213], v[248:249], 0
  s_nop 7
  v_cvt_pk_bf16_f32 v28, v28, v29
  v_cvt_pk_bf16_f32 v29, v30, v31
  buffer_store_dwordx2 v[28:29], v2, s[36:39], s83 offen offset:0 sc1
  v_cvt_pk_bf16_f32 v32, v32, v33
  v_cvt_pk_bf16_f32 v33, v34, v35
  buffer_store_dwordx2 v[32:33], v2, s[36:39], s83 offen offset:512 sc1
L_skip_z:
  s_nop 7
  v_cvt_pk_bf16_f32 v36, v36, v37
  v_cvt_pk_bf16_f32 v37, v38, v39
  buffer_store_dwordx2 v[36:37], v2, s[36:39], s82 offen offset:0 sc1
  v_cvt_pk_bf16_f32 v40, v40, v41
  v_cvt_pk_bf16_f32 v41, v42, v43
  buffer_store_dwordx2 v[40:41], v2, s[36:39], s82 offen offset:512 sc1
  v_mov_b32 v56, v62
  v_mov_b32 v57, v63
  v_lshrrev_b32 v64, 3, v0
  v_and_b32 v65, 7, v0
  v_bfe_u32 v66, v0, 4, 1
  v_lshrrev_b32 v67, 1, v65
  v_xor_b32 v67, v67, v66
  v_and_b32 v68, 1, v65
  v_lshl_or_b32 v67, v67, 1, v68
  v_lshlrev_b32 v67, 4, v67
  v_lshl_add_u32 v67, v64, 10, v67
  s_lshl_b32 s62, s42, 7
  v_add_u32 v200, s62, v67
  v_xor_b32 v201, 64, v200
  v_add_u32 v201, 7168, v201
  v_add_u32 v202, 14336, v200
  v_add_u32 v203, 14336, v201
  s_lshl_b32 s57, s44, 2
  s_add_u32 s57, s57, 0
  s_lshl_b32 s61, s57, 12
  s_add_u32 s61, s61, 98304
  s_lshl_b32 s60, s44, 3
  s_lshr_b32 s60, 168037888, s60
  s_and_b32 s60, s60, 0xff
  s_lshl_b32 s60, s60, 15
  s_mov_b32 m0, s61
  s_nop 0
  buffer_load_dwordx4 v200, s[28:31], s60 offen offset:0 lds
  buffer_load_dwordx4 v201, s[28:31], s60 offen offset:1024 lds
  buffer_load_dwordx4 v202, s[28:31], s60 offen offset:2048 lds
  buffer_load_dwordx4 v203, s[28:31], s60 offen offset:3072 lds
  s_lshl_b32 s57, s44, 2
  s_add_u32 s57, s57, 1
  s_lshl_b32 s61, s57, 12
  s_add_u32 s61, s61, 98304
  s_lshl_b32 s60, s44, 3
  s_lshr_b32 s60, 184881923, s60
  s_and_b32 s60, s60, 0xff
  s_lshl_b32 s60, s60, 15
  s_mov_b32 m0, s61
  s_nop 0
  buffer_load_dwordx4 v200, s[28:31], s60 offen offset:0 lds
  buffer_load_dwordx4 v201, s[28:31], s60 offen offset:1024 lds
  buffer_load_dwordx4 v202, s[28:31], s60 offen offset:2048 lds
  buffer_load_dwordx4 v203, s[28:31], s60 offen offset:3072 lds
  s_lshl_b32 s56, s46, 5
  s_add_u32 s56, s56, s45
  s_lshl_b32 s78, s56, 1
  v_and_b32 v20, 15, v0
  v_lshlrev_b32 v20, 1, v20
  s_lshl_b32 s59, s44, 3
  s_add_u32 s59, s59, s42
  s_lshl_b32 s59, s59, 8
  s_add_u32 s59, s59, 45056
  s_lshl_b32 s56, s48, 16
  s_lshl_b32 s57, s44, 11
  s_add_u32 s56, s56, s57
  s_add_u32 s56, s56, 11534336
  s_add_u32 s57, s3, 0
  s_and_b32 s57, s57, 7
  s_lshl_b32 s57, s57, 13
  s_add_u32 s64, s57, s56
  s_add_u32 s57, s3, 1
  s_and_b32 s57, s57, 7
  s_lshl_b32 s57, s57, 13
  s_add_u32 s65, s57, s56
  s_add_u32 s57, s3, 2
  s_and_b32 s57, s57, 7
  s_lshl_b32 s57, s57, 13
  s_add_u32 s66, s57, s56
  s_add_u32 s57, s3, 3
  s_and_b32 s57, s57, 7
  s_lshl_b32 s57, s57, 13
  s_add_u32 s67, s57, s56
  s_add_u32 s57, s3, 4
  s_and_b32 s57, s57, 7
  s_lshl_b32 s57, s57, 13
  s_add_u32 s68, s57, s56
  s_add_u32 s57, s3, 5
  s_and_b32 s57, s57, 7
  s_lshl_b32 s57, s57, 13
  s_add_u32 s69, s57, s56
  s_add_u32 s57, s3, 6
  s_and_b32 s57, s57, 7
  s_lshl_b32 s57, s57, 13
  s_add_u32 s70, s57, s56
  s_add_u32 s57, s3, 7
  s_and_b32 s57, s57, 7
  s_lshl_b32 s57, s57, 13
  s_add_u32 s71, s57, s56
  s_lshl_b32 s86, s44, 13
  s_add_u32 s86, s86, 24576
  s_lshl_b32 s87, s47, 12
  s_lshl_b32 s58, s46, 11
  s_add_u32 s87, s87, s58
  s_add_u32 s87, s87, 24576
  s_lshr_b32 s57, s45, 4
  s_lshl_b32 s58, s46, 1
  s_add_u32 s57, s57, s58
  s_mul_i32 s57, s57, 22528
  s_add_u32 s58, s48, s47
  s_lshl_b32 s58, s58, 9
  s_add_u32 s57, s57, s58
  s_add_u32 s81, s57, 14680064
  s_add_u32 s82, s81, 22528
  s_waitcnt vmcnt(8)
  s_barrier
  s_cmp_lg_u32 s44, 0
  s_cbranch_scc1 L_noflag_19
  s_mov_b64 exec, 1
  buffer_store_dwordx2 v[4:5], off, s[36:39], s84 sc1
  s_mov_b64 exec, -1
L_noflag_19:
  buffer_load_ushort v62, v20, s[24:27], s78 offen
  buffer_load_ushort v63, v20, s[24:27], s78 offen offset:32
  ds_read_b64_tr_b16 v[28:29], v59 offset:0
  ds_read_b64_tr_b16 v[30:31], v59 offset:768
  ds_read_b64_tr_b16 v[32:33], v59 offset:64
  ds_read_b64_tr_b16 v[34:35], v59 offset:832
  ds_read_b64_tr_b16 v[36:37], v59 offset:128
  ds_read_b64_tr_b16 v[38:39], v59 offset:896
  ds_read_b64_tr_b16 v[40:41], v59 offset:6144
  ds_read_b64_tr_b16 v[42:43], v59 offset:6912
  ds_read_b64_tr_b16 v[44:45], v59 offset:6208
  ds_read_b64_tr_b16 v[46:47], v59 offset:6976
  ds_read_b64_tr_b16 v[48:49], v59 offset:6272
  ds_read_b64_tr_b16 v[50:51], v59 offset:7040
  s_waitcnt lgkmcnt(6)
  v_mfma_f32_16x16x32_bf16 v[240:243], v[28:31], v[252:255], 0
  ds_read_b64_tr_b16 v[16:17], v59 offset:12288
  ds_read_b64_tr_b16 v[18:19], v59 offset:13056
  ds_read_b64_tr_b16 v[20:21], v59 offset:12352
  v_mfma_f32_16x16x32_bf16 v[244:247], v[32:35], v[252:255], 0
  ds_read_b64_tr_b16 v[22:23], v59 offset:13120
  ds_read_b64_tr_b16 v[24:25], v59 offset:12416
  ds_read_b64_tr_b16 v[26:27], v59 offset:13184
  v_mfma_f32_16x16x32_bf16 v[248:251], v[36:39], v[252:255], 0
  s_lshl_b32 s57, s44, 2
  s_add_u32 s57, s57, 2
  s_lshl_b32 s61, s57, 12
  s_add_u32 s61, s61, 98304
  s_lshl_b32 s60, s44, 3
  s_lshr_b32 s60, 201785606, s60
  s_and_b32 s60, s60, 0xff
  s_lshl_b32 s60, s60, 15
  s_mov_b32 m0, s61
  s_nop 0
  buffer_load_dwordx4 v200, s[28:31], s60 offen offset:0 lds
  s_waitcnt lgkmcnt(6)
  v_mfma_f32_16x16x32_bf16 v[240:243], v[40:43], v[252:255], v[240:243]
  ds_read_b64_tr_b16 v[28:29], v59 offset:18432
  ds_read_b64_tr_b16 v[30:31], v59 offset:19200
  ds_read_b64_tr_b16 v[32:33], v59 offset:18496
  v_mfma_f32_16x16x32_bf16 v[244:247], v[44:47], v[252:255], v[244:247]
  ds_read_b64_tr_b16 v[34:35], v59 offset:19264
  ds_read_b64_tr_b16 v[36:37], v59 offset:18560
  ds_read_b64_tr_b16 v[38:39], v59 offset:19328
  v_mfma_f32_16x16x32_bf16 v[248:251], v[48:51], v[252:255], v[248:251]
  buffer_load_dwordx4 v201, s[28:31], s60 offen offset:1024 lds
  s_waitcnt lgkmcnt(6)
  v_mfma_f32_16x16x32_bf16 v[240:243], v[16:19], v[252:255], v[240:243]
  ds_read_b64_tr_b16 v[40:41], v59 offset:24576
  ds_read_b64_tr_b16 v[42:43], v59 offset:25344
  ds_read_b64_tr_b16 v[44:45], v59 offset:24640
  v_mfma_f32_16x16x32_bf16 v[244:247], v[20:23], v[252:255], v[244:247]
  ds_read_b64_tr_b16 v[46:47], v59 offset:25408
  ds_read_b64_tr_b16 v[48:49], v59 offset:24704
  ds_read_b64_tr_b16 v[50:51], v59 offset:25472
  v_mfma_f32_16x16x32_bf16 v[248:251], v[24:27], v[252:255], v[248:251]
  buffer_load_dwordx4 v202, s[28:31], s60 offen offset:2048 lds
  s_waitcnt lgkmcnt(6)
  v_mfma_f32_16x16x32_bf16 v[240:243], v[28:31], v[252:255], v[240:243]
  ds_read_b64_tr_b16 v[16:17], v59 offset:30720
  ds_read_b64_tr_b16 v[18:19], v59 offset:31488
  ds_read_b64_tr_b16 v[20:21], v59 offset:30784
  v_mfma_f32_16x16x32_bf16 v[244:247], v[32:35], v[252:255], v[244:247]
  ds_read_b64_tr_b16 v[22:23], v59 offset:31552
  ds_read_b64_tr_b16 v[24:25], v59 offset:30848
  ds_read_b64_tr_b16 v[26:27], v59 offset:31616
  v_mfma_f32_16x16x32_bf16 v[248:251], v[36:39], v[252:255], v[248:251]
  buffer_load_dwordx4 v203, s[28:31], s60 offen offset:3072 lds
  s_waitcnt lgkmcnt(6)
  v_mfma_f32_16x16x32_bf16 v[240:243], v[40:43], v[252:255], v[240:243]
  ds_read_b64_tr_b16 v[28:29], v59 offset:36864
  ds_read_b64_tr_b16 v[30:31], v59 offset:37632
  ds_read_b64_tr_b16 v[32:33], v59 offset:36928
  v_mfma_f32_16x16x32_bf16 v[244:247], v[44:47], v[252:255], v[244:247]
  ds_read_b64_tr_b16 v[34:35], v59 offset:37696
  ds_read_b64_tr_b16 v[36:37], v59 offset:36992
  ds_read_b64_tr_b16 v[38:39], v59 offset:37760
  v_mfma_f32_16x16x32_bf16 v[248:251], v[48:51], v[252:255], v[248:251]
  s_lshl_b32 s57, s44, 2
  s_add_u32 s57, s57, 3
  s_lshl_b32 s61, s57, 12
  s_add_u32 s61, s61, 98304
  s_lshl_b32 s60, s44, 3
  s_lshr_b32 s60, 218628617, s60
  s_and_b32 s60, s60, 0xff
  s_lshl_b32 s60, s60, 15
  s_mov_b32 m0, s61
  s_nop 0
  buffer_load_dwordx4 v200, s[28:31], s60 offen offset:0 lds
  s_waitcnt lgkmcnt(6)
  v_mfma_f32_16x16x32_bf16 v[240:243], v[16:19], v[252:255], v[240:243]
  ds_read_b64_tr_b16 v[40:41], v59 offset:43008
  ds_read_b64_tr_b16 v[42:43], v59 offset:43776
  ds_read_b64_tr_b16 v[44:45], v59 offset:43072
  v_mfma_f32_16x16x32_bf16 v[244:247], v[20:23], v[252:255], v[244:247]
  ds_read_b64_tr_b16 v[46:47], v59 offset:43840
  ds_read_b64_tr_b16 v[48:49], v59 offset:43136
  ds_read_b64_tr_b16 v[50:51], v59 offset:43904
  v_mfma_f32_16x16x32_bf16 v[248:251], v[24:27], v[252:255], v[248:251]
  buffer_load_dwordx4 v201, s[28:31], s60 offen offset:1024 lds
  s_waitcnt lgkmcnt(6)
  s_barrier
  v_mfma_f32_16x16x32_bf16 v[240:243], v[28:31], v[252:255], v[240:243]
  ds_read_b64_tr_b16 v[16:17], v60 offset:0
  ds_read_b64_tr_b16 v[18:19], v60 offset:768
  ds_read_b64_tr_b16 v[20:21], v60 offset:64
  v_mfma_f32_16x16x32_bf16 v[244:247], v[32:35], v[252:255], v[244:247]
  ds_read_b64_tr_b16 v[22:23], v60 offset:832
  ds_read_b64_tr_b16 v[24:25], v60 offset:128
  ds_read_b64_tr_b16 v[26:27], v60 offset:896
  v_mfma_f32_16x16x32_bf16 v[248:251], v[36:39], v[252:255], v[248:251]
  buffer_load_dwordx4 v202, s[28:31], s60 offen offset:2048 lds
  s_waitcnt lgkmcnt(6)
  v_mfma_f32_16x16x32_bf16 v[240:243], v[40:43], v[252:255], v[240:243]
  ds_read_b64_tr_b16 v[28:29], v60 offset:6144
  ds_read_b64_tr_b16 v[30:31], v60 offset:6912
  ds_read_b64_tr_b16 v[32:33], v60 offset:6208
  v_mfma_f32_16x16x32_bf16 v[244:247], v[44:47], v[252:255], v[244:247]
  ds_read_b64_tr_b16 v[34:35], v60 offset:6976
  ds_read_b64_tr_b16 v[36:37], v60 offset:6272
  ds_read_b64_tr_b16 v[38:39], v60 offset:7040
  v_mfma_f32_16x16x32_bf16 v[248:251], v[48:51], v[252:255], v[248:251]
  buffer_load_dwordx4 v203, s[28:31], s60 offen offset:3072 lds
  s_waitcnt lgkmcnt(6)
  v_mfma_f32_16x16x32_bf16 v[240:243], v[16:19], v[252:255], v[240:243]
  ds_read_b64_tr_b16 v[40:41], v60 offset:12288
  ds_read_b64_tr_b16 v[42:43], v60 offset:13056
  ds_read_b64_tr_b16 v[44:45], v60 offset:12352
  ds_read_b64_tr_b16 v[46:47], v60 offset:13120
  ds_read_b64_tr_b16 v[48:49], v60 offset:12416
  ds_read_b64_tr_b16 v[50:51], v60 offset:13184
  v_mfma_f32_16x16x32_bf16 v[244:247], v[20:23], v[252:255], v[244:247]
  s_add_u32 s57, s44, 16
  s_sub_u32 s61, s57, 16
  s_lshl_b32 s61, s61, 12
  s_lshl_b32 s60, s44, 3
  s_lshr_b32 s60, 303108111, s60
  s_and_b32 s60, s60, 0xff
  s_lshl_b32 s60, s60, 15
  s_mov_b32 m0, s61
  s_nop 0
  buffer_load_dwordx4 v200, s[28:31], s60 offen offset:0 lds
  v_mfma_f32_16x16x32_bf16 v[248:251], v[24:27], v[252:255], v[248:251]
  buffer_load_dwordx4 v201, s[28:31], s60 offen offset:1024 lds
  s_waitcnt lgkmcnt(6)
  v_mfma_f32_16x16x32_bf16 v[240:243], v[28:31], v[252:255], v[240:243]
  ds_read_b64_tr_b16 v[16:17], v60 offset:18432
  ds_read_b64_tr_b16 v[18:19], v60 offset:19200
  ds_read_b64_tr_b16 v[20:21], v60 offset:18496
  ds_read_b64_tr_b16 v[22:23], v60 offset:19264
  ds_read_b64_tr_b16 v[24:25], v60 offset:18560
  ds_read_b64_tr_b16 v[26:27], v60 offset:19328
  v_mfma_f32_16x16x32_bf16 v[244:247], v[32:35], v[252:255], v[244:247]
  buffer_load_dwordx4 v202, s[28:31], s60 offen offset:2048 lds
  v_mfma_f32_16x16x32_bf16 v[248:251], v[36:39], v[252:255], v[248:251]
  buffer_load_dwordx4 v203, s[28:31], s60 offen offset:3072 lds
  s_waitcnt lgkmcnt(6)
  v_mfma_f32_16x16x32_bf16 v[240:243], v[40:43], v[252:255], v[240:243]
  ds_read_b64_tr_b16 v[28:29], v60 offset:24576
  ds_read_b64_tr_b16 v[30:31], v60 offset:25344
  ds_read_b64_tr_b16 v[32:33], v60 offset:24640
  ds_read_b64_tr_b16 v[34:35], v60 offset:25408
  ds_read_b64_tr_b16 v[36:37], v60 offset:24704
  ds_read_b64_tr_b16 v[38:39], v60 offset:25472
  v_mfma_f32_16x16x32_bf16 v[244:247], v[44:47], v[252:255], v[244:247]
  s_cmp_lt_u32 s44, 2
  s_cselect_b32 s61, 20, 16
  s_add_u32 s57, s44, s61
  s_sub_u32 s61, s57, 16
  s_lshl_b32 s61, s61, 12
  s_lshl_b32 s60, s44, 3
  s_lshr_b32 s60, 303109396, s60
  s_and_b32 s60, s60, 0xff
  s_lshl_b32 s60, s60, 15
  s_mov_b32 m0, s61
  s_nop 0
  buffer_load_dwordx4 v200, s[28:31], s60 offen offset:0 lds
  v_mfma_f32_16x16x32_bf16 v[248:251], v[48:51], v[252:255], v[248:251]
  buffer_load_dwordx4 v201, s[28:31], s60 offen offset:1024 lds
  s_waitcnt lgkmcnt(6)
  v_mfma_f32_16x16x32_bf16 v[240:243], v[16:19], v[252:255], v[240:243]
  ds_read_b64_tr_b16 v[40:41], v60 offset:30720
  ds_read_b64_tr_b16 v[42:43], v60 offset:31488
  ds_read_b64_tr_b16 v[44:45], v60 offset:30784
  ds_read_b64_tr_b16 v[46:47], v60 offset:31552
  ds_read_b64_tr_b16 v[48:49], v60 offset:30848
  ds_read_b64_tr_b16 v[50:51], v60 offset:31616
  v_mfma_f32_16x16x32_bf16 v[244:247], v[20:23], v[252:255], v[244:247]
  buffer_load_dwordx4 v202, s[28:31], s60 offen offset:2048 lds
  v_mfma_f32_16x16x32_bf16 v[248:251], v[24:27], v[252:255], v[248:251]
  buffer_load_dwordx4 v203, s[28:31], s60 offen offset:3072 lds
  s_waitcnt lgkmcnt(6)
  v_mfma_f32_16x16x32_bf16 v[240:243], v[28:31], v[252:255], v[240:243]
  ds_read_b64_tr_b16 v[16:17], v60 offset:36864
  ds_read_b64_tr_b16 v[18:19], v60 offset:37632
  ds_read_b64_tr_b16 v[20:21], v60 offset:36928
  v_mfma_f32_16x16x32_bf16 v[244:247], v[32:35], v[252:255], v[244:247]
  ds_read_b64_tr_b16 v[22:23], v60 offset:37696
  ds_read_b64_tr_b16 v[24:25], v60 offset:36992
  ds_read_b64_tr_b16 v[26:27], v60 offset:37760
  v_mfma_f32_16x16x32_bf16 v[248:251], v[36:39], v[252:255], v[248:251]
  buffer_load_dwordx2 v[58:59], v7, s[36:39], s59 offen sc1
  s_waitcnt lgkmcnt(6)
  v_mfma_f32_16x16x32_bf16 v[240:243], v[40:43], v[252:255], v[240:243]
  ds_read_b64_tr_b16 v[28:29], v60 offset:43008
  ds_read_b64_tr_b16 v[30:31], v60 offset:43776
  ds_read_b64_tr_b16 v[32:33], v60 offset:43072
  v_mfma_f32_16x16x32_bf16 v[244:247], v[44:47], v[252:255], v[244:247]
  ds_read_b64_tr_b16 v[34:35], v60 offset:43840
  ds_read_b64_tr_b16 v[36:37], v60 offset:43136
  ds_read_b64_tr_b16 v[38:39], v60 offset:43904
  v_mfma_f32_16x16x32_bf16 v[248:251], v[48:51], v[252:255], v[248:251]
  s_waitcnt lgkmcnt(6)
  v_mfma_f32_16x16x32_bf16 v[240:243], v[16:19], v[252:255], v[240:243]
  v_mfma_f32_16x16x32_bf16 v[244:247], v[20:23], v[252:255], v[244:247]
  v_mfma_f32_16x16x32_bf16 v[248:251], v[24:27], v[252:255], v[248:251]
  s_waitcnt lgkmcnt(0)
  v_mfma_f32_16x16x32_bf16 v[240:243], v[28:31], v[252:255], v[240:243]
  v_mfma_f32_16x16x32_bf16 v[244:247], v[32:35], v[252:255], v[244:247]
  v_mfma_f32_16x16x32_bf16 v[248:251], v[36:39], v[252:255], v[248:251]
  v_add_u32 v61, 0x10000, v1
  s_waitcnt vmcnt(0)
  v_cmp_ne_u64 vcc, s[50:51], v[58:59]
  s_nop 1
  s_cbranch_vccz L_late_20
  s_mov_b32 s55, 0x40000
L_poll_21:
  buffer_load_dwordx2 v[58:59], v7, s[36:39], s59 offen sc1
  s_waitcnt vmcnt(0)
  v_cmp_ne_u64 vcc, s[50:51], v[58:59]
  s_sub_u32 s55, s55, 1
  s_cbranch_scc1 L_polled_22
  s_cbranch_vccnz L_poll_21
L_polled_22:
L_late_20:
  v_lshlrev_b32 v62, 16, v62
  v_lshlrev_b32 v63, 16, v63
  v_add_u32 v54, s86, v1
  v_add_u32 v55, s87, v1
  v_lshrrev_b32 v192, 4, v0
  v_bfe_u32 v193, v0, 2, 2
  v_and_b32 v194, 3, v0
  v_lshl_add_u32 v195, v192, 3, v193
  v_lshlrev_b32 v195, 7, v195
  v_lshl_add_u32 v195, v194, 3, v195
  v_lshrrev_b32 v193, 1, v193
  v_and_b32 v192, 1, v192
  v_lshl_or_b32 v193, v192, 1, v193
  s_lshl_b32 s59, s47, 1
  v_xor_b32 v193, s59, v193
  v_lshl_add_u32 v59, v193, 5, v195
  v_xor_b32 v60, 32, v59
  s_add_u32 s56, s64, 0
  buffer_load_dwordx4 v[64:67], v1, s[36:39], s56 offen offset:0 sc1
  buffer_load_dwordx4 v[68:71], v61, s[36:39], s56 offen offset:0 sc1
  buffer_load_dwordx4 v[72:75], v1, s[36:39], s56 offen offset:1024 sc1
  buffer_load_dwordx4 v[76:79], v61, s[36:39], s56 offen offset:1024 sc1
  s_add_u32 s56, s65, 0
  buffer_load_dwordx4 v[80:83], v1, s[36:39], s56 offen offset:0 sc1
  buffer_load_dwordx4 v[84:87], v61, s[36:39], s56 offen offset:0 sc1
  buffer_load_dwordx4 v[88:91], v1, s[36:39], s56 offen offset:1024 sc1
  buffer_load_dwordx4 v[92:95], v61, s[36:39], s56 offen offset:1024 sc1
  s_add_u32 s56, s66, 0
  buffer_load_dwordx4 v[96:99], v1, s[36:39], s56 offen offset:0 sc1
  buffer_load_dwordx4 v[100:103], v61, s[36:39], s56 offen offset:0 sc1
  buffer_load_dwordx4 v[104:107], v1, s[36:39], s56 offen offset:1024 sc1
  buffer_load_dwordx4 v[108:111], v61, s[36:39], s56 offen offset:1024 sc1
  s_add_u32 s56, s67, 0
  buffer_load_dwordx4 v[112:115], v1, s[36:39], s56 offen offset:0 sc1
  buffer_load_dwordx4 v[116:119], v61, s[36:39], s56 offen offset:0 sc1
  s_lshl_b32 s88, s54, 8
  s_add_u32 s88, s88, 61440
  s_lshl_b32 s63, s42, 3
  s_add_u32 s88, s88, s63
  s_lshl_b32 s89, s54, 8
  s_add_u32 s89, s89, 61440
  s_waitcnt vmcnt(12)
  v_mfma_f32_16x16x32_bf16 v[128:131], v[64:67], a[0:3], 0
  s_mov_b32 s86, 0xbdd2d3e8
  v_mov_b32 v58, 0xc0135761
  v_mfma_f32_16x16x32_bf16 v[132:135], v[64:67], a[4:7], 0
  v_mul_f32 v192, v240, v53
  v_mul_f32 v193, v241, v53
  v_mfma_f32_16x16x32_bf16 v[136:139], v[64:67], a[8:11], 0
  v_mul_f32 v194, v242, v53
  v_mul_f32 v195, v243, v53
  v_mfma_f32_16x16x32_bf16 v[140:143], v[64:67], a[12:15], 0
  v_mul_f32 v196, v240, v57
  v_mul_f32 v197, v241, v57
  v_mfma_f32_16x16x32_bf16 v[144:147], v[68:71], a[0:3], 0
  v_mul_f32 v198, v242, v57
  v_mul_f32 v199, v243, v57
  v_mfma_f32_16x16x32_bf16 v[148:151], v[68:71], a[4:7], 0
  v_mfma_f32_16x16x32_bf16 v[152:155], v[68:71], a[8:11], 0
  buffer_load_dwordx4 v[120:123], v1, s[36:39], s56 offen offset:1024 sc1
  v_mfma_f32_16x16x32_bf16 v[156:159], v[68:71], a[12:15], 0
  buffer_load_dwordx4 v[124:127], v61, s[36:39], s56 offen offset:1024 sc1
  s_waitcnt vmcnt(12)
  v_mfma_f32_16x16x32_bf16 v[128:131], v[72:75], a[16:19], v[128:131]
  v_fma_f32 v216, v216, v52, v192
  v_fma_f32 v217, v217, v52, v193
  v_mfma_f32_16x16x32_bf16 v[132:135], v[72:75], a[20:23], v[132:135]
  v_fma_f32 v218, v218, v52, v194
  v_fma_f32 v219, v219, v52, v195
  v_mfma_f32_16x16x32_bf16 v[136:139], v[72:75], a[24:27], v[136:139]
  v_fma_f32 v228, v228, v56, v196
  v_fma_f32 v229, v229, v56, v197
  v_mfma_f32_16x16x32_bf16 v[140:143], v[72:75], a[28:31], v[140:143]
  v_fma_f32 v230, v230, v56, v198
  v_fma_f32 v231, v231, v56, v199
  v_mfma_f32_16x16x32_bf16 v[144:147], v[76:79], a[16:19], v[144:147]
  v_mul_f32 v192, v216, v216
  v_mul_f32 v193, v217, v217
  v_mfma_f32_16x16x32_bf16 v[148:151], v[76:79], a[20:23], v[148:151]
  v_mfma_f32_16x16x32_bf16 v[152:155], v[76:79], a[24:27], v[152:155]
  s_add_u32 s56, s68, 0
  buffer_load_dwordx4 v[64:67], v1, s[36:39], s56 offen offset:0 sc1
  v_mfma_f32_16x16x32_bf16 v[156:159], v[76:79], a[28:31], v[156:159]
  buffer_load_dwordx4 v[68:71], v61, s[36:39], s56 offen offset:0 sc1
  s_waitcnt vmcnt(12)
  v_mfma_f32_16x16x32_bf16 v[128:131], v[80:83], a[32:35], v[128:131]
  v_mul_f32 v194, v218, v218
  v_mul_f32 v195, v219, v219
  v_mfma_f32_16x16x32_bf16 v[132:135], v[80:83], a[36:39], v[132:135]
  v_mul_f32 v196, v228, v228
  v_mul_f32 v197, v229, v229
  v_mfma_f32_16x16x32_bf16 v[136:139], v[80:83], a[40:43], v[136:139]
  v_mul_f32 v198, v230, v230
  v_mul_f32 v199, v231, v231
  v_mfma_f32_16x16x32_bf16 v[140:143], v[80:83], a[44:47], v[140:143]
  v_fma_f32 v192, v192, s86, v58
  v_fma_f32 v193, v193, s86, v58
  v_mfma_f32_16x16x32_bf16 v[144:147], v[84:87], a[32:35], v[144:147]
  v_fma_f32 v194, v194, s86, v58
  v_fma_f32 v195, v195, s86, v58
  v_mfma_f32_16x16x32_bf16 v[148:151], v[84:87], a[36:39], v[148:151]
  v_mfma_f32_16x16x32_bf16 v[152:155], v[84:87], a[40:43], v[152:155]
  buffer_load_dwordx4 v[72:75], v1, s[36:39], s56 offen offset:1024 sc1
  v_mfma_f32_16x16x32_bf16 v[156:159], v[84:87], a[44:47], v[156:159]
  buffer_load_dwordx4 v[76:79], v61, s[36:39], s56 offen offset:1024 sc1
  s_waitcnt vmcnt(12)
  v_mfma_f32_16x16x32_bf16 v[128:131], v[88:91], a[48:51], v[128:131]
  v_fma_f32 v196, v196, s86, v58
  v_fma_f32 v197, v197, s86, v58
  v_mfma_f32_16x16x32_bf16 v[132:135], v[88:91], a[52:55], v[132:135]
  v_fma_f32 v198, v198, s86, v58
  v_fma_f32 v199, v199, s86, v58
  v_mfma_f32_16x16x32_bf16 v[136:139], v[88:91], a[56:59], v[136:139]
  v_mul_f32 v192, v192, v216
  v_mul_f32 v193, v193, v217
  v_mfma_f32_16x16x32_bf16 v[140:143], v[88:91], a[60:63], v[140:143]
  v_mul_f32 v194, v194, v218
  v_mul_f32 v195, v195, v219
  v_mfma_f32_16x16x32_bf16 v[144:147], v[92:95], a[48:51], v[144:147]
  v_mul_f32 v196, v196, v228
  v_mul_f32 v197, v197, v229
  v_mfma_f32_16x16x32_bf16 v[148:151], v[92:95], a[52:55], v[148:151]
  v_mfma_f32_16x16x32_bf16 v[152:155], v[92:95], a[56:59], v[152:155]
  s_add_u32 s56, s69, 0
  buffer_load_dwordx4 v[80:83], v1, s[36:39], s56 offen offset:0 sc1
  v_mfma_f32_16x16x32_bf16 v[156:159], v[92:95], a[60:63], v[156:159]
  buffer_load_dwordx4 v[84:87], v61, s[36:39], s56 offen offset:0 sc1
  s_waitcnt vmcnt(12)
  v_mfma_f32_16x16x32_bf16 v[128:131], v[96:99], a[64:67], v[128:131]
  v_mul_f32 v198, v198, v230
  v_mul_f32 v199, v199, v231
  v_mfma_f32_16x16x32_bf16 v[132:135], v[96:99], a[68:71], v[132:135]
  v_exp_f32 v192, v192
  v_exp_f32 v193, v193
  v_mfma_f32_16x16x32_bf16 v[136:139], v[96:99], a[72:75], v[136:139]
  v_exp_f32 v194, v194
  v_exp_f32 v195, v195
  v_mfma_f32_16x16x32_bf16 v[140:143], v[96:99], a[76:79], v[140:143]
  v_exp_f32 v196, v196
  v_exp_f32 v197, v197
  v_mfma_f32_16x16x32_bf16 v[144:147], v[100:103], a[64:67], v[144:147]
  v_exp_f32 v198, v198
  v_exp_f32 v199, v199
  v_mfma_f32_16x16x32_bf16 v[148:151], v[100:103], a[68:71], v[148:151]
  v_mfma_f32_16x16x32_bf16 v[152:155], v[100:103], a[72:75], v[152:155]
  buffer_load_dwordx4 v[88:91], v1, s[36:39], s56 offen offset:1024 sc1
  v_mfma_f32_16x16x32_bf16 v[156:159], v[100:103], a[76:79], v[156:159]
  buffer_load_dwordx4 v[92:95], v61, s[36:39], s56 offen offset:1024 sc1
  s_waitcnt vmcnt(12)
  v_mfma_f32_16x16x32_bf16 v[128:131], v[104:107], a[80:83], v[128:131]
  v_add_f32 v192, 1.0, v192
  v_add_f32 v193, 1.0, v193
  v_mfma_f32_16x16x32_bf16 v[132:135], v[104:107], a[84:87], v[132:135]
  v_add_f32 v194, 1.0, v194
  v_add_f32 v195, 1.0, v195
  v_mfma_f32_16x16x32_bf16 v[136:139], v[104:107], a[88:91], v[136:139]
  v_add_f32 v196, 1.0, v196
  v_add_f32 v197, 1.0, v197
  v_mfma_f32_16x16x32_bf16 v[140:143], v[104:107], a[92:95], v[140:143]
  v_add_f32 v198, 1.0, v198
  v_add_f32 v199, 1.0, v199
  v_mfma_f32_16x16x32_bf16 v[144:147], v[108:111], a[80:83], v[144:147]
  v_rcp_f32 v192, v192
  v_rcp_f32 v193, v193
  v_mfma_f32_16x16x32_bf16 v[148:151], v[108:111], a[84:87], v[148:151]
  v_mfma_f32_16x16x32_bf16 v[152:155], v[108:111], a[88:91], v[152:155]
  s_add_u32 s56, s70, 0
  buffer_load_dwordx4 v[96:99], v1, s[36:39], s56 offen offset:0 sc1
  v_mfma_f32_16x16x32_bf16 v[156:159], v[108:111], a[92:95], v[156:159]
  buffer_load_dwordx4 v[100:103], v61, s[36:39], s56 offen offset:0 sc1
  s_waitcnt vmcnt(12)
  v_mfma_f32_16x16x32_bf16 v[128:131], v[112:115], a[96:99], v[128:131]
  v_rcp_f32 v194, v194
  v_rcp_f32 v195, v195
  v_mfma_f32_16x16x32_bf16 v[132:135], v[112:115], a[100:103], v[132:135]
  v_rcp_f32 v196, v196
  v_rcp_f32 v197, v197
  v_mfma_f32_16x16x32_bf16 v[136:139], v[112:115], a[104:107], v[136:139]
  v_rcp_f32 v198, v198
  v_rcp_f32 v199, v199
  v_mfma_f32_16x16x32_bf16 v[140:143], v[112:115], a[108:111], v[140:143]
  v_mul_f32 v216, v216, v192
  v_mul_f32 v217, v217, v193
  v_mfma_f32_16x16x32_bf16 v[144:147], v[116:119], a[96:99], v[144:147]
  v_mul_f32 v218, v218, v194
  v_mul_f32 v219, v219, v195
  v_mfma_f32_16x16x32_bf16 v[148:151], v[116:119], a[100:103], v[148:151]
  v_mfma_f32_16x16x32_bf16 v[152:155], v[116:119], a[104:107], v[152:155]
  buffer_load_dwordx4 v[104:107], v1, s[36:39], s56 offen offset:1024 sc1
  v_mfma_f32_16x16x32_bf16 v[156:159], v[116:119], a[108:111], v[156:159]
  buffer_load_dwordx4 v[108:111], v61, s[36:39], s56 offen offset:1024 sc1
  s_waitcnt vmcnt(12)
  v_mfma_f32_16x16x32_bf16 v[128:131], v[120:123], a[112:115], v[128:131]
  v_mul_f32 v228, v228, v196
  v_mul_f32 v229, v229, v197
  v_mfma_f32_16x16x32_bf16 v[132:135], v[120:123], a[116:119], v[132:135]
  v_mul_f32 v230, v230, v198
  v_mul_f32 v231, v231, v199
  v_mfma_f32_16x16x32_bf16 v[136:139], v[120:123], a[120:123], v[136:139]
  v_cvt_pk_bf16_f32 v16, v216, v217
  v_cvt_pk_bf16_f32 v17, v218, v219
  v_mfma_f32_16x16x32_bf16 v[140:143], v[120:123], a[124:127], v[140:143]
  v_cvt_pk_bf16_f32 v22, v228, v229
  v_cvt_pk_bf16_f32 v23, v230, v231
  v_mfma_f32_16x16x32_bf16 v[144:147], v[124:127], a[112:115], v[144:147]
  v_mul_f32 v192, v244, v53
  v_mul_f32 v193, v245, v53
  v_mfma_f32_16x16x32_bf16 v[148:151], v[124:127], a[116:119], v[148:151]
  v_mfma_f32_16x16x32_bf16 v[152:155], v[124:127], a[120:123], v[152:155]
  s_add_u32 s56, s71, 0
  buffer_load_dwordx4 v[112:115], v1, s[36:39], s56 offen offset:0 sc1
  v_mfma_f32_16x16x32_bf16 v[156:159], v[124:127], a[124:127], v[156:159]
  buffer_load_dwordx4 v[116:119], v61, s[36:39], s56 offen offset:0 sc1
  s_waitcnt vmcnt(12)
  v_mfma_f32_16x16x32_bf16 v[128:131], v[64:67], a[128:131], v[128:131]
  v_mul_f32 v194, v246, v53
  v_mul_f32 v195, v247, v53
  v_mfma_f32_16x16x32_bf16 v[132:135], v[64:67], a[132:135], v[132:135]
  v_mul_f32 v196, v244, v57
  v_mul_f32 v197, v245, v57
  v_mfma_f32_16x16x32_bf16 v[136:139], v[64:67], a[136:139], v[136:139]
  v_mul_f32 v198, v246, v57
  v_mul_f32 v199, v247, v57
  v_mfma_f32_16x16x32_bf16 v[140:143], v[64:67], a[140:143], v[140:143]
  v_fma_f32 v220, v220, v52, v192
  v_fma_f32 v221, v221, v52, v193
  v_mfma_f32_16x16x32_bf16 v[144:147], v[68:71], a[128:131], v[144:147]
  v_fma_f32 v222, v222, v52, v194
  v_fma_f32 v223, v223, v52, v195
  v_mfma_f32_16x16x32_bf16 v[148:151], v[68:71], a[132:135], v[148:151]
  v_mfma_f32_16x16x32_bf16 v[152:155], v[68:71], a[136:139], v[152:155]
  buffer_load_dwordx4 v[120:123], v1, s[36:39], s56 offen offset:1024 sc1
  v_mfma_f32_16x16x32_bf16 v[156:159], v[68:71], a[140:143], v[156:159]
  buffer_load_dwordx4 v[124:127], v61, s[36:39], s56 offen offset:1024 sc1
  s_waitcnt vmcnt(12)
  v_mfma_f32_16x16x32_bf16 v[128:131], v[72:75], a[144:147], v[128:131]
  v_fma_f32 v232, v232, v56, v196
  v_fma_f32 v233, v233, v56, v197
  v_mfma_f32_16x16x32_bf16 v[132:135], v[72:75], a[148:151], v[132:135]
  v_fma_f32 v234, v234, v56, v198
  v_fma_f32 v235, v235, v56, v199
  v_mfma_f32_16x16x32_bf16 v[136:139], v[72:75], a[152:155], v[136:139]
  v_mul_f32 v192, v220, v220
  v_mul_f32 v193, v221, v221
  v_mfma_f32_16x16x32_bf16 v[140:143], v[72:75], a[156:159], v[140:143]
  v_mul_f32 v194, v222, v222
  v_mul_f32 v195, v223, v223
  v_mfma_f32_16x16x32_bf16 v[144:147], v[76:79], a[144:147], v[144:147]
  v_mul_f32 v196, v232, v232
  v_mul_f32 v197, v233, v233
  v_mfma_f32_16x16x32_bf16 v[148:151], v[76:79], a[148:151], v[148:151]
  v_mfma_f32_16x16x32_bf16 v[152:155], v[76:79], a[152:155], v[152:155]
  s_add_u32 s56, s64, 131072
  buffer_load_dwordx4 v[64:67], v1, s[36:39], s56 offen offset:0 sc1
  v_mfma_f32_16x16x32_bf16 v[156:159], v[76:79], a[156:159], v[156:159]
  buffer_load_dwordx4 v[68:71], v61, s[36:39], s56 offen offset:0 sc1
  s_waitcnt vmcnt(12)
  v_mfma_f32_16x16x32_bf16 v[128:131], v[80:83], a[160:163], v[128:131]
  v_mul_f32 v198, v234, v234
  v_mul_f32 v199, v235, v235
  v_mfma_f32_16x16x32_bf16 v[132:135], v[80:83], a[164:167], v[132:135]
  v_fma_f32 v192, v192, s86, v58
  v_fma_f32 v193, v193, s86, v58
  v_mfma_f32_16x16x32_bf16 v[136:139], v[80:83], a[168:171], v[136:139]
  v_fma_f32 v194, v194, s86, v58
  v_fma_f32 v195, v195, s86, v58
  v_mfma_f32_16x16x32_bf16 v[140:143], v[80:83], a[172:175], v[140:143]
  v_fma_f32 v196, v196, s86, v58
  v_fma_f32 v197, v197, s86, v58
  v_mfma_f32_16x16x32_bf16 v[144:147], v[84:87], a[160:163], v[144:147]
  v_fma_f32 v198, v198, s86, v58
  v_mfma_f32_16x16x32_bf16 v[148:151], v[84:87], a[164:167], v[148:151]
  v_mfma_f32_16x16x32_bf16 v[152:155], v[84:87], a[168:171], v[152:155]
  buffer_load_dwordx4 v[72:75], v1, s[36:39], s56 offen offset:1024 sc1
  v_mfma_f32_16x16x32_bf16 v[156:159], v[84:87], a[172:175], v[156:159]
  buffer_load_dwordx4 v[76:79], v61, s[36:39], s56 offen offset:1024 sc1
  s_waitcnt vmcnt(12)
  v_mfma_f32_16x16x32_bf16 v[128:131], v[88:91], a[176:179], v[128:131]
  v_fma_f32 v199, v199, s86, v58
  v_mul_f32 v192, v192, v220
  v_mfma_f32_16x16x32_bf16 v[132:135], v[88:91], a[180:183], v[132:135]
  v_mul_f32 v193, v193, v221
  v_mul_f32 v194, v194, v222
  v_mfma_f32_16x16x32_bf16 v[136:139], v[88:91], a[184:187], v[136:139]
  v_mul_f32 v195, v195, v223
  v_mul_f32 v196, v196, v232
  v_mfma_f32_16x16x32_bf16 v[140:143], v[88:91], a[188:191], v[140:143]
  v_mul_f32 v197, v197, v233
  v_mul_f32 v198, v198, v234
  v_mfma_f32_16x16x32_bf16 v[144:147], v[92:95], a[176:179], v[144:147]
  v_mul_f32 v199, v199, v235
  v_mfma_f32_16x16x32_bf16 v[148:151], v[92:95], a[180:183], v[148:151]
  v_mfma_f32_16x16x32_bf16 v[152:155], v[92:95], a[184:187], v[152:155]
  s_add_u32 s56, s65, 131072
  buffer_load_dwordx4 v[80:83], v1, s[36:39], s56 offen offset:0 sc1
  v_mfma_f32_16x16x32_bf16 v[156:159], v[92:95], a[188:191], v[156:159]
  buffer_load_dwordx4 v[84:87], v61, s[36:39], s56 offen offset:0 sc1
  s_waitcnt vmcnt(12)
  v_mfma_f32_16x16x32_bf16 v[128:131], v[96:99], a[192:195], v[128:131]
  v_exp_f32 v192, v192
  v_exp_f32 v193, v193
  v_mfma_f32_16x16x32_bf16 v[132:135], v[96:99], a[196:199], v[132:135]
  v_exp_f32 v194, v194
  v_exp_f32 v195, v195
  v_mfma_f32_16x16x32_bf16 v[136:139], v[96:99], a[200:203], v[136:139]
  v_exp_f32 v196, v196
  v_exp_f32 v197, v197
  v_mfma_f32_16x16x32_bf16 v[140:143], v[96:99], a[204:207], v[140:143]
  v_exp_f32 v198, v198
  v_exp_f32 v199, v199
  v_mfma_f32_16x16x32_bf16 v[144:147], v[100:103], a[192:195], v[144:147]
  v_add_f32 v192, 1.0, v192
  v_mfma_f32_16x16x32_bf16 v[148:151], v[100:103], a[196:199], v[148:151]
  v_mfma_f32_16x16x32_bf16 v[152:155], v[100:103], a[200:203], v[152:155]
  buffer_load_dwordx4 v[88:91], v1, s[36:39], s56 offen offset:1024 sc1
  v_mfma_f32_16x16x32_bf16 v[156:159], v[100:103], a[204:207], v[156:159]
  buffer_load_dwordx4 v[92:95], v61, s[36:39], s56 offen offset:1024 sc1
  s_waitcnt vmcnt(12)
  v_mfma_f32_16x16x32_bf16 v[128:131], v[104:107], a[208:211], v[128:131]
  v_add_f32 v193, 1.0, v193
  v_add_f32 v194, 1.0, v194
  v_mfma_f32_16x16x32_bf16 v[132:135], v[104:107], a[212:215], v[132:135]
  v_add_f32 v195, 1.0, v195
  v_add_f32 v196, 1.0, v196
  v_mfma_f32_16x16x32_bf16 v[136:139], v[104:107], a[216:219], v[136:139]
  v_add_f32 v197, 1.0, v197
  v_add_f32 v198, 1.0, v198
  v_mfma_f32_16x16x32_bf16 v[140:143], v[104:107], a[220:223], v[140:143]
  v_add_f32 v199, 1.0, v199
  v_rcp_f32 v192, v192
  v_mfma_f32_16x16x32_bf16 v[144:147], v[108:111], a[208:211], v[144:147]
  v_rcp_f32 v193, v193
  v_mfma_f32_16x16x32_bf16 v[148:151], v[108:111], a[212:215], v[148:151]
  v_mfma_f32_16x16x32_bf16 v[152:155], v[108:111], a[216:219], v[152:155]
  s_add_u32 s56, s66, 131072
  buffer_load_dwordx4 v[96:99], v1, s[36:39], s56 offen offset:0 sc1
  v_mfma_f32_16x16x32_bf16 v[156:159], v[108:111], a[220:223], v[156:159]
  buffer_load_dwordx4 v[100:103], v61, s[36:39], s56 offen offset:0 sc1
  s_waitcnt vmcnt(12)
  v_mfma_f32_16x16x32_bf16 v[128:131], v[112:115], a[224:227], v[128:131]
  v_rcp_f32 v194, v194
  v_rcp_f32 v195, v195
  v_mfma_f32_16x16x32_bf16 v[132:135], v[112:115], a[228:231], v[132:135]
  v_rcp_f32 v196, v196
  v_rcp_f32 v197, v197
  v_mfma_f32_16x16x32_bf16 v[136:139], v[112:115], a[232:235], v[136:139]
  v_rcp_f32 v198, v198
  v_rcp_f32 v199, v199
  v_mfma_f32_16x16x32_bf16 v[140:143], v[112:115], a[236:239], v[140:143]
  v_mul_f32 v220, v220, v192
  v_mul_f32 v221, v221, v193
  v_mfma_f32_16x16x32_bf16 v[144:147], v[116:119], a[224:227], v[144:147]
  v_mul_f32 v222, v222, v194
  v_mfma_f32_16x16x32_bf16 v[148:151], v[116:119], a[228:231], v[148:151]
  v_mfma_f32_16x16x32_bf16 v[152:155], v[116:119], a[232:235], v[152:155]
  buffer_load_dwordx4 v[104:107], v1, s[36:39], s56 offen offset:1024 sc1
  v_mfma_f32_16x16x32_bf16 v[156:159], v[116:119], a[236:239], v[156:159]
  buffer_load_dwordx4 v[108:111], v61, s[36:39], s56 offen offset:1024 sc1
  s_waitcnt vmcnt(12)
  v_mfma_f32_16x16x32_bf16 v[128:131], v[120:123], a[240:243], v[128:131]
  v_mul_f32 v223, v223, v195
  v_mul_f32 v232, v232, v196
  v_mfma_f32_16x16x32_bf16 v[132:135], v[120:123], a[244:247], v[132:135]
  v_mul_f32 v233, v233, v197
  v_mul_f32 v234, v234, v198
  v_mfma_f32_16x16x32_bf16 v[136:139], v[120:123], a[248:251], v[136:139]
  v_mul_f32 v235, v235, v199
  v_cvt_pk_bf16_f32 v18, v220, v221
  v_mfma_f32_16x16x32_bf16 v[140:143], v[120:123], a[252:255], v[140:143]
  v_cvt_pk_bf16_f32 v19, v222, v223
  v_cvt_pk_bf16_f32 v24, v232, v233
  v_mfma_f32_16x16x32_bf16 v[144:147], v[124:127], a[240:243], v[144:147]
  v_cvt_pk_bf16_f32 v25, v234, v235
  s_barrier
  v_mfma_f32_16x16x32_bf16 v[148:151], v[124:127], a[244:247], v[148:151]
  v_mfma_f32_16x16x32_bf16 v[152:155], v[124:127], a[248:251], v[152:155]
  s_add_u32 s56, s67, 131072
  buffer_load_dwordx4 v[112:115], v1, s[36:39], s56 offen offset:0 sc1
  v_mfma_f32_16x16x32_bf16 v[156:159], v[124:127], a[252:255], v[156:159]
  buffer_load_dwordx4 v[116:119], v61, s[36:39], s56 offen offset:0 sc1
  s_waitcnt vmcnt(12)
  v_mfma_f32_16x16x32_bf16 v[160:163], v[64:67], a[0:3], 0
  ds_write_b128 v54, v[128:131] offset:0
  v_mul_f32 v192, v248, v53
  v_mfma_f32_16x16x32_bf16 v[164:167], v[64:67], a[4:7], 0
  v_mul_f32 v193, v249, v53
  v_mul_f32 v194, v250, v53
  v_mfma_f32_16x16x32_bf16 v[168:171], v[64:67], a[8:11], 0
  v_mul_f32 v195, v251, v53
  v_mul_f32 v196, v248, v57
  v_mfma_f32_16x16x32_bf16 v[172:175], v[64:67], a[12:15], 0
  v_mul_f32 v197, v249, v57
  v_mul_f32 v198, v250, v57
  v_mfma_f32_16x16x32_bf16 v[176:179], v[68:71], a[0:3], 0
  v_mfma_f32_16x16x32_bf16 v[180:183], v[68:71], a[4:7], 0
  v_mfma_f32_16x16x32_bf16 v[184:187], v[68:71], a[8:11], 0
  buffer_load_dwordx4 v[120:123], v1, s[36:39], s56 offen offset:1024 sc1
  v_mfma_f32_16x16x32_bf16 v[188:191], v[68:71], a[12:15], 0
  buffer_load_dwordx4 v[124:127], v61, s[36:39], s56 offen offset:1024 sc1
  s_waitcnt vmcnt(12)
  v_mfma_f32_16x16x32_bf16 v[160:163], v[72:75], a[16:19], v[160:163]
  ds_write_b128 v54, v[132:135] offset:1024
  v_mul_f32 v199, v251, v57
  v_mfma_f32_16x16x32_bf16 v[164:167], v[72:75], a[20:23], v[164:167]
  v_fma_f32 v224, v224, v52, v192
  v_fma_f32 v225, v225, v52, v193
  v_mfma_f32_16x16x32_bf16 v[168:171], v[72:75], a[24:27], v[168:171]
  v_fma_f32 v226, v226, v52, v194
  v_fma_f32 v227, v227, v52, v195
  v_mfma_f32_16x16x32_bf16 v[172:175], v[72:75], a[28:31], v[172:175]
  v_fma_f32 v236, v236, v56, v196
  v_fma_f32 v237, v237, v56, v197
  v_mfma_f32_16x16x32_bf16 v[176:179], v[76:79], a[16:19], v[176:179]
  v_mfma_f32_16x16x32_bf16 v[180:183], v[76:79], a[20:23], v[180:183]
  v_mfma_f32_16x16x32_bf16 v[184:187], v[76:79], a[24:27], v[184:187]
  s_add_u32 s56, s68, 131072
  buffer_load_dwordx4 v[64:67], v1, s[36:39], s56 offen offset:0 sc1
  v_mfma_f32_16x16x32_bf16 v[188:191], v[76:79], a[28:31], v[188:191]
  buffer_load_dwordx4 v[68:71], v61, s[36:39], s56 offen offset:0 sc1
  s_waitcnt vmcnt(12)
  v_mfma_f32_16x16x32_bf16 v[160:163], v[80:83], a[32:35], v[160:163]
  ds_write_b128 v54, v[136:139] offset:2048
  v_fma_f32 v238, v238, v56, v198
  v_mfma_f32_16x16x32_bf16 v[164:167], v[80:83], a[36:39], v[164:167]
  v_fma_f32 v239, v239, v56, v199
  v_mul_f32 v192, v224, v224
  v_mfma_f32_16x16x32_bf16 v[168:171], v[80:83], a[40:43], v[168:171]
  v_mul_f32 v193, v225, v225
  v_mul_f32 v194, v226, v226
  v_mfma_f32_16x16x32_bf16 v[172:175], v[80:83], a[44:47], v[172:175]
  v_mul_f32 v195, v227, v227
  v_mul_f32 v196, v236, v236
  v_mfma_f32_16x16x32_bf16 v[176:179], v[84:87], a[32:35], v[176:179]
  v_mfma_f32_16x16x32_bf16 v[180:183], v[84:87], a[36:39], v[180:183]
  v_mfma_f32_16x16x32_bf16 v[184:187], v[84:87], a[40:43], v[184:187]
  buffer_load_dwordx4 v[72:75], v1, s[36:39], s56 offen offset:1024 sc1
  v_mfma_f32_16x16x32_bf16 v[188:191], v[84:87], a[44:47], v[188:191]
  buffer_load_dwordx4 v[76:79], v61, s[36:39], s56 offen offset:1024 sc1
  s_waitcnt vmcnt(12)
  v_mfma_f32_16x16x32_bf16 v[160:163], v[88:91], a[48:51], v[160:163]
  ds_write_b128 v54, v[140:143] offset:3072
  v_mul_f32 v197, v237, v237
  v_mfma_f32_16x16x32_bf16 v[164:167], v[88:91], a[52:55], v[164:167]
  v_mul_f32 v198, v238, v238
  v_mul_f32 v199, v239, v239
  v_mfma_f32_16x16x32_bf16 v[168:171], v[88:91], a[56:59], v[168:171]
  v_fma_f32 v192, v192, s86, v58
  v_fma_f32 v193, v193, s86, v58
  v_mfma_f32_16x16x32_bf16 v[172:175], v[88:91], a[60:63], v[172:175]
  v_fma_f32 v194, v194, s86, v58
  v_fma_f32 v195, v195, s86, v58
  v_mfma_f32_16x16x32_bf16 v[176:179], v[92:95], a[48:51], v[176:179]
  v_mfma_f32_16x16x32_bf16 v[180:183], v[92:95], a[52:55], v[180:183]
  v_mfma_f32_16x16x32_bf16 v[184:187], v[92:95], a[56:59], v[184:187]
  s_add_u32 s56, s69, 131072
  buffer_load_dwordx4 v[80:83], v1, s[36:39], s56 offen offset:0 sc1
  v_mfma_f32_16x16x32_bf16 v[188:191], v[92:95], a[60:63], v[188:191]
  buffer_load_dwordx4 v[84:87], v61, s[36:39], s56 offen offset:0 sc1
  s_waitcnt vmcnt(12)
  v_mfma_f32_16x16x32_bf16 v[160:163], v[96:99], a[64:67], v[160:163]
  ds_write_b128 v54, v[144:147] offset:4096
  v_fma_f32 v196, v196, s86, v58
  v_mfma_f32_16x16x32_bf16 v[164:167], v[96:99], a[68:71], v[164:167]
  v_fma_f32 v197, v197, s86, v58
  v_fma_f32 v198, v198, s86, v58
  v_mfma_f32_16x16x32_bf16 v[168:171], v[96:99], a[72:75], v[168:171]
  v_fma_f32 v199, v199, s86, v58
  v_mul_f32 v192, v192, v224
  v_mfma_f32_16x16x32_bf16 v[172:175], v[96:99], a[76:79], v[172:175]
  v_mul_f32 v193, v193, v225
  v_mul_f32 v194, v194, v226
  v_mfma_f32_16x16x32_bf16 v[176:179], v[100:103], a[64:67], v[176:179]
  v_mfma_f32_16x16x32_bf16 v[180:183], v[100:103], a[68:71], v[180:183]
  v_mfma_f32_16x16x32_bf16 v[184:187], v[100:103], a[72:75], v[184:187]
  buffer_load_dwordx4 v[88:91], v1, s[36:39], s56 offen offset:1024 sc1
  v_mfma_f32_16x16x32_bf16 v[188:191], v[100:103], a[76:79], v[188:191]
  buffer_load_dwordx4 v[92:95], v61, s[36:39], s56 offen offset:1024 sc1
  s_waitcnt vmcnt(12)
  v_mfma_f32_16x16x32_bf16 v[160:163], v[104:107], a[80:83], v[160:163]
  ds_write_b128 v54, v[148:151] offset:5120
  v_mul_f32 v195, v195, v227
  v_mfma_f32_16x16x32_bf16 v[164:167], v[104:107], a[84:87], v[164:167]
  v_mul_f32 v196, v196, v236
  v_mul_f32 v197, v197, v237
  v_mfma_f32_16x16x32_bf16 v[168:171], v[104:107], a[88:91], v[168:171]
  v_mul_f32 v198, v198, v238
  v_mul_f32 v199, v199, v239
  v_mfma_f32_16x16x32_bf16 v[172:175], v[104:107], a[92:95], v[172:175]
  v_exp_f32 v192, v192
  v_exp_f32 v193, v193
  v_mfma_f32_16x16x32_bf16 v[176:179], v[108:111], a[80:83], v[176:179]
  v_mfma_f32_16x16x32_bf16 v[180:183], v[108:111], a[84:87], v[180:183]
  v_mfma_f32_16x16x32_bf16 v[184:187], v[108:111], a[88:91], v[184:187]
  s_add_u32 s56, s70, 131072
  buffer_load_dwordx4 v[96:99], v1, s[36:39], s56 offen offset:0 sc1
  v_mfma_f32_16x16x32_bf16 v[188:191], v[108:111], a[92:95], v[188:191]
  buffer_load_dwordx4 v[100:103], v61, s[36:39], s56 offen offset:0 sc1
  s_waitcnt vmcnt(12)
  v_mfma_f32_16x16x32_bf16 v[160:163], v[112:115], a[96:99], v[160:163]
  ds_write_b128 v54, v[152:155] offset:6144
  v_exp_f32 v194, v194
  v_mfma_f32_16x16x32_bf16 v[164:167], v[112:115], a[100:103], v[164:167]
  v_exp_f32 v195, v195
  v_exp_f32 v196, v196
  v_mfma_f32_16x16x32_bf16 v[168:171], v[112:115], a[104:107], v[168:171]
  v_exp_f32 v197, v197
  v_exp_f32 v198, v198
  v_mfma_f32_16x16x32_bf16 v[172:175], v[112:115], a[108:111], v[172:175]
  v_exp_f32 v199, v199
  v_add_f32 v192, 1.0, v192
  v_mfma_f32_16x16x32_bf16 v[176:179], v[116:119], a[96:99], v[176:179]
  v_mfma_f32_16x16x32_bf16 v[180:183], v[116:119], a[100:103], v[180:183]
  v_mfma_f32_16x16x32_bf16 v[184:187], v[116:119], a[104:107], v[184:187]
  buffer_load_dwordx4 v[104:107], v1, s[36:39], s56 offen offset:1024 sc1
  v_mfma_f32_16x16x32_bf16 v[188:191], v[116:119], a[108:111], v[188:191]
  buffer_load_dwordx4 v[108:111], v61, s[36:39], s56 offen offset:1024 sc1
  s_waitcnt vmcnt(12)
  v_mfma_f32_16x16x32_bf16 v[160:163], v[120:123], a[112:115], v[160:163]
  ds_write_b128 v54, v[156:159] offset:7168
  v_add_f32 v193, 1.0, v193
  v_mfma_f32_16x16x32_bf16 v[164:167], v[120:123], a[116:119], v[164:167]
  v_add_f32 v194, 1.0, v194
  v_add_f32 v195, 1.0, v195
  v_mfma_f32_16x16x32_bf16 v[168:171], v[120:123], a[120:123], v[168:171]
  v_add_f32 v196, 1.0, v196
  v_add_f32 v197, 1.0, v197
  v_mfma_f32_16x16x32_bf16 v[172:175], v[120:123], a[124:127], v[172:175]
  v_add_f32 v198, 1.0, v198
  v_add_f32 v199, 1.0, v199
  v_mfma_f32_16x16x32_bf16 v[176:179], v[124:127], a[112:115], v[176:179]
  v_mfma_f32_16x16x32_bf16 v[180:183], v[124:127], a[116:119], v[180:183]
  v_mfma_f32_16x16x32_bf16 v[184:187], v[124:127], a[120:123], v[184:187]
  s_add_u32 s56, s71, 131072
  buffer_load_dwordx4 v[112:115], v1, s[36:39], s56 offen offset:0 sc1
  v_mfma_f32_16x16x32_bf16 v[188:191], v[124:127], a[124:127], v[188:191]
  buffer_load_dwordx4 v[116:119], v61, s[36:39], s56 offen offset:0 sc1
  s_waitcnt vmcnt(12)
  v_mfma_f32_16x16x32_bf16 v[160:163], v[64:67], a[128:131], v[160:163]
  s_waitcnt lgkmcnt(0)
  s_barrier
  v_mfma_f32_16x16x32_bf16 v[164:167], v[64:67], a[132:135], v[164:167]
  v_rcp_f32 v192, v192
  v_rcp_f32 v193, v193
  v_mfma_f32_16x16x32_bf16 v[168:171], v[64:67], a[136:139], v[168:171]
  v_rcp_f32 v194, v194
  v_rcp_f32 v195, v195
  v_mfma_f32_16x16x32_bf16 v[172:175], v[64:67], a[140:143], v[172:175]
  v_rcp_f32 v196, v196
  v_rcp_f32 v197, v197
  v_mfma_f32_16x16x32_bf16 v[176:179], v[68:71], a[128:131], v[176:179]
  v_rcp_f32 v198, v198
  v_mfma_f32_16x16x32_bf16 v[180:183], v[68:71], a[132:135], v[180:183]
  v_mfma_f32_16x16x32_bf16 v[184:187], v[68:71], a[136:139], v[184:187]
  buffer_load_dwordx4 v[120:123], v1, s[36:39], s56 offen offset:1024 sc1
  v_mfma_f32_16x16x32_bf16 v[188:191], v[68:71], a[140:143], v[188:191]
  buffer_load_dwordx4 v[124:127], v61, s[36:39], s56 offen offset:1024 sc1
  s_waitcnt vmcnt(12)
  v_mfma_f32_16x16x32_bf16 v[160:163], v[72:75], a[144:147], v[160:163]
  ds_read_b128 v[28:31], v55 offset:0
  ds_read_b128 v[32:35], v55 offset:1024
  v_mfma_f32_16x16x32_bf16 v[164:167], v[72:75], a[148:151], v[164:167]
  ds_read_b128 v[36:39], v55 offset:8192
  ds_read_b128 v[40:43], v55 offset:9216
  v_mfma_f32_16x16x32_bf16 v[168:171], v[72:75], a[152:155], v[168:171]
  ds_read_b128 v[44:47], v55 offset:16384
  ds_read_b128 v[48:51], v55 offset:17408
  v_mfma_f32_16x16x32_bf16 v[172:175], v[72:75], a[156:159], v[172:175]
  ds_read_b128 v[128:131], v55 offset:24576
  ds_read_b128 v[132:135], v55 offset:25600
  v_mfma_f32_16x16x32_bf16 v[176:179], v[76:79], a[144:147], v[176:179]
  v_rcp_f32 v199, v199
  v_mul_f32 v224, v224, v192
  v_mfma_f32_16x16x32_bf16 v[180:183], v[76:79], a[148:151], v[180:183]
  v_mul_f32 v225, v225, v193
  v_mul_f32 v226, v226, v194
  v_mul_f32 v227, v227, v195
  v_mul_f32 v236, v236, v196
  v_mul_f32 v237, v237, v197
  v_mfma_f32_16x16x32_bf16 v[184:187], v[76:79], a[152:155], v[184:187]
  s_add_u32 s56, s64, 262144
  buffer_load_dwordx4 v[64:67], v1, s[36:39], s56 offen offset:0 sc1
  v_mfma_f32_16x16x32_bf16 v[188:191], v[76:79], a[156:159], v[188:191]
  buffer_load_dwordx4 v[68:71], v61, s[36:39], s56 offen offset:0 sc1
  s_waitcnt vmcnt(12)
  v_mfma_f32_16x16x32_bf16 v[160:163], v[80:83], a[160:163], v[160:163]
  v_mul_f32 v238, v238, v198
  v_mul_f32 v239, v239, v199
  v_mfma_f32_16x16x32_bf16 v[164:167], v[80:83], a[164:167], v[164:167]
  v_cvt_pk_bf16_f32 v20, v224, v225
  v_cvt_pk_bf16_f32 v21, v226, v227
  v_mfma_f32_16x16x32_bf16 v[168:171], v[80:83], a[168:171], v[168:171]
  v_cvt_pk_bf16_f32 v26, v236, v237
  v_cvt_pk_bf16_f32 v27, v238, v239
  v_mfma_f32_16x16x32_bf16 v[172:175], v[80:83], a[172:175], v[172:175]
  v_mfma_f32_16x16x32_bf16 v[176:179], v[84:87], a[160:163], v[176:179]
  v_mfma_f32_16x16x32_bf16 v[180:183], v[84:87], a[164:167], v[180:183]
  v_mfma_f32_16x16x32_bf16 v[184:187], v[84:87], a[168:171], v[184:187]
  buffer_load_dwordx4 v[72:75], v1, s[36:39], s56 offen offset:1024 sc1
  v_mfma_f32_16x16x32_bf16 v[188:191], v[84:87], a[172:175], v[188:191]
  buffer_load_dwordx4 v[76:79], v61, s[36:39], s56 offen offset:1024 sc1
  s_waitcnt vmcnt(12)
  v_mfma_f32_16x16x32_bf16 v[160:163], v[88:91], a[176:179], v[160:163]
  s_waitcnt lgkmcnt(0)
  v_add_f32 v128, v128, v28
  v_mfma_f32_16x16x32_bf16 v[164:167], v[88:91], a[180:183], v[164:167]
  v_add_f32 v129, v129, v29
  v_add_f32 v130, v130, v30
  v_mfma_f32_16x16x32_bf16 v[168:171], v[88:91], a[184:187], v[168:171]
  v_add_f32 v131, v131, v31
  v_add_f32 v132, v132, v32
  v_mfma_f32_16x16x32_bf16 v[172:175], v[88:91], a[188:191], v[172:175]
  v_add_f32 v133, v133, v33
  v_add_f32 v134, v134, v34
  v_mfma_f32_16x16x32_bf16 v[176:179], v[92:95], a[176:179], v[176:179]
  v_add_f32 v135, v135, v35
  v_add_f32 v36, v36, v44
  v_mfma_f32_16x16x32_bf16 v[180:183], v[92:95], a[180:183], v[180:183]
  v_add_f32 v37, v37, v45
  v_add_f32 v38, v38, v46
  v_mfma_f32_16x16x32_bf16 v[184:187], v[92:95], a[184:187], v[184:187]
  s_add_u32 s56, s65, 262144
  buffer_load_dwordx4 v[80:83], v1, s[36:39], s56 offen offset:0 sc1
  v_mfma_f32_16x16x32_bf16 v[188:191], v[92:95], a[188:191], v[188:191]
  buffer_load_dwordx4 v[84:87], v61, s[36:39], s56 offen offset:0 sc1
  s_waitcnt vmcnt(12)
  v_mfma_f32_16x16x32_bf16 v[160:163], v[96:99], a[192:195], v[160:163]
  v_add_f32 v39, v39, v47
  v_add_f32 v40, v40, v48
  v_mfma_f32_16x16x32_bf16 v[164:167], v[96:99], a[196:199], v[164:167]
  v_add_f32 v41, v41, v49
  v_add_f32 v42, v42, v50
  v_mfma_f32_16x16x32_bf16 v[168:171], v[96:99], a[200:203], v[168:171]
  v_add_f32 v43, v43, v51
  v_add_f32 v128, v128, v62
  v_mfma_f32_16x16x32_bf16 v[172:175], v[96:99], a[204:207], v[172:175]
  v_add_f32 v129, v129, v62
  v_add_f32 v130, v130, v62
  v_mfma_f32_16x16x32_bf16 v[176:179], v[100:103], a[192:195], v[176:179]
  v_add_f32 v131, v131, v62
  v_add_f32 v132, v132, v63
  v_mfma_f32_16x16x32_bf16 v[180:183], v[100:103], a[196:199], v[180:183]
  v_add_f32 v133, v133, v63
  v_mfma_f32_16x16x32_bf16 v[184:187], v[100:103], a[200:203], v[184:187]
  buffer_load_dwordx4 v[88:91], v1, s[36:39], s56 offen offset:1024 sc1
  v_mfma_f32_16x16x32_bf16 v[188:191], v[100:103], a[204:207], v[188:191]
  buffer_load_dwordx4 v[92:95], v61, s[36:39], s56 offen offset:1024 sc1
  s_waitcnt vmcnt(12)
  v_mfma_f32_16x16x32_bf16 v[160:163], v[104:107], a[208:211], v[160:163]
  v_add_f32 v134, v134, v63
  v_add_f32 v135, v135, v63
  v_mfma_f32_16x16x32_bf16 v[164:167], v[104:107], a[212:215], v[164:167]
  v_lshlrev_b32 v28, 16, v16
  v_and_b32 v29, s53, v16
  v_mfma_f32_16x16x32_bf16 v[168:171], v[104:107], a[216:219], v[168:171]
  v_lshlrev_b32 v30, 16, v17
  v_and_b32 v31, s53, v17
  v_mfma_f32_16x16x32_bf16 v[172:175], v[104:107], a[220:223], v[172:175]
  v_lshlrev_b32 v32, 16, v22
  v_and_b32 v33, s53, v22
  v_mfma_f32_16x16x32_bf16 v[176:179], v[108:111], a[208:211], v[176:179]
  v_lshlrev_b32 v34, 16, v23
  v_and_b32 v35, s53, v23
  v_mfma_f32_16x16x32_bf16 v[180:183], v[108:111], a[212:215], v[180:183]
  v_add_f32 v128, v128, v36
  v_mfma_f32_16x16x32_bf16 v[184:187], v[108:111], a[216:219], v[184:187]
  s_add_u32 s56, s66, 262144
  buffer_load_dwordx4 v[96:99], v1, s[36:39], s56 offen offset:0 sc1
  v_mfma_f32_16x16x32_bf16 v[188:191], v[108:111], a[220:223], v[188:191]
  buffer_load_dwordx4 v[100:103], v61, s[36:39], s56 offen offset:0 sc1
  s_waitcnt vmcnt(12)
  v_mfma_f32_16x16x32_bf16 v[160:163], v[112:115], a[224:227], v[160:163]
  v_add_f32 v129, v129, v37
  v_add_f32 v130, v130, v38
  v_mfma_f32_16x16x32_bf16 v[164:167], v[112:115], a[228:231], v[164:167]
  v_add_f32 v131, v131, v39
  v_add_f32 v132, v132, v40
  v_mfma_f32_16x16x32_bf16 v[168:171], v[112:115], a[232:235], v[168:171]
  v_add_f32 v133, v133, v41
  v_add_f32 v134, v134, v42
  v_mfma_f32_16x16x32_bf16 v[172:175], v[112:115], a[236:239], v[172:175]
  v_add_f32 v135, v135, v43
  v_mul_f32 v128, v128, v28
  v_mfma_f32_16x16x32_bf16 v[176:179], v[116:119], a[224:227], v[176:179]
  v_mul_f32 v129, v129, v29
  v_mul_f32 v130, v130, v30
  v_mfma_f32_16x16x32_bf16 v[180:183], v[116:119], a[228:231], v[180:183]
  v_mul_f32 v131, v131, v31
  v_mfma_f32_16x16x32_bf16 v[184:187], v[116:119], a[232:235], v[184:187]
  buffer_load_dwordx4 v[104:107], v1, s[36:39], s56 offen offset:1024 sc1
  v_mfma_f32_16x16x32_bf16 v[188:191], v[116:119], a[236:239], v[188:191]
  buffer_load_dwordx4 v[108:111], v61, s[36:39], s56 offen offset:1024 sc1
  s_waitcnt vmcnt(12)
  v_mfma_f32_16x16x32_bf16 v[160:163], v[120:123], a[240:243], v[160:163]
  v_mul_f32 v132, v132, v32
  v_mul_f32 v133, v133, v33
  v_mfma_f32_16x16x32_bf16 v[164:167], v[120:123], a[244:247], v[164:167]
  v_mul_f32 v134, v134, v34
  v_mul_f32 v135, v135, v35
  v_mfma_f32_16x16x32_bf16 v[168:171], v[120:123], a[248:251], v[168:171]
  v_cvt_pk_bf16_f32 v28, v128, v129
  v_cvt_pk_bf16_f32 v29, v130, v131
  v_mfma_f32_16x16x32_bf16 v[172:175], v[120:123], a[252:255], v[172:175]
  v_cvt_pk_bf16_f32 v30, v132, v133
  v_cvt_pk_bf16_f32 v31, v134, v135
  v_mfma_f32_16x16x32_bf16 v[176:179], v[124:127], a[240:243], v[176:179]
  buffer_store_dwordx2 v[28:29], v2, s[36:39], s81 offen offset:0 sc1
  buffer_store_dwordx2 v[30:31], v2, s[36:39], s82 offen offset:0 sc1
  v_mfma_f32_16x16x32_bf16 v[180:183], v[124:127], a[244:247], v[180:183]
  v_mfma_f32_16x16x32_bf16 v[184:187], v[124:127], a[248:251], v[184:187]
  s_add_u32 s56, s67, 262144
  buffer_load_dwordx4 v[112:115], v1, s[36:39], s56 offen offset:0 sc1
  v_mfma_f32_16x16x32_bf16 v[188:191], v[124:127], a[252:255], v[188:191]
  buffer_load_dwordx4 v[116:119], v61, s[36:39], s56 offen offset:0 sc1
  s_waitcnt vmcnt(14)
  v_mfma_f32_16x16x32_bf16 v[128:131], v[64:67], a[0:3], 0
  ds_write_b128 v54, v[160:163] offset:32768
  ds_read_b64_tr_b16 v[200:201], v59 offset:0
  v_mfma_f32_16x16x32_bf16 v[132:135], v[64:67], a[4:7], 0
  ds_read_b64_tr_b16 v[202:203], v59 offset:512
  ds_read_b64_tr_b16 v[224:225], v60 offset:0
  v_mfma_f32_16x16x32_bf16 v[136:139], v[64:67], a[8:11], 0
  v_mfma_f32_16x16x32_bf16 v[140:143], v[64:67], a[12:15], 0
  v_mfma_f32_16x16x32_bf16 v[144:147], v[68:71], a[0:3], 0
  v_mfma_f32_16x16x32_bf16 v[148:151], v[68:71], a[4:7], 0
  v_mfma_f32_16x16x32_bf16 v[152:155], v[68:71], a[8:11], 0
  buffer_load_dwordx4 v[120:123], v1, s[36:39], s56 offen offset:1024 sc1
  v_mfma_f32_16x16x32_bf16 v[156:159], v[68:71], a[12:15], 0
  buffer_load_dwordx4 v[124:127], v61, s[36:39], s56 offen offset:1024 sc1
  s_waitcnt vmcnt(14)
  v_mfma_f32_16x16x32_bf16 v[128:131], v[72:75], a[16:19], v[128:131]
  ds_write_b128 v54, v[164:167] offset:33792
  ds_read_b64_tr_b16 v[226:227], v60 offset:512
  v_mfma_f32_16x16x32_bf16 v[132:135], v[72:75], a[20:23], v[132:135]
  ds_read_b64_tr_b16 v[204:205], v59 offset:4096
  ds_read_b64_tr_b16 v[206:207], v59 offset:4608
  v_mfma_f32_16x16x32_bf16 v[136:139], v[72:75], a[24:27], v[136:139]
  v_mfma_f32_16x16x32_bf16 v[140:143], v[72:75], a[28:31], v[140:143]
  v_mfma_f32_16x16x32_bf16 v[144:147], v[76:79], a[16:19], v[144:147]
  v_mfma_f32_16x16x32_bf16 v[148:151], v[76:79], a[20:23], v[148:151]
  v_mfma_f32_16x16x32_bf16 v[152:155], v[76:79], a[24:27], v[152:155]
  s_add_u32 s56, s68, 262144
  buffer_load_dwordx4 v[64:67], v1, s[36:39], s56 offen offset:0 sc1
  v_mfma_f32_16x16x32_bf16 v[156:159], v[76:79], a[28:31], v[156:159]
  buffer_load_dwordx4 v[68:71], v61, s[36:39], s56 offen offset:0 sc1
  s_waitcnt vmcnt(14)
  v_mfma_f32_16x16x32_bf16 v[128:131], v[80:83], a[32:35], v[128:131]
  ds_write_b128 v54, v[168:171] offset:34816
  ds_read_b64_tr_b16 v[228:229], v60 offset:4096
  v_mfma_f32_16x16x32_bf16 v[132:135], v[80:83], a[36:39], v[132:135]
  ds_read_b64_tr_b16 v[230:231], v60 offset:4608
  ds_read_b64_tr_b16 v[208:209], v59 offset:8192
  v_mfma_f32_16x16x32_bf16 v[136:139], v[80:83], a[40:43], v[136:139]
  v_mfma_f32_16x16x32_bf16 v[140:143], v[80:83], a[44:47], v[140:143]
  v_mfma_f32_16x16x32_bf16 v[144:147], v[84:87], a[32:35], v[144:147]
  v_mfma_f32_16x16x32_bf16 v[148:151], v[84:87], a[36:39], v[148:151]
  v_mfma_f32_16x16x32_bf16 v[152:155], v[84:87], a[40:43], v[152:155]
  buffer_load_dwordx4 v[72:75], v1, s[36:39], s56 offen offset:1024 sc1
  v_mfma_f32_16x16x32_bf16 v[156:159], v[84:87], a[44:47], v[156:159]
  buffer_load_dwordx4 v[76:79], v61, s[36:39], s56 offen offset:1024 sc1
  s_waitcnt vmcnt(14)
  v_mfma_f32_16x16x32_bf16 v[128:131], v[88:91], a[48:51], v[128:131]
  ds_write_b128 v54, v[172:175] offset:35840
  ds_read_b64_tr_b16 v[210:211], v59 offset:8704
  v_mfma_f32_16x16x32_bf16 v[132:135], v[88:91], a[52:55], v[132:135]
  ds_read_b64_tr_b16 v[232:233], v60 offset:8192
  ds_read_b64_tr_b16 v[234:235], v60 offset:8704
  v_mfma_f32_16x16x32_bf16 v[136:139], v[88:91], a[56:59], v[136:139]
  v_mfma_f32_16x16x32_bf16 v[140:143], v[88:91], a[60:63], v[140:143]
  v_mfma_f32_16x16x32_bf16 v[144:147], v[92:95], a[48:51], v[144:147]
  v_mfma_f32_16x16x32_bf16 v[148:151], v[92:95], a[52:55], v[148:151]
  v_mfma_f32_16x16x32_bf16 v[152:155], v[92:95], a[56:59], v[152:155]
  s_add_u32 s56, s69, 262144
  buffer_load_dwordx4 v[80:83], v1, s[36:39], s56 offen offset:0 sc1
  v_mfma_f32_16x16x32_bf16 v[156:159], v[92:95], a[60:63], v[156:159]
  buffer_load_dwordx4 v[84:87], v61, s[36:39], s56 offen offset:0 sc1
  s_waitcnt vmcnt(14)
  v_mfma_f32_16x16x32_bf16 v[128:131], v[96:99], a[64:67], v[128:131]
  ds_write_b128 v54, v[176:179] offset:36864
  ds_read_b64_tr_b16 v[212:213], v59 offset:12288
  v_mfma_f32_16x16x32_bf16 v[132:135], v[96:99], a[68:71], v[132:135]
  ds_read_b64_tr_b16 v[214:215], v59 offset:12800
  ds_read_b64_tr_b16 v[236:237], v60 offset:12288
  v_mfma_f32_16x16x32_bf16 v[136:139], v[96:99], a[72:75], v[136:139]
  v_mfma_f32_16x16x32_bf16 v[140:143], v[96:99], a[76:79], v[140:143]
  v_mfma_f32_16x16x32_bf16 v[144:147], v[100:103], a[64:67], v[144:147]
  v_mfma_f32_16x16x32_bf16 v[148:151], v[100:103], a[68:71], v[148:151]
  v_mfma_f32_16x16x32_bf16 v[152:155], v[100:103], a[72:75], v[152:155]
  buffer_load_dwordx4 v[88:91], v1, s[36:39], s56 offen offset:1024 sc1
  v_mfma_f32_16x16x32_bf16 v[156:159], v[100:103], a[76:79], v[156:159]
  buffer_load_dwordx4 v[92:95], v61, s[36:39], s56 offen offset:1024 sc1
  s_waitcnt vmcnt(14)
  v_mfma_f32_16x16x32_bf16 v[128:131], v[104:107], a[80:83], v[128:131]
  ds_write_b128 v54, v[180:183] offset:37888
  ds_read_b64_tr_b16 v[238:239], v60 offset:12800
  v_mfma_f32_16x16x32_bf16 v[132:135], v[104:107], a[84:87], v[132:135]
  ds_read_b64_tr_b16 v[216:217], v59 offset:16384
  ds_read_b64_tr_b16 v[218:219], v59 offset:16896
  v_mfma_f32_16x16x32_bf16 v[136:139], v[104:107], a[88:91], v[136:139]
  v_mfma_f32_16x16x32_bf16 v[140:143], v[104:107], a[92:95], v[140:143]
  v_mfma_f32_16x16x32_bf16 v[144:147], v[108:111], a[80:83], v[144:147]
  v_mfma_f32_16x16x32_bf16 v[148:151], v[108:111], a[84:87], v[148:151]
  v_mfma_f32_16x16x32_bf16 v[152:155], v[108:111], a[88:91], v[152:155]
  s_add_u32 s56, s70, 262144
  buffer_load_dwordx4 v[96:99], v1, s[36:39], s56 offen offset:0 sc1
  v_mfma_f32_16x16x32_bf16 v[156:159], v[108:111], a[92:95], v[156:159]
  buffer_load_dwordx4 v[100:103], v61, s[36:39], s56 offen offset:0 sc1
  s_waitcnt vmcnt(12)
  v_mfma_f32_16x16x32_bf16 v[128:131], v[112:115], a[96:99], v[128:131]
  ds_write_b128 v54, v[184:187] offset:38912
  ds_read_b64_tr_b16 v[240:241], v60 offset:16384
  v_mfma_f32_16x16x32_bf16 v[132:135], v[112:115], a[100:103], v[132:135]
  ds_read_b64_tr_b16 v[242:243], v60 offset:16896
  ds_read_b64_tr_b16 v[220:221], v59 offset:20480
  v_mfma_f32_16x16x32_bf16 v[136:139], v[112:115], a[104:107], v[136:139]
  v_mfma_f32_16x16x32_bf16 v[140:143], v[112:115], a[108:111], v[140:143]
  v_mfma_f32_16x16x32_bf16 v[144:147], v[116:119], a[96:99], v[144:147]
  v_mfma_f32_16x16x32_bf16 v[148:151], v[116:119], a[100:103], v[148:151]
  v_mfma_f32_16x16x32_bf16 v[152:155], v[116:119], a[104:107], v[152:155]
  buffer_load_dwordx4 v[104:107], v1, s[36:39], s56 offen offset:1024 sc1
  v_mfma_f32_16x16x32_bf16 v[156:159], v[116:119], a[108:111], v[156:159]
  buffer_load_dwordx4 v[108:111], v61, s[36:39], s56 offen offset:1024 sc1
  s_waitcnt vmcnt(12)
  v_mfma_f32_16x16x32_bf16 v[128:131], v[120:123], a[112:115], v[128:131]
  ds_write_b128 v54, v[188:191] offset:39936
  ds_read_b64_tr_b16 v[222:223], v59 offset:20992
  v_mfma_f32_16x16x32_bf16 v[132:135], v[120:123], a[116:119], v[132:135]
  ds_read_b64_tr_b16 v[244:245], v60 offset:20480
  ds_read_b64_tr_b16 v[246:247], v60 offset:20992
  v_mfma_f32_16x16x32_bf16 v[136:139], v[120:123], a[120:123], v[136:139]
  v_mfma_f32_16x16x32_bf16 v[140:143], v[120:123], a[124:127], v[140:143]
  v_mfma_f32_16x16x32_bf16 v[144:147], v[124:127], a[112:115], v[144:147]
  v_mfma_f32_16x16x32_bf16 v[148:151], v[124:127], a[116:119], v[148:151]
  v_mfma_f32_16x16x32_bf16 v[152:155], v[124:127], a[120:123], v[152:155]
  s_add_u32 s56, s71, 262144
  buffer_load_dwordx4 v[112:115], v1, s[36:39], s56 offen offset:0 sc1
  v_mfma_f32_16x16x32_bf16 v[156:159], v[124:127], a[124:127], v[156:159]
  buffer_load_dwordx4 v[116:119], v61, s[36:39], s56 offen offset:0 sc1
  s_waitcnt vmcnt(12)
  v_mfma_f32_16x16x32_bf16 v[128:131], v[64:67], a[128:131], v[128:131]
  s_waitcnt lgkmcnt(0)
  s_barrier
  v_mfma_f32_16x16x32_bf16 v[132:135], v[64:67], a[132:135], v[132:135]
  v_mfma_f32_16x16x32_bf16 v[136:139], v[64:67], a[136:139], v[136:139]
  v_mfma_f32_16x16x32_bf16 v[140:143], v[64:67], a[140:143], v[140:143]
  v_mfma_f32_16x16x32_bf16 v[144:147], v[68:71], a[128:131], v[144:147]
  v_mfma_f32_16x16x32_bf16 v[148:151], v[68:71], a[132:135], v[148:151]
  v_mfma_f32_16x16x32_bf16 v[152:155], v[68:71], a[136:139], v[152:155]
  buffer_load_dwordx4 v[120:123], v1, s[36:39], s56 offen offset:1024 sc1
  v_mfma_f32_16x16x32_bf16 v[156:159], v[68:71], a[140:143], v[156:159]
  buffer_load_dwordx4 v[124:127], v61, s[36:39], s56 offen offset:1024 sc1
  s_waitcnt vmcnt(12)
  v_mfma_f32_16x16x32_bf16 v[128:131], v[72:75], a[144:147], v[128:131]
  s_cmp_lg_u32 s44, 0
  s_cbranch_scc1 L_noflag_23
  s_mov_b64 exec, 1
  buffer_store_dwordx2 v[4:5], off, s[36:39], s88 sc1
  s_mov_b64 exec, -1
L_noflag_23:
  ds_read_b128 v[28:31], v55 offset:32768
  v_mfma_f32_16x16x32_bf16 v[132:135], v[72:75], a[148:151], v[132:135]
  ds_read_b128 v[32:35], v55 offset:33792
  ds_read_b128 v[36:39], v55 offset:40960
  v_mfma_f32_16x16x32_bf16 v[136:139], v[72:75], a[152:155], v[136:139]
  ds_read_b128 v[40:43], v55 offset:41984
  ds_read_b128 v[44:47], v55 offset:49152
  v_mfma_f32_16x16x32_bf16 v[140:143], v[72:75], a[156:159], v[140:143]
  ds_read_b128 v[48:51], v55 offset:50176
  ds_read_b128 v[160:163], v55 offset:57344
  v_mfma_f32_16x16x32_bf16 v[144:147], v[76:79], a[144:147], v[144:147]
  ds_read_b128 v[164:167], v55 offset:58368
  v_mfma_f32_16x16x32_bf16 v[148:151], v[76:79], a[148:151], v[148:151]
  v_mfma_f32_16x16x32_bf16 v[152:155], v[76:79], a[152:155], v[152:155]
  v_mfma_f32_16x16x32_bf16 v[156:159], v[76:79], a[156:159], v[156:159]
  s_waitcnt vmcnt(10)
  v_mfma_f32_16x16x32_bf16 v[128:131], v[80:83], a[160:163], v[128:131]
  v_mfma_f32_16x16x32_bf16 v[132:135], v[80:83], a[164:167], v[132:135]
  v_mfma_f32_16x16x32_bf16 v[136:139], v[80:83], a[168:171], v[136:139]
  v_mfma_f32_16x16x32_bf16 v[140:143], v[80:83], a[172:175], v[140:143]
  v_mfma_f32_16x16x32_bf16 v[144:147], v[84:87], a[160:163], v[144:147]
  v_mfma_f32_16x16x32_bf16 v[148:151], v[84:87], a[164:167], v[148:151]
  v_mfma_f32_16x16x32_bf16 v[152:155], v[84:87], a[168:171], v[152:155]
  v_mfma_f32_16x16x32_bf16 v[156:159], v[84:87], a[172:175], v[156:159]
  s_waitcnt vmcnt(8)
  v_mfma_f32_16x16x32_bf16 v[128:131], v[88:91], a[176:179], v[128:131]
  s_waitcnt lgkmcnt(0)
  v_add_f32 v160, v160, v28
  v_mfma_f32_16x16x32_bf16 v[132:135], v[88:91], a[180:183], v[132:135]
  v_add_f32 v161, v161, v29
  v_add_f32 v162, v162, v30
  v_mfma_f32_16x16x32_bf16 v[136:139], v[88:91], a[184:187], v[136:139]
  v_add_f32 v163, v163, v31
  v_add_f32 v164, v164, v32
  v_mfma_f32_16x16x32_bf16 v[140:143], v[88:91], a[188:191], v[140:143]
  v_add_f32 v165, v165, v33
  v_add_f32 v166, v166, v34
  v_mfma_f32_16x16x32_bf16 v[144:147], v[92:95], a[176:179], v[144:147]
  v_add_f32 v167, v167, v35
  v_add_f32 v36, v36, v44
  v_mfma_f32_16x16x32_bf16 v[148:151], v[92:95], a[180:183], v[148:151]
  v_add_f32 v37, v37, v45
  v_add_f32 v38, v38, v46
  v_mfma_f32_16x16x32_bf16 v[152:155], v[92:95], a[184:187], v[152:155]
  v_mfma_f32_16x16x32_bf16 v[156:159], v[92:95], a[188:191], v[156:159]
  s_waitcnt vmcnt(6)
  v_mfma_f32_16x16x32_bf16 v[128:131], v[96:99], a[192:195], v[128:131]
  v_add_f32 v39, v39, v47
  v_add_f32 v40, v40, v48
  v_mfma_f32_16x16x32_bf16 v[132:135], v[96:99], a[196:199], v[132:135]
  v_add_f32 v41, v41, v49
  v_add_f32 v42, v42, v50
  v_mfma_f32_16x16x32_bf16 v[136:139], v[96:99], a[200:203], v[136:139]
  v_add_f32 v43, v43, v51
  v_add_f32 v160, v160, v62
  v_mfma_f32_16x16x32_bf16 v[140:143], v[96:99], a[204:207], v[140:143]
  v_add_f32 v161, v161, v62
  v_add_f32 v162, v162, v62
  v_mfma_f32_16x16x32_bf16 v[144:147], v[100:103], a[192:195], v[144:147]
  v_add_f32 v163, v163, v62
  v_add_f32 v164, v164, v63
  v_mfma_f32_16x16x32_bf16 v[148:151], v[100:103], a[196:199], v[148:151]
  v_add_f32 v165, v165, v63
  v_mfma_f32_16x16x32_bf16 v[152:155], v[100:103], a[200:203], v[152:155]
  v_mfma_f32_16x16x32_bf16 v[156:159], v[100:103], a[204:207], v[156:159]
  s_waitcnt vmcnt(4)
  v_mfma_f32_16x16x32_bf16 v[128:131], v[104:107], a[208:211], v[128:131]
  v_add_f32 v166, v166, v63
  v_add_f32 v167, v167, v63
  v_mfma_f32_16x16x32_bf16 v[132:135], v[104:107], a[212:215], v[132:135]
  v_lshlrev_b32 v28, 16, v18
  v_and_b32 v29, s53, v18
  v_mfma_f32_16x16x32_bf16 v[136:139], v[104:107], a[216:219], v[136:139]
  v_lshlrev_b32 v30, 16, v19
  v_and_b32 v31, s53, v19
  v_mfma_f32_16x16x32_bf16 v[140:143], v[104:107], a[220:223], v[140:143]
  v_lshlrev_b32 v32, 16, v24
  v_and_b32 v33, s53, v24
  v_mfma_f32_16x16x32_bf16 v[144:147], v[108:111], a[208:211], v[144:147]
  v_lshlrev_b32 v34, 16, v25
  v_and_b32 v35, s53, v25
  v_mfma_f32_16x16x32_bf16 v[148:151], v[108:111], a[212:215], v[148:151]
  v_add_f32 v160, v160, v36
  v_mfma_f32_16x16x32_bf16 v[152:155], v[108:111], a[216:219], v[152:155]
  v_mfma_f32_16x16x32_bf16 v[156:159], v[108:111], a[220:223], v[156:159]
  s_waitcnt vmcnt(2)
  v_mfma_f32_16x16x32_bf16 v[128:131], v[112:115], a[224:227], v[128:131]
  v_add_f32 v161, v161, v37
  v_add_f32 v162, v162, v38
  v_mfma_f32_16x16x32_bf16 v[132:135], v[112:115], a[228:231], v[132:135]
  v_add_f32 v163, v163, v39
  v_add_f32 v164, v164, v40
  v_mfma_f32_16x16x32_bf16 v[136:139], v[112:115], a[232:235], v[136:139]
  v_add_f32 v165, v165, v41
  v_add_f32 v166, v166, v42
  v_mfma_f32_16x16x32_bf16 v[140:143], v[112:115], a[236:239], v[140:143]
  v_add_f32 v167, v167, v43
  v_mul_f32 v160, v160, v28
  v_mfma_f32_16x16x32_bf16 v[144:147], v[116:119], a[224:227], v[144:147]
  v_mul_f32 v161, v161, v29
  v_mul_f32 v162, v162, v30
  v_mfma_f32_16x16x32_bf16 v[148:151], v[116:119], a[228:231], v[148:151]
  v_mul_f32 v163, v163, v31
  buffer_load_dwordx2 v[52:53], v7, s[36:39], s89 offen sc1
  v_mfma_f32_16x16x32_bf16 v[152:155], v[116:119], a[232:235], v[152:155]
  v_mfma_f32_16x16x32_bf16 v[156:159], v[116:119], a[236:239], v[156:159]
  s_waitcnt vmcnt(1)
  v_mfma_f32_16x16x32_bf16 v[128:131], v[120:123], a[240:243], v[128:131]
  v_mul_f32 v164, v164, v32
  v_mul_f32 v165, v165, v33
  v_mfma_f32_16x16x32_bf16 v[132:135], v[120:123], a[244:247], v[132:135]
  v_mul_f32 v166, v166, v34
  v_mul_f32 v167, v167, v35
  v_mfma_f32_16x16x32_bf16 v[136:139], v[120:123], a[248:251], v[136:139]
  v_cvt_pk_bf16_f32 v28, v160, v161
  v_cvt_pk_bf16_f32 v29, v162, v163
  v_mfma_f32_16x16x32_bf16 v[140:143], v[120:123], a[252:255], v[140:143]
  v_cvt_pk_bf16_f32 v30, v164, v165
  v_cvt_pk_bf16_f32 v31, v166, v167
  v_mfma_f32_16x16x32_bf16 v[144:147], v[124:127], a[240:243], v[144:147]
  buffer_store_dwordx2 v[28:29], v2, s[36:39], s81 offen offset:1024 sc1
  buffer_store_dwordx2 v[30:31], v2, s[36:39], s82 offen offset:1024 sc1
  v_mfma_f32_16x16x32_bf16 v[148:151], v[124:127], a[244:247], v[148:151]
  v_mfma_f32_16x16x32_bf16 v[152:155], v[124:127], a[248:251], v[152:155]
  v_mfma_f32_16x16x32_bf16 v[156:159], v[124:127], a[252:255], v[156:159]
  ds_write_b128 v54, v[128:131] offset:0
  ds_write_b128 v54, v[132:135] offset:1024
  ds_write_b128 v54, v[136:139] offset:2048
  ds_write_b128 v54, v[140:143] offset:3072
  ds_write_b128 v54, v[144:147] offset:4096
  s_nop 0
  ds_write_b128 v54, v[148:151] offset:5120
  ds_write_b128 v54, v[152:155] offset:6144
  ds_write_b128 v54, v[156:159] offset:7168
  s_waitcnt lgkmcnt(0)
  s_cmp_lg_u32 s44, 0
  s_cbranch_scc1 L_late_24
  s_waitcnt vmcnt(2)
  v_cmp_ne_u64 vcc, s[50:51], v[52:53]
  s_nop 1
  s_cbranch_vccz L_late_24
  s_mov_b32 s55, 0x40000
L_poll_25:
  buffer_load_dwordx2 v[52:53], v7, s[36:39], s89 offen sc1
  s_waitcnt vmcnt(0)
  v_cmp_ne_u64 vcc, s[50:51], v[52:53]
  s_sub_u32 s55, s55, 1
  s_cbranch_scc1 L_polled_26
  s_cbranch_vccnz L_poll_25
L_polled_26:
L_late_24:
  s_barrier
  ds_read_b128 v[28:31], v55 offset:0
  ds_read_b128 v[32:35], v55 offset:1024
  ds_read_b128 v[36:39], v55 offset:8192
  ds_read_b128 v[40:43], v55 offset:9216
  ds_read_b128 v[44:47], v55 offset:16384
  ds_read_b128 v[48:51], v55 offset:17408
  ds_read_b128 v[128:131], v55 offset:24576
  ds_read_b128 v[132:135], v55 offset:25600
  v_add_u32 v56, 98304, v59
  v_add_u32 v57, 98304, v60
  v_lshlrev_b32 v192, 16, v20
  v_and_b32 v193, s53, v20
  v_lshlrev_b32 v194, 16, v21
  v_and_b32 v195, s53, v21
  v_lshlrev_b32 v196, 16, v26
  v_and_b32 v197, s53, v26
  v_lshlrev_b32 v198, 16, v27
  v_and_b32 v199, s53, v27
  s_lshl_b32 s85, s54, 8
  s_add_u32 s85, s85, 53248
  s_lshl_b32 s63, s42, 3
  s_add_u32 s85, s85, s63
  s_waitcnt lgkmcnt(0)
  v_pk_add_f32 v[128:129], v[128:129], v[28:29]
  v_pk_add_f32 v[130:131], v[130:131], v[30:31]
  v_pk_add_f32 v[132:133], v[132:133], v[32:33]
  v_pk_add_f32 v[134:135], v[134:135], v[34:35]
  v_pk_add_f32 v[36:37], v[36:37], v[44:45]
  v_pk_add_f32 v[38:39], v[38:39], v[46:47]
  v_pk_add_f32 v[40:41], v[40:41], v[48:49]
  v_pk_add_f32 v[42:43], v[42:43], v[50:51]
  v_pk_add_f32 v[128:129], v[128:129], v[62:63] op_sel:[0,0] op_sel_hi:[1,0]
  v_pk_add_f32 v[130:131], v[130:131], v[62:63] op_sel:[0,0] op_sel_hi:[1,0]
  v_pk_add_f32 v[132:133], v[132:133], v[62:63] op_sel:[0,1] op_sel_hi:[1,1]
  v_pk_add_f32 v[134:135], v[134:135], v[62:63] op_sel:[0,1] op_sel_hi:[1,1]
  v_pk_add_f32 v[128:129], v[128:129], v[36:37]
  v_pk_add_f32 v[130:131], v[130:131], v[38:39]
  v_pk_add_f32 v[132:133], v[132:133], v[40:41]
  v_pk_add_f32 v[134:135], v[134:135], v[42:43]
  v_pk_mul_f32 v[128:129], v[128:129], v[192:193]
  v_pk_mul_f32 v[130:131], v[130:131], v[194:195]
  v_pk_mul_f32 v[132:133], v[132:133], v[196:197]
  v_pk_mul_f32 v[134:135], v[134:135], v[198:199]
  v_cvt_pk_bf16_f32 v28, v128, v129
  v_cvt_pk_bf16_f32 v29, v130, v131
  v_cvt_pk_bf16_f32 v30, v132, v133
  v_cvt_pk_bf16_f32 v31, v134, v135
  s_cmp_eq_u32 s80, 0
  s_cbranch_scc1 L_gstore_28
  s_cmp_eq_u32 s42, 7
  s_cbranch_scc0 L_gskip_27
  v_mov_b32 v28, 0
  v_mov_b32 v29, 0
  v_mov_b32 v30, 0
  v_mov_b32 v31, 0
L_gstore_28:
  buffer_store_dwordx2 v[28:29], v2, s[36:39], s81 offen offset:2048 sc1
  buffer_store_dwordx2 v[30:31], v2, s[36:39], s82 offen offset:2048 sc1
L_gskip_27:
  s_lshr_b32 s56, s45, 4
  s_add_u32 s56, s56, s44
  s_mul_i32 s56, s56, 22528
  s_add_u32 s72, s56, 14680064
  s_lshl_b32 s73, s44, 10
  s_add_u32 s58, s72, 0
  s_add_u32 m0, s73, 57344
  s_nop 0
  buffer_load_dwordx4 v1, s[36:39], s58 offen sc1 lds
  s_add_u32 s58, s72, 3072
  s_add_u32 m0, s73, 61440
  s_nop 0
  buffer_load_dwordx4 v1, s[36:39], s58 offen sc1 lds
  s_add_u32 s58, s72, 6144
  s_add_u32 m0, s73, 65536
  s_nop 0
  buffer_load_dwordx4 v1, s[36:39], s58 offen sc1 lds
  s_add_u32 s58, s72, 9216
  s_add_u32 m0, s73, 69632
  s_nop 0
  buffer_load_dwordx4 v1, s[36:39], s58 offen sc1 lds
  s_add_u32 s58, s72, 14336
  s_add_u32 m0, s73, 73728
  s_nop 0
  buffer_load_dwordx4 v1, s[36:39], s58 offen sc1 lds
  s_add_u32 s58, s72, 19456
  s_add_u32 m0, s73, 77824
  s_nop 0
  buffer_load_dwordx4 v1, s[36:39], s58 offen sc1 lds
  s_waitcnt vmcnt(6)
  s_barrier
  s_cmp_lg_u32 s44, 0
  s_cbranch_scc1 L_noflag_29
  s_mov_b64 exec, 1
  buffer_store_dwordx2 v[4:5], off, s[36:39], s85 sc1
  s_mov_b64 exec, -1
L_noflag_29:
  s_lshl_b32 s59, s54, 8
  s_add_u32 s59, s59, 53248
  s_lshl_b32 s60, s46, 11
  v_add_u32 v31, s60, v1
  v_add_u32 v30, 24576, v31
  ds_read_b64_tr_b16 a[0:1], v56 offset:0
  ds_read_b64_tr_b16 a[2:3], v56 offset:512
  ds_read_b64_tr_b16 a[64:65], v57 offset:0
  ds_read_b64_tr_b16 a[66:67], v57 offset:512
  ds_read_b64_tr_b16 a[4:5], v56 offset:4096
  ds_read_b64_tr_b16 a[6:7], v56 offset:4608
  ds_read_b64_tr_b16 a[68:69], v57 offset:4096
  ds_read_b64_tr_b16 a[70:71], v57 offset:4608
  ds_read_b64_tr_b16 a[8:9], v56 offset:8192
  ds_read_b64_tr_b16 a[10:11], v56 offset:8704
  ds_read_b64_tr_b16 a[72:73], v57 offset:8192
  ds_read_b64_tr_b16 a[74:75], v57 offset:8704
  ds_read_b64_tr_b16 a[12:13], v56 offset:12288
  ds_read_b64_tr_b16 a[14:15], v56 offset:12800
  ds_read_b64_tr_b16 a[76:77], v57 offset:12288
  ds_read_b64_tr_b16 a[78:79], v57 offset:12800
  ds_read_b64_tr_b16 a[16:17], v56 offset:16384
  ds_read_b64_tr_b16 a[18:19], v56 offset:16896
  ds_read_b64_tr_b16 a[80:81], v57 offset:16384
  ds_read_b64_tr_b16 a[82:83], v57 offset:16896
  ds_read_b64_tr_b16 a[20:21], v56 offset:20480
  ds_read_b64_tr_b16 a[22:23], v56 offset:20992
  ds_read_b64_tr_b16 a[84:85], v57 offset:20480
  ds_read_b64_tr_b16 a[86:87], v57 offset:20992
  ds_read_b64_tr_b16 a[24:25], v56 offset:24576
  ds_read_b64_tr_b16 a[26:27], v56 offset:25088
  ds_read_b64_tr_b16 a[88:89], v57 offset:24576
  ds_read_b64_tr_b16 a[90:91], v57 offset:25088
  ds_read_b64_tr_b16 a[28:29], v56 offset:28672
  ds_read_b64_tr_b16 a[30:31], v56 offset:29184
  ds_read_b64_tr_b16 a[92:93], v57 offset:28672
  ds_read_b64_tr_b16 a[94:95], v57 offset:29184
  buffer_load_dwordx2 v[36:37], v7, s[36:39], s59 offen sc1
  ds_read_b64_tr_b16 a[32:33], v56 offset:32768
  ds_read_b64_tr_b16 a[34:35], v56 offset:33280
  ds_read_b64_tr_b16 a[96:97], v57 offset:32768
  ds_read_b64_tr_b16 a[98:99], v57 offset:33280
  ds_read_b64_tr_b16 a[36:37], v56 offset:36864
  ds_read_b64_tr_b16 a[38:39], v56 offset:37376
  ds_read_b64_tr_b16 a[100:101], v57 offset:36864
  ds_read_b64_tr_b16 a[102:103], v57 offset:37376
  ds_read_b64_tr_b16 a[40:41], v56 offset:40960
  ds_read_b64_tr_b16 a[42:43], v56 offset:41472
  ds_read_b64_tr_b16 a[104:105], v57 offset:40960
  ds_read_b64_tr_b16 a[106:107], v57 offset:41472
  ds_read_b64_tr_b16 a[44:45], v56 offset:45056
  ds_read_b64_tr_b16 a[46:47], v56 offset:45568
  ds_read_b64_tr_b16 a[108:109], v57 offset:45056
  ds_read_b64_tr_b16 a[110:111], v57 offset:45568
  ds_read_b64_tr_b16 a[48:49], v56 offset:49152
  ds_read_b64_tr_b16 a[50:51], v56 offset:49664
  ds_read_b64_tr_b16 a[112:113], v57 offset:49152
  ds_read_b64_tr_b16 a[114:115], v57 offset:49664
  ds_read_b64_tr_b16 a[52:53], v56 offset:53248
  ds_read_b64_tr_b16 a[54:55], v56 offset:53760
  ds_read_b64_tr_b16 a[116:117], v57 offset:53248
  ds_read_b64_tr_b16 a[118:119], v57 offset:53760
  ds_read_b64_tr_b16 a[56:57], v56 offset:57344
  ds_read_b64_tr_b16 a[58:59], v56 offset:57856
  ds_read_b64_tr_b16 a[120:121], v57 offset:57344
  ds_read_b64_tr_b16 a[122:123], v57 offset:57856
  ds_read_b64_tr_b16 a[60:61], v56 offset:61440
  ds_read_b64_tr_b16 a[62:63], v56 offset:61952
  ds_read_b64_tr_b16 a[124:125], v57 offset:61440
  ds_read_b64_tr_b16 a[126:127], v57 offset:61952
  v_and_b32 v32, 15, v0
  v_lshrrev_b32 v33, 4, v0
  v_lshlrev_b32 v32, 10, v32
  v_and_b32 v34, 1, v33
  v_lshl_add_u32 v32, v34, 5, v32
  v_lshrrev_b32 v33, 1, v33
  v_lshl_add_u32 v32, v33, 4, v32
  s_lshl_b32 s56, s46, 5
  s_add_u32 s56, s56, s45
  s_lshl_b32 s56, s56, 10
  s_lshl_b32 s60, s42, 7
  s_add_u32 s56, s56, s60
  s_lshl_b32 s60, s47, 6
  s_add_u32 s81, s56, s60
  s_add_u32 s82, s81, 0x4000
  v_lshlrev_b32 v96, 16, v8
  v_and_b32 v97, s53, v8
  v_lshlrev_b32 v98, 16, v9
  v_and_b32 v99, s53, v9
  v_lshlrev_b32 v100, 16, v10
  v_and_b32 v101, s53, v10
  v_lshlrev_b32 v102, 16, v11
  v_and_b32 v103, s53, v11
  v_lshlrev_b32 v104, 16, v12
  v_and_b32 v105, s53, v12
  v_lshlrev_b32 v106, 16, v13
  v_and_b32 v107, s53, v13
  v_lshlrev_b32 v108, 16, v14
  v_and_b32 v109, s53, v14
  v_lshlrev_b32 v110, 16, v15
  v_and_b32 v111, s53, v15
  s_waitcnt vmcnt(1) lgkmcnt(0)
  s_cmp_lg_u32 s44, 0
  s_cbranch_scc1 L_late_30
  s_waitcnt vmcnt(0)
  v_cmp_ne_u64 vcc, s[50:51], v[36:37]
  s_nop 1
  s_cbranch_vccz L_late_30
  s_mov_b32 s55, 0x40000
L_poll_31:
  buffer_load_dwordx2 v[36:37], v7, s[36:39], s59 offen sc1
  s_waitcnt vmcnt(0)
  v_cmp_ne_u64 vcc, s[50:51], v[36:37]
  s_sub_u32 s55, s55, 1
  s_cbranch_scc1 L_polled_32
  s_cbranch_vccnz L_poll_31
L_polled_32:
L_late_30:
  s_barrier
  s_add_u32 s58, s72, 1024
  s_add_u32 m0, s73, 81920
  s_nop 0
  buffer_load_dwordx4 v1, s[36:39], s58 offen sc1 lds
  s_add_u32 s58, s72, 2048
  s_add_u32 m0, s73, 86016
  s_nop 0
  buffer_load_dwordx4 v1, s[36:39], s58 offen sc1 lds
  s_add_u32 s58, s72, 4096
  s_add_u32 m0, s73, 24576
  s_nop 0
  buffer_load_dwordx4 v1, s[36:39], s58 offen sc1 lds
  s_add_u32 s58, s72, 5120
  s_add_u32 m0, s73, 28672
  s_nop 0
  buffer_load_dwordx4 v1, s[36:39], s58 offen sc1 lds
  s_add_u32 s58, s72, 7168
  s_add_u32 m0, s73, 32768
  s_nop 0
  buffer_load_dwordx4 v1, s[36:39], s58 offen sc1 lds
  s_add_u32 s58, s72, 8192
  s_add_u32 m0, s73, 36864
  s_nop 0
  buffer_load_dwordx4 v1, s[36:39], s58 offen sc1 lds
  s_add_u32 s58, s72, 10240
  s_add_u32 m0, s73, 40960
  s_nop 0
  buffer_load_dwordx4 v1, s[36:39], s58 offen sc1 lds
  s_add_u32 s58, s72, 11264
  s_add_u32 m0, s73, 45056
  s_nop 0
  buffer_load_dwordx4 v1, s[36:39], s58 offen sc1 lds
  ds_read_b128 v[64:67], v30 offset:32768
  ds_read_b128 v[68:71], v30 offset:33792
  ds_read_b128 v[72:75], v30 offset:36864
  ds_read_b128 v[76:79], v30 offset:37888
  s_waitcnt lgkmcnt(2)
  v_mfma_f32_16x16x32_bf16 v[128:131], a[0:3], v[64:67], v[96:99]
  ds_read_b128 v[80:83], v30 offset:40960
  v_mfma_f32_16x16x32_bf16 v[132:135], a[64:67], v[64:67], v[100:103]
  ds_read_b128 v[84:87], v30 offset:41984
  v_mfma_f32_16x16x32_bf16 v[136:139], a[0:3], v[68:71], v[104:107]
  v_mfma_f32_16x16x32_bf16 v[140:143], a[64:67], v[68:71], v[108:111]
  s_waitcnt lgkmcnt(2)
  v_mfma_f32_16x16x32_bf16 v[128:131], a[4:7], v[72:75], v[128:131]
  ds_read_b128 v[88:91], v30 offset:45056
  v_mfma_f32_16x16x32_bf16 v[132:135], a[68:71], v[72:75], v[132:135]
  ds_read_b128 v[92:95], v30 offset:46080
  v_mfma_f32_16x16x32_bf16 v[136:139], a[4:7], v[76:79], v[136:139]
  v_mfma_f32_16x16x32_bf16 v[140:143], a[68:71], v[76:79], v[140:143]
  s_waitcnt lgkmcnt(2)
  v_mfma_f32_16x16x32_bf16 v[128:131], a[8:11], v[80:83], v[128:131]
  ds_read_b128 v[64:67], v30 offset:49152
  v_mfma_f32_16x16x32_bf16 v[132:135], a[72:75], v[80:83], v[132:135]
  ds_read_b128 v[68:71], v30 offset:50176
  v_mfma_f32_16x16x32_bf16 v[136:139], a[8:11], v[84:87], v[136:139]
  v_mfma_f32_16x16x32_bf16 v[140:143], a[72:75], v[84:87], v[140:143]
  s_waitcnt lgkmcnt(2)
  v_mfma_f32_16x16x32_bf16 v[128:131], a[12:15], v[88:91], v[128:131]
  ds_read_b128 v[72:75], v30 offset:53248
  v_mfma_f32_16x16x32_bf16 v[132:135], a[76:79], v[88:91], v[132:135]
  ds_read_b128 v[76:79], v30 offset:54272
  v_mfma_f32_16x16x32_bf16 v[136:139], a[12:15], v[92:95], v[136:139]
  v_mfma_f32_16x16x32_bf16 v[140:143], a[76:79], v[92:95], v[140:143]
  s_waitcnt lgkmcnt(2)
  s_waitcnt vmcnt(4)
  s_barrier
  v_mfma_f32_16x16x32_bf16 v[128:131], a[16:19], v[64:67], v[128:131]
  ds_read_b128 v[80:83], v30 offset:57344
  v_mfma_f32_16x16x32_bf16 v[132:135], a[80:83], v[64:67], v[132:135]
  ds_read_b128 v[84:87], v30 offset:58368
  v_mfma_f32_16x16x32_bf16 v[136:139], a[16:19], v[68:71], v[136:139]
  s_add_u32 s58, s72, 12288
  s_add_u32 m0, s73, 49152
  s_nop 0
  buffer_load_dwordx4 v1, s[36:39], s58 offen sc1 lds
  v_mfma_f32_16x16x32_bf16 v[140:143], a[80:83], v[68:71], v[140:143]
  s_add_u32 s58, s72, 13312
  s_add_u32 m0, s73, 53248
  s_nop 0
  buffer_load_dwordx4 v1, s[36:39], s58 offen sc1 lds
  s_waitcnt lgkmcnt(2)
  v_mfma_f32_16x16x32_bf16 v[128:131], a[20:23], v[72:75], v[128:131]
  ds_read_b128 v[88:91], v30 offset:61440
  v_mfma_f32_16x16x32_bf16 v[132:135], a[84:87], v[72:75], v[132:135]
  ds_read_b128 v[92:95], v30 offset:62464
  v_mfma_f32_16x16x32_bf16 v[136:139], a[20:23], v[76:79], v[136:139]
  s_add_u32 s58, s72, 15360
  s_add_u32 m0, s73, 0
  s_nop 0
  buffer_load_dwordx4 v1, s[36:39], s58 offen sc1 lds
  v_mfma_f32_16x16x32_bf16 v[140:143], a[84:87], v[76:79], v[140:143]
  s_add_u32 s58, s72, 16384
  s_add_u32 m0, s73, 4096
  s_nop 0
  buffer_load_dwordx4 v1, s[36:39], s58 offen sc1 lds
  s_waitcnt lgkmcnt(2)
  v_mfma_f32_16x16x32_bf16 v[128:131], a[24:27], v[80:83], v[128:131]
  ds_read_b128 v[64:67], v30 offset:0
  v_mfma_f32_16x16x32_bf16 v[132:135], a[88:91], v[80:83], v[132:135]
  ds_read_b128 v[68:71], v30 offset:1024
  v_mfma_f32_16x16x32_bf16 v[136:139], a[24:27], v[84:87], v[136:139]
  s_add_u32 s58, s72, 17408
  s_add_u32 m0, s73, 8192
  s_nop 0
  buffer_load_dwordx4 v1, s[36:39], s58 offen sc1 lds
  v_mfma_f32_16x16x32_bf16 v[140:143], a[88:91], v[84:87], v[140:143]
  s_add_u32 s58, s72, 18432
  s_add_u32 m0, s73, 12288
  s_nop 0
  buffer_load_dwordx4 v1, s[36:39], s58 offen sc1 lds
  s_waitcnt lgkmcnt(2)
  v_mfma_f32_16x16x32_bf16 v[128:131], a[28:31], v[88:91], v[128:131]
  ds_read_b128 v[72:75], v30 offset:4096
  v_mfma_f32_16x16x32_bf16 v[132:135], a[92:95], v[88:91], v[132:135]
  ds_read_b128 v[76:79], v30 offset:5120
  v_mfma_f32_16x16x32_bf16 v[136:139], a[28:31], v[92:95], v[136:139]
  s_add_u32 s58, s72, 20480
  s_add_u32 m0, s73, 16384
  s_nop 0
  buffer_load_dwordx4 v1, s[36:39], s58 offen sc1 lds
  v_mfma_f32_16x16x32_bf16 v[140:143], a[92:95], v[92:95], v[140:143]
  s_add_u32 s58, s72, 21504
  s_add_u32 m0, s73, 20480
  s_nop 0
  buffer_load_dwordx4 v1, s[36:39], s58 offen sc1 lds
  s_waitcnt lgkmcnt(2)
  s_waitcnt vmcnt(8)
  s_barrier
  v_mfma_f32_16x16x32_bf16 v[128:131], a[32:35], v[64:67], v[128:131]
  ds_read_b128 v[80:83], v30 offset:8192
  v_mfma_f32_16x16x32_bf16 v[132:135], a[96:99], v[64:67], v[132:135]
  ds_read_b128 v[84:87], v30 offset:9216
  v_mfma_f32_16x16x32_bf16 v[136:139], a[32:35], v[68:71], v[136:139]
  v_mfma_f32_16x16x32_bf16 v[140:143], a[96:99], v[68:71], v[140:143]
  s_waitcnt lgkmcnt(2)
  v_mfma_f32_16x16x32_bf16 v[128:131], a[36:39], v[72:75], v[128:131]
  ds_read_b128 v[88:91], v30 offset:12288
  v_mfma_f32_16x16x32_bf16 v[132:135], a[100:103], v[72:75], v[132:135]
  ds_read_b128 v[92:95], v30 offset:13312
  v_mfma_f32_16x16x32_bf16 v[136:139], a[36:39], v[76:79], v[136:139]
  v_mfma_f32_16x16x32_bf16 v[140:143], a[100:103], v[76:79], v[140:143]
  s_waitcnt lgkmcnt(2)
  v_mfma_f32_16x16x32_bf16 v[128:131], a[40:43], v[80:83], v[128:131]
  ds_read_b128 v[64:67], v30 offset:16384
  v_mfma_f32_16x16x32_bf16 v[132:135], a[104:107], v[80:83], v[132:135]
  ds_read_b128 v[68:71], v30 offset:17408
  v_mfma_f32_16x16x32_bf16 v[136:139], a[40:43], v[84:87], v[136:139]
  v_mfma_f32_16x16x32_bf16 v[140:143], a[104:107], v[84:87], v[140:143]
  s_waitcnt lgkmcnt(2)
  v_mfma_f32_16x16x32_bf16 v[128:131], a[44:47], v[88:91], v[128:131]
  ds_read_b128 v[72:75], v30 offset:20480
  v_mfma_f32_16x16x32_bf16 v[132:135], a[108:111], v[88:91], v[132:135]
  ds_read_b128 v[76:79], v30 offset:21504
  v_mfma_f32_16x16x32_bf16 v[136:139], a[44:47], v[92:95], v[136:139]
  v_mfma_f32_16x16x32_bf16 v[140:143], a[108:111], v[92:95], v[140:143]
  s_waitcnt lgkmcnt(2)
  s_waitcnt vmcnt(4)
  s_barrier
  v_mfma_f32_16x16x32_bf16 v[128:131], a[48:51], v[64:67], v[128:131]
  ds_read_b128 v[80:83], v30 offset:24576
  v_mfma_f32_16x16x32_bf16 v[132:135], a[112:115], v[64:67], v[132:135]
  ds_read_b128 v[84:87], v30 offset:25600
  v_mfma_f32_16x16x32_bf16 v[136:139], a[48:51], v[68:71], v[136:139]
  v_mfma_f32_16x16x32_bf16 v[140:143], a[112:115], v[68:71], v[140:143]
  s_waitcnt lgkmcnt(2)
  v_mfma_f32_16x16x32_bf16 v[128:131], a[52:55], v[72:75], v[128:131]
  ds_read_b128 v[88:91], v30 offset:28672
  v_mfma_f32_16x16x32_bf16 v[132:135], a[116:119], v[72:75], v[132:135]
  ds_read_b128 v[92:95], v30 offset:29696
  v_mfma_f32_16x16x32_bf16 v[136:139], a[52:55], v[76:79], v[136:139]
  v_mfma_f32_16x16x32_bf16 v[140:143], a[116:119], v[76:79], v[140:143]
  s_waitcnt lgkmcnt(2)
  v_mfma_f32_16x16x32_bf16 v[128:131], a[56:59], v[80:83], v[128:131]
  ds_read_b128 v[64:67], v31 offset:0
  v_mfma_f32_16x16x32_bf16 v[132:135], a[120:123], v[80:83], v[132:135]
  ds_read_b128 v[68:71], v31 offset:1024
  v_mfma_f32_16x16x32_bf16 v[136:139], a[56:59], v[84:87], v[136:139]
  v_mfma_f32_16x16x32_bf16 v[140:143], a[120:123], v[84:87], v[140:143]
  s_waitcnt lgkmcnt(2)
  v_mfma_f32_16x16x32_bf16 v[128:131], a[60:63], v[88:91], v[128:131]
  ds_read_b128 v[72:75], v31 offset:4096
  v_mfma_f32_16x16x32_bf16 v[132:135], a[124:127], v[88:91], v[132:135]
  ds_read_b128 v[76:79], v31 offset:5120
  v_mfma_f32_16x16x32_bf16 v[136:139], a[60:63], v[92:95], v[136:139]
  v_mfma_f32_16x16x32_bf16 v[140:143], a[124:127], v[92:95], v[140:143]
  s_waitcnt lgkmcnt(2)
  s_waitcnt vmcnt(0)
  s_barrier
  v_mfma_f32_16x16x32_bf16 v[128:131], v[200:203], v[64:67], v[128:131]
  ds_read_b128 v[80:83], v31 offset:8192
  v_mfma_f32_16x16x32_bf16 v[132:135], v[224:227], v[64:67], v[132:135]
  ds_read_b128 v[84:87], v31 offset:9216
  v_mfma_f32_16x16x32_bf16 v[136:139], v[200:203], v[68:71], v[136:139]
  v_mfma_f32_16x16x32_bf16 v[140:143], v[224:227], v[68:71], v[140:143]
  s_waitcnt lgkmcnt(2)
  v_mfma_f32_16x16x32_bf16 v[128:131], v[204:207], v[72:75], v[128:131]
  ds_read_b128 v[88:91], v31 offset:12288
  v_mfma_f32_16x16x32_bf16 v[132:135], v[228:231], v[72:75], v[132:135]
  ds_read_b128 v[92:95], v31 offset:13312
  v_mfma_f32_16x16x32_bf16 v[136:139], v[204:207], v[76:79], v[136:139]
  v_mfma_f32_16x16x32_bf16 v[140:143], v[228:231], v[76:79], v[140:143]
  s_waitcnt lgkmcnt(2)
  v_mfma_f32_16x16x32_bf16 v[128:131], v[208:211], v[80:83], v[128:131]
  ds_read_b128 v[64:67], v31 offset:16384
  v_mfma_f32_16x16x32_bf16 v[132:135], v[232:235], v[80:83], v[132:135]
  ds_read_b128 v[68:71], v31 offset:17408
  v_mfma_f32_16x16x32_bf16 v[136:139], v[208:211], v[84:87], v[136:139]
  v_mfma_f32_16x16x32_bf16 v[140:143], v[232:235], v[84:87], v[140:143]
  s_waitcnt lgkmcnt(2)
  v_mfma_f32_16x16x32_bf16 v[128:131], v[212:215], v[88:91], v[128:131]
  ds_read_b128 v[72:75], v31 offset:20480
  v_mfma_f32_16x16x32_bf16 v[132:135], v[236:239], v[88:91], v[132:135]
  ds_read_b128 v[76:79], v31 offset:21504
  v_mfma_f32_16x16x32_bf16 v[136:139], v[212:215], v[92:95], v[136:139]
  v_mfma_f32_16x16x32_bf16 v[140:143], v[236:239], v[92:95], v[140:143]
  s_waitcnt lgkmcnt(2)
  v_mfma_f32_16x16x32_bf16 v[128:131], v[216:219], v[64:67], v[128:131]
  v_mfma_f32_16x16x32_bf16 v[132:135], v[240:243], v[64:67], v[132:135]
  v_mfma_f32_16x16x32_bf16 v[136:139], v[216:219], v[68:71], v[136:139]
  v_mfma_f32_16x16x32_bf16 v[140:143], v[240:243], v[68:71], v[140:143]
  s_waitcnt lgkmcnt(0)
  v_mfma_f32_16x16x32_bf16 v[128:131], v[220:223], v[72:75], v[128:131]
  v_mfma_f32_16x16x32_bf16 v[132:135], v[244:247], v[72:75], v[132:135]
  v_mfma_f32_16x16x32_bf16 v[136:139], v[220:223], v[76:79], v[136:139]
  v_mfma_f32_16x16x32_bf16 v[140:143], v[244:247], v[76:79], v[140:143]
  s_nop 4
  v_cvt_pk_bf16_f32 v64, v128, v129
  v_cvt_pk_bf16_f32 v65, v130, v131
  v_cvt_pk_bf16_f32 v66, v132, v133
  v_cvt_pk_bf16_f32 v67, v134, v135
  v_cvt_pk_bf16_f32 v68, v136, v137
  v_cvt_pk_bf16_f32 v69, v138, v139
  v_cvt_pk_bf16_f32 v70, v140, v141
  v_cvt_pk_bf16_f32 v71, v142, v143
  v_permlane16_swap_b32 v64, v66
  v_permlane16_swap_b32 v65, v67
  buffer_store_dwordx4 v[64:67], v32, s[32:35], s81 offen
  v_permlane16_swap_b32 v68, v70
  v_permlane16_swap_b32 v69, v71
  buffer_store_dwordx4 v[68:71], v32, s[32:35], s82 offen
L_finish:
  s_cmp_eq_u32 s2, 0
  s_cselect_b32 s56, s44, 1
  s_cmp_eq_u32 s56, 0
  s_cbranch_scc0 L_noepoch
  s_mov_b64 exec, 1
  buffer_store_dwordx2 v[4:5], off, s[36:39], 0 sc1
  s_mov_b64 exec, -1
L_noepoch:
  s_waitcnt vmcnt(0)
L_exit:
  s_endpgm
L_attn_slow:
  s_nop 15
  s_lshl_b32 s76, s43, 17
  s_add_u32 s76, s76, 3145728
  v_mov_b32 v8, 0xff800000
  v_mov_b32 v10, 0xff800000
  s_mov_b32 s77, 0
L_slow_max:
  s_lshr_b32 s78, s77, 1
  s_lshl_b32 s78, s78, 12
  s_and_b32 s79, s77, 1
  s_lshl_b32 s79, s79, 10
  s_add_u32 s78, s78, s79
  s_add_u32 s78, s78, s76
  buffer_load_dwordx4 v[184:187], v1, s[36:39], s78 offen sc1
  s_waitcnt vmcnt(0)
  v_mfma_f32_32x32x16_bf16 v[64:79], v[184:187], v[176:179], 0
  v_mfma_f32_32x32x16_bf16 v[80:95], v[184:187], v[180:183], 0
  s_nop 10
  v_max3_f32 v8, v8, v64, v65
  v_max3_f32 v8, v8, v66, v67
  v_max3_f32 v8, v8, v68, v69
  v_max3_f32 v8, v8, v70, v71
  v_max3_f32 v8, v8, v72, v73
  v_max3_f32 v8, v8, v74, v75
  v_max3_f32 v8, v8, v76, v77
  v_max3_f32 v8, v8, v78, v79
  v_max3_f32 v10, v10, v80, v81
  v_max3_f32 v10, v10, v82, v83
  v_max3_f32 v10, v10, v84, v85
  v_max3_f32 v10, v10, v86, v87
  v_max3_f32 v10, v10, v88, v89
  v_max3_f32 v10, v10, v90, v91
  v_max3_f32 v10, v10, v92, v93
  v_max3_f32 v10, v10, v94, v95
  s_add_u32 s77, s77, 1
  s_cmp_lt_u32 s77, 64
  s_cbranch_scc1 L_slow_max
  v_mov_b32 v9, v8
  v_mov_b32 v11, v10
  s_nop 0
  v_permlane32_swap_b32 v8, v9
  v_permlane32_swap_b32 v10, v11
  v_max_f32 v8, v8, v9
  v_sub_f32 v8, 0, v8
  v_mov_b32 v144, v8
  v_mov_b32 v145, v8
  v_mov_b32 v146, v8
  v_mov_b32 v147, v8
  v_mov_b32 v148, v8
  v_mov_b32 v149, v8
  v_mov_b32 v150, v8
  v_mov_b32 v151, v8
  v_mov_b32 v152, v8
  v_mov_b32 v153, v8
  v_mov_b32 v154, v8
  v_mov_b32 v155, v8
  v_mov_b32 v156, v8
  v_mov_b32 v157, v8
  v_mov_b32 v158, v8
  v_mov_b32 v159, v8
  v_max_f32 v10, v10, v11
  v_sub_f32 v10, 0, v10
  v_mov_b32 v160, v10
  v_mov_b32 v161, v10
  v_mov_b32 v162, v10
  v_mov_b32 v163, v10
  v_mov_b32 v164, v10
  v_mov_b32 v165, v10
  v_mov_b32 v166, v10
  v_mov_b32 v167, v10
  v_mov_b32 v168, v10
  v_mov_b32 v169, v10
  v_mov_b32 v170, v10
  v_mov_b32 v171, v10
  v_mov_b32 v172, v10
  v_mov_b32 v173, v10
  v_mov_b32 v174, v10
  v_mov_b32 v175, v10
  v_mov_b32 v112, 0
  v_mov_b32 v113, 0
  v_mov_b32 v114, 0
  v_mov_b32 v115, 0
  v_mov_b32 v116, 0
  v_mov_b32 v117, 0
  v_mov_b32 v118, 0
  v_mov_b32 v119, 0
  v_mov_b32 v120, 0
  v_mov_b32 v121, 0
  v_mov_b32 v122, 0
  v_mov_b32 v123, 0
  v_mov_b32 v124, 0
  v_mov_b32 v125, 0
  v_mov_b32 v126, 0
  v_mov_b32 v127, 0
  v_mov_b32 v128, 0
  v_mov_b32 v129, 0
  v_mov_b32 v130, 0
  v_mov_b32 v131, 0
  v_mov_b32 v132, 0
  v_mov_b32 v133, 0
  v_mov_b32 v134, 0
  v_mov_b32 v135, 0
  v_mov_b32 v136, 0
  v_mov_b32 v137, 0
  v_mov_b32 v138, 0
  v_mov_b32 v139, 0
  v_mov_b32 v140, 0
  v_mov_b32 v141, 0
  v_mov_b32 v142, 0
  v_mov_b32 v143, 0
  v_and_b32 v8, 27, v0
  v_cmp_eq_u32 vcc, 16, v8
  v_mov_b32 v9, s52
  s_nop 0
  v_cndmask_b32 v9, v3, v9, vcc
  v_mov_b32 v192, v9
  v_mov_b32 v193, v9
  v_mov_b32 v194, v9
  v_mov_b32 v195, v9
  v_mov_b32 v196, v9
  v_mov_b32 v197, v9
  v_mov_b32 v198, v9
  v_mov_b32 v199, v9
  v_and_b32 v8, 15, v0
  v_lshrrev_b32 v10, 5, v0
  v_lshl_add_u32 v10, v10, 4, v8
  v_lshlrev_b32 v10, 4, v10
  s_mov_b32 s77, 0
  s_mov_b32 s60, 0x0000ffff
  s_mov_b32 s61, 0x0000ffff
L_slow_pv:
  s_lshr_b32 s78, s77, 1
  s_lshl_b32 s78, s78, 12
  s_and_b32 s79, s77, 1
  s_lshl_b32 s79, s79, 10
  s_add_u32 s78, s78, s79
  s_add_u32 s78, s78, s76
  buffer_load_dwordx4 v[184:187], v1, s[36:39], s78 offen sc1
  s_add_u32 s78, s78, 2048
  s_mov_b64 exec, s[60:61]
  buffer_load_dwordx4 v[192:195], v10, s[36:39], s78 offen sc1
  buffer_load_dwordx4 v[196:199], v10, s[36:39], s78 offen offset:512 sc1
  s_mov_b64 exec, -1
  s_waitcnt vmcnt(0)
  v_mfma_f32_32x32x16_bf16 v[64:79], v[184:187], v[176:179], v[144:159]
  v_mfma_f32_32x32x16_bf16 v[80:95], v[184:187], v[180:183], v[160:175]
  s_nop 10
  v_exp_f32 v64, v64
  v_exp_f32 v65, v65
  v_exp_f32 v66, v66
  v_exp_f32 v67, v67
  v_exp_f32 v68, v68
  v_exp_f32 v69, v69
  v_exp_f32 v70, v70
  v_exp_f32 v71, v71
  v_exp_f32 v72, v72
  v_exp_f32 v73, v73
  v_exp_f32 v74, v74
  v_exp_f32 v75, v75
  v_exp_f32 v76, v76
  v_exp_f32 v77, v77
  v_exp_f32 v78, v78
  v_exp_f32 v79, v79
  v_smfmac_f32_32x32x32_bf16 v[112:127], v[192:195], v[64:71], v208
  s_nop 0
  v_smfmac_f32_32x32x32_bf16 v[112:127], v[196:199], v[72:79], v208
  v_exp_f32 v80, v80
  v_exp_f32 v81, v81
  v_exp_f32 v82, v82
  v_exp_f32 v83, v83
  v_exp_f32 v84, v84
  v_exp_f32 v85, v85
  v_exp_f32 v86, v86
  v_exp_f32 v87, v87
  v_exp_f32 v88, v88
  v_exp_f32 v89, v89
  v_exp_f32 v90, v90
  v_exp_f32 v91, v91
  v_exp_f32 v92, v92
  v_exp_f32 v93, v93
  v_exp_f32 v94, v94
  v_exp_f32 v95, v95
  v_smfmac_f32_32x32x32_bf16 v[128:143], v[192:195], v[80:87], v208
  s_nop 0
  v_smfmac_f32_32x32x32_bf16 v[128:143], v[196:199], v[88:95], v208
  s_add_u32 s77, s77, 1
  s_cmp_lt_u32 s77, 64
  s_nop 15
  s_cbranch_scc1 L_slow_pv
  s_nop 15
  s_branch L_attn_done
L_code_end:
.section .rodata,"a"
.p2align 6
.amdhsa_kernel sequential_preLN__softmax_full_mha__mixer_gmlp__prompt_kernel
  .amdhsa_next_free_vgpr 512
  .amdhsa_next_free_sgpr 102
  .amdhsa_accum_offset 256
  .amdhsa_group_segment_fixed_size 0
  .amdhsa_kernarg_size 88
  .amdhsa_user_sgpr_count 2
  .amdhsa_user_sgpr_kernarg_segment_ptr 1
  .amdhsa_system_sgpr_workgroup_id_x 1
  .amdhsa_float_denorm_mode_32 3
.end_amdhsa_kernel
```
